```python
import torch

def _softmax(x, axis=-1):
    return torch.softmax(x, dim=axis)
def _gelu(x):
    return torch.nn.functional.gelu(x, approximate="tanh")
def _silu(x):
    return torch.nn.functional.silu(x)
def _sigmoid(x):
    return torch.sigmoid(x)
def _layernorm(x, axis=-1, eps=1e-5):
    m = x.mean(dim=axis, keepdim=True)
    v = x.var(dim=axis, keepdim=True, unbiased=False)
    return (x - m) / torch.sqrt(v + eps)
def _scatter_add(tgt, idx, src, axis=0):
    return tgt.clone().index_add_(axis, idx, src)
def _segment_sum(src, seg, n):
    out = torch.zeros((n,) + src.shape[1:], dtype=src.dtype)
    return out.index_add_(0, seg, src)
def _pad(x, pw):
    flat = tuple(v for pair in reversed(pw) for v in pair)
    return torch.nn.functional.pad(x, flat)

kernel_name = 'recurrent_scan__ssm_conv_s4__mixer_s_mlp__prompt'

def setup_inputs():

    _w = (lambda a: (lambda t: t.to(torch.bfloat16) if t.is_floating_point() else t)(torch.as_tensor(a)))
    def _A_setup():
        B, L, D, N = 1, 2048, 640, 192
        A_re = -(lambda _x: torch.exp(torch.as_tensor(_x)))((lambda *s: torch.randn(*s, dtype=torch.bfloat16) * 3.2)(D, N))
        A_im = torch.pi * (lambda *s: torch.randn(*s, dtype=torch.bfloat16) * 0.05)(D, N)
        B_re = (lambda *s: torch.randn(*s, dtype=torch.bfloat16) * 0.1)(D, N)
        B_im = (lambda *s: torch.randn(*s, dtype=torch.bfloat16) * 0.1)(D, N)
        C_re = (lambda *s: torch.randn(*s, dtype=torch.bfloat16) * 0.1)(D, N)
        C_im = (lambda *s: torch.randn(*s, dtype=torch.bfloat16) * 0.1)(D, N)
        log_dt = (lambda *s: torch.randn(*s, dtype=torch.bfloat16) * 0.05)(D) * 0.5 - 4.0
        Dskip = (lambda *s: torch.randn(*s, dtype=torch.bfloat16) * 0.05)(D)
        return {
            "u": _w((lambda *s: torch.randn(*s, dtype=torch.bfloat16) * 0.05)(B, L, D)),
            "A_re": _w(A_re),
            "A_im": _w(A_im),
            "B_re": _w(B_re),
            "B_im": _w(B_im),
            "C_re": _w(C_re),
            "C_im": _w(C_im),
            "log_dt": _w(log_dt),
            "Dskip": _w(Dskip),
        }
    _A_in = _A_setup()

    def _B_setup():
        B, S, D, F = 1, 2048, 640, 1536
        return {
            "x":  _w((lambda *s: torch.randn(*s, dtype=torch.bfloat16) * 0.05)(B, S, D)),
            "w1": _w((lambda *s: torch.randn(*s, dtype=torch.bfloat16) * 3.2)(D, D) * (D ** -0.5)),
            "w2": _w((lambda *s: torch.randn(*s, dtype=torch.bfloat16) * 3.2)(D, D) * (D ** -0.5)),
            "w3": _w((lambda *s: torch.randn(*s, dtype=torch.bfloat16) * 3.2)(D, F) * (D ** -0.5)),
            "w4": _w((lambda *s: torch.randn(*s, dtype=torch.bfloat16) * 3.2)(F, D) * (F ** -0.5)),
        }
    _B_in = _B_setup()

    return {
        "A_u": _A_in["u"],
        "A_A_re": _A_in["A_re"],
        "A_A_im": _A_in["A_im"],
        "A_B_re": _A_in["B_re"],
        "A_B_im": _A_in["B_im"],
        "A_C_re": _A_in["C_re"],
        "A_C_im": _A_in["C_im"],
        "A_log_dt": _A_in["log_dt"],
        "A_Dskip": _A_in["Dskip"],
        "B_x": _B_in["x"],
        "B_w1": _B_in["w1"],
        "B_w2": _B_in["w2"],
        "B_w3": _B_in["w3"],
        "B_w4": _B_in["w4"],
    }

def reference(A_u, A_A_re, A_A_im, A_B_re, A_B_im, A_C_re, A_C_im, A_log_dt, A_Dskip, B_x, B_w1, B_w2, B_w3, B_w4):
    def _A_ref(u, A_re, A_im, B_re, B_im, C_re, C_im, log_dt, Dskip):
        Bsz, L, D = u.shape
        dt = torch.exp(log_dt)[:, None]
        A = A_re + 1j * A_im
        Bc = B_re + 1j * B_im
        Cc = C_re + 1j * C_im
        logdA = dt * A
        dB = dt * Bc
        l = (lambda x, dt: x.to(dt))(torch.arange(L), A_re.dtype)
        P = torch.exp(logdA[:, :, None] * l[None, None, :])
        K = torch.einsum("dn,dnl,dn->dl", Cc, P, dB).real
        L2 = 2 * L
        Kp = _pad(K, ((0, 0), (0, L)))
        up = (lambda x, *d: x.permute(*d))(u, 0, 2, 1)
        up = _pad(up, ((0, 0), (0, 0), (0, L)))
        Kf = (lambda x, axes=(-2,-1): torch.fft.rfft2(x.float(), dim=axes))(Kp[:, None, :], axes=(-2, -1))
        Uf = (lambda x, axes=(-2,-1): torch.fft.rfft2(x.float(), dim=axes))(up[:, :, None, :], axes=(-2, -1))
        Yf = Uf * Kf[None, :, :, :]
        y = (lambda x, s, axes=(-2,-1): torch.fft.irfft2(x, s=s, dim=axes).to(torch.bfloat16))(Yf, (1, L2), axes=(-2, -1))[:, :, 0, :L]
        y = (lambda x, *d: x.permute(*d))(y, 0, 2, 1) + u * Dskip[None, None, :]
        return y

    def _B_ref(x, w1, w2, w3, w4):
        B, S, D = x.shape
        h = _gelu(_layernorm(x, axis=-1) @ w1)
        c = D // 4
        g0 = _pad(h[:, :, 0*c:1*c], ((0, 0), (1, 0), (0, 0)))[:, :S, :]
        g1 = _pad(h[:, :, 1*c:2*c], ((0, 0), (0, 1), (0, 0)))[:, 1:, :]
        g2 = _pad(h[:, :, 2*c:3*c], ((0, 0), (2, 0), (0, 0)))[:, :S, :]
        g3 = _pad(h[:, :, 3*c:   ], ((0, 0), (0, 2), (0, 0)))[:, 2:, :]
        hs = torch.concatenate([g0, g1, g2, g3], axis=-1) @ w2
        x1 = x + hs
        h2 = _gelu(_layernorm(x1, axis=-1) @ w3) @ w4
        return x1 + h2

    x = A_u
    xn = _layernorm(x, axis=-1)
    s = _A_ref(xn, A_A_re, A_A_im, A_B_re, A_B_im, A_C_re, A_C_im, A_log_dt, A_Dskip)
    g = _silu(_B_ref(xn, B_w1, B_w2, B_w3, B_w4))
    return x + s * g
```

```asm
; @launch grid=(256,1,1) block=(256,1,1) lds=163840
.amdgcn_target "amdgcn-amd-amdhsa--gfx950"
.text
.globl recurrent_scan__ssm_conv_s4__mixer_s_mlp__prompt_kernel
.p2align 8
.type recurrent_scan__ssm_conv_s4__mixer_s_mlp__prompt_kernel,@function
recurrent_scan__ssm_conv_s4__mixer_s_mlp__prompt_kernel:
    s_cmp_ge_u32 s2, 256
    s_cbranch_scc1 L_end
    s_load_dwordx16 s[4:19], s[0:1], 0
    s_load_dwordx16 s[20:35], s[0:1], 64
    s_load_dwordx2 s[36:37], s[0:1], 128
    v_lshrrev_b32 v37, 6, v0
    v_and_b32 v0, 63, v0
    v_readfirstlane_b32 s62, v37
    v_lshlrev_b32 v1, 4, v0
    v_lshlrev_b32 v36, 3, v0
    v_and_b32 v2, 15, v0
    v_lshrrev_b32 v3, 4, v0
    s_bfe_u32 s60, s2, 0x30003
    s_and_b32 s61, s2, 7
    s_lshl_b32 s61, s61, 2
    s_lshr_b32 s66, s2, 6
    s_add_u32 s61, s61, s66
    s_lshr_b32 s66, s60, 2
    s_add_u32 s63, s66, 1
    s_sub_u32 s66, 0, s63
    s_bitcmp1_b32 s60, 1
    s_cselect_b32 s63, s66, s63
    s_mul_i32 s66, s61, 3
    s_lshl_b32 s67, s61, 1
    s_add_u32 s67, s67, 16
    s_cmp_lt_u32 s61, 16
    s_cselect_b32 s66, s66, s67
    s_cselect_b32 s67, 3, 2
    s_cmp_lt_u32 s62, s67
    s_cselect_b32 s77, 1, 0
    s_cselect_b32 s67, s62, 0
    s_add_u32 s66, s66, s67
    s_mul_i32 s76, s60, 80
    s_add_u32 s76, s76, s66
    s_sub_u32 s67, s76, s67
    s_add_u32 s81, s67, 1
    s_mul_i32 s66, s61, 3
    s_mul_i32 s80, s60, 80
    s_add_u32 s80, s80, s66
    s_sub_u32 s80, s80, 46
    s_cmp_eq_u32 s62, 3
    s_cselect_b32 s80, s67, s80
    s_cmp_eq_u32 s77, 1
    s_cselect_b32 s80, s76, s80
    s_cselect_b32 s81, s76, s81
    s_cselect_b32 s66, 63, 31
    s_cselect_b32 s67, 0, 256
    v_and_b32 v237, s66, v0
    v_lshl_add_u32 v237, v237, 2, s67
    s_mul_i32 s66, s80, 384
    v_add_u32 v236, s66, v237
    s_mul_i32 s66, s81, 384
    v_add_u32 v237, s66, v237
    s_lshl_b32 s66, s61, 6
    s_sub_u32 s66, s66, s63
    v_lshl_add_u32 v228, s62, 2, v3
    v_xor_b32 v229, v228, v2
    v_add_u32 v228, s66, v228
    v_mul_i32_i24 v228, 1280, v228
    v_lshl_add_u32 v228, v229, 4, v228
    v_add_u32 v200, 0, v228
    v_min_u32 v200, 0x7ffff000, v200
    v_add_u32 v201, 20480, v228
    v_min_u32 v201, 0x7ffff000, v201
    v_add_u32 v202, 40960, v228
    v_min_u32 v202, 0x7ffff000, v202
    v_add_u32 v203, 61440, v228
    v_min_u32 v203, 0x7ffff000, v203
    s_lshl_b32 s100, s62, 10
    s_mul_i32 s101, s62, 5120
    s_mul_i32 s74, s62, 40960
    s_mul_i32 s68, s60, 160
    s_add_u32 s74, s74, s68
    s_add_u32 s69, s66, 64
    s_lshl_b32 s70, s61, 6
    s_cmp_gt_i32 s63, 0
    s_cselect_b32 s69, s69, s70
    s_mul_i32 s69, s69, 1280
    s_mul_i32 s71, s62, 640
    s_add_u32 s69, s69, s71
    s_lshr_b32 s70, s80, 1
    s_lshl_b32 s70, s70, 2
    s_lshr_b32 s72, s81, 1
    s_lshl_b32 s72, s72, 2
    s_lshl_b32 s73, s61, 3
    s_add_u32 s73, s73, s60
    s_lshl_b32 s73, s73, 2
    s_add_u32 s73, s73, s62
    s_mul_i32 s38, s73, 2560
    v_lshl_add_u32 v245, v0, 7, s38
    s_mul_i32 s38, s73, 896
    v_lshl_add_u32 v246, v0, 7, s38
    v_min_u32 v246, 819196, v246
    s_waitcnt lgkmcnt(0)
    s_load_dword s78, s[18:19], s70
    s_load_dword s87, s[18:19], s72
    s_load_dword s79, s[20:21], s70
    s_load_dwordx2 s[64:65], s[36:37], 0
    global_load_dword v24, v236, s[6:7]
    global_load_dword v25, v237, s[6:7]
    global_load_dword v26, v236, s[8:9]
    global_load_dword v27, v237, s[8:9]
    global_load_dword v28, v236, s[10:11]
    global_load_dword v29, v237, s[10:11]
    global_load_dword v30, v236, s[12:13]
    global_load_dword v31, v237, s[12:13]
    global_load_dword v32, v236, s[14:15]
    global_load_dword v33, v237, s[14:15]
    global_load_dword v34, v236, s[16:17]
    global_load_dword v35, v237, s[16:17]
    s_mov_b64 exec, 0xfffff
    global_load_dword v254, v245, s[4:5]
    s_mov_b64 exec, -1
    s_mov_b64 exec, 0x7f
    global_load_dword v254, v246, s[24:25]
    s_mov_b64 exec, -1
    s_getpc_b64 s[72:73]
L_pc:
    s_lshr_b32 s66, s2, 3
    s_lshl_b32 s66, s66, 2
    s_add_u32 s66, s66, s62
    s_mul_i32 s66, s66, 384
    v_lshl_add_u32 v228, v0, 7, s66
    v_min_u32 v228, 38140, v228
    s_mov_b64 exec, 7
    global_load_dword v254, v228, s[72:73]
    s_mov_b64 exec, -1
    s_mov_b32 s40, s4
    s_and_b32 s41, s5, 0xffff
    s_mov_b32 s42, 0x280000
    s_mov_b32 s43, 0x20000
    s_mov_b32 s90, s69
    s_add_u32 s91, s71, 161280
    s_mov_b32 s38, 0
    s_add_u32 m0, s100, 79360
    s_nop 0
    buffer_load_dwordx4 v200, s[40:43], s38 offen lds
    s_add_u32 m0, s100, 83456
    s_nop 0
    buffer_load_dwordx4 v201, s[40:43], s38 offen lds
    s_add_u32 m0, s100, 87552
    s_nop 0
    buffer_load_dwordx4 v202, s[40:43], s38 offen lds
    s_add_u32 m0, s100, 91648
    s_nop 0
    buffer_load_dwordx4 v203, s[40:43], s38 offen lds
    s_mov_b32 s44, s24
    s_and_b32 s45, s25, 0xffff
    s_mov_b32 s46, 0xc8000
    s_mov_b32 s47, 0x20000
    s_mov_b32 s52, s36
    s_and_b32 s53, s37, 0xffff
    s_mov_b32 s54, 0x1500000
    s_mov_b32 s55, 0x20000
    s_mov_b32 s56, s32
    s_and_b32 s57, s33, 0xffff
    s_mov_b32 s58, 0x280000
    s_mov_b32 s59, 0x20000
    v_add_u32 v228, 0, v0
    v_mul_u32_u24 v229, 6554, v228
    v_lshrrev_b32 v229, 16, v229
    v_mul_u32_u24 v230, 10, v229
    v_sub_u32 v230, v228, v230
    v_lshrrev_b32 v231, 1, v229
    v_xor_b32 v231, v231, v229
    v_and_b32 v231, 4, v231
    v_mul_u32_u24 v231, 3, v231
    v_xor_b32 v229, v229, v231
    v_mul_u32_u24 v229, 1280, v229
    v_lshl_add_u32 v204, v230, 4, v229
    v_add_u32 v228, 64, v0
    v_mul_u32_u24 v229, 6554, v228
    v_lshrrev_b32 v229, 16, v229
    v_mul_u32_u24 v230, 10, v229
    v_sub_u32 v230, v228, v230
    v_lshrrev_b32 v231, 1, v229
    v_xor_b32 v231, v231, v229
    v_and_b32 v231, 4, v231
    v_mul_u32_u24 v231, 3, v231
    v_xor_b32 v229, v229, v231
    v_mul_u32_u24 v229, 1280, v229
    v_lshl_add_u32 v205, v230, 4, v229
    v_add_u32 v228, 128, v0
    v_mul_u32_u24 v229, 6554, v228
    v_lshrrev_b32 v229, 16, v229
    v_mul_u32_u24 v230, 10, v229
    v_sub_u32 v230, v228, v230
    v_lshrrev_b32 v231, 1, v229
    v_xor_b32 v231, v231, v229
    v_and_b32 v231, 4, v231
    v_mul_u32_u24 v231, 3, v231
    v_xor_b32 v229, v229, v231
    v_mul_u32_u24 v229, 1280, v229
    v_lshl_add_u32 v206, v230, 4, v229
    v_add_u32 v228, 192, v0
    v_mul_u32_u24 v229, 6554, v228
    v_lshrrev_b32 v229, 16, v229
    v_mul_u32_u24 v230, 10, v229
    v_sub_u32 v230, v228, v230
    v_lshrrev_b32 v231, 1, v229
    v_xor_b32 v231, v231, v229
    v_and_b32 v231, 4, v231
    v_mul_u32_u24 v231, 3, v231
    v_xor_b32 v229, v229, v231
    v_mul_u32_u24 v229, 1280, v229
    v_lshl_add_u32 v207, v230, 4, v229
    v_add_u32 v228, 256, v0
    v_mul_u32_u24 v229, 6554, v228
    v_lshrrev_b32 v229, 16, v229
    v_mul_u32_u24 v230, 10, v229
    v_sub_u32 v230, v228, v230
    v_lshrrev_b32 v231, 1, v229
    v_xor_b32 v231, v231, v229
    v_and_b32 v231, 4, v231
    v_mul_u32_u24 v231, 3, v231
    v_xor_b32 v229, v229, v231
    v_mul_u32_u24 v229, 1280, v229
    v_lshl_add_u32 v208, v230, 4, v229
    v_lshlrev_b32 v247, 21, v0
    s_mul_i32 s82, s62, 3
    s_lshl_b32 s66, s61, 2
    s_add_u32 s66, s66, s62
    s_sub_u32 s66, 127, s66
    s_cmp_ge_u32 s66, 120
    s_cbranch_scc1 L_rt_none
    s_cmp_ge_u32 s66, 60
    s_cbranch_scc1 L_rt_w4
    s_mul_i32 s69, s66, 86
    s_lshr_b32 s69, s69, 8
    s_mul_i32 s70, s69, 3
    s_sub_u32 s66, s66, s70
    s_mul_i32 s70, s69, 52
    s_lshr_b32 s70, s70, 8
    s_mul_i32 s71, s70, 5
    s_sub_u32 s71, s69, s71
    s_mul_i32 s67, s70, 160
    s_lshr_b32 s68, s71, 1
    s_mul_i32 s68, s68, 80
    s_and_b32 s72, s71, 1
    s_lshl_b32 s72, s72, 5
    s_add_u32 s68, s68, s72
    s_cmp_eq_u32 s71, 4
    s_cselect_b32 s68, 64, s68
    s_cselect_b32 s72, 80, 16
    s_add_u32 s67, s67, s68
    s_mov_b32 s68, s72
    s_mov_b32 s48, s28
    s_and_b32 s49, s29, 0xffff
    s_mov_b32 s50, 0x1e0000
    s_mov_b32 s51, 0x20000
    s_mul_i32 s97, s67, 3072
    s_mul_i32 s70, s60, 384
    s_add_u32 s97, s97, s70
    s_lshl_b32 s70, s66, 7
    s_add_u32 s97, s97, s70
    s_mul_i32 s72, s60, 80
    s_add_u32 s72, s72, s69
    s_mul_i32 s72, s72, 3
    s_lshl_b32 s70, s66, 2
    s_add_u32 s70, s70, 0
    s_mul_i32 s71, s70, 86
    s_lshr_b32 s71, s71, 8
    s_mul_i32 s71, s71, 57
    s_add_u32 s70, s70, s71
    s_add_u32 s70, s70, s72
    s_lshl_b32 s70, s70, 10
    s_add_u32 s83, s70, 1310720
    s_lshl_b32 s70, s66, 2
    s_add_u32 s70, s70, 1
    s_mul_i32 s71, s70, 86
    s_lshr_b32 s71, s71, 8
    s_mul_i32 s71, s71, 57
    s_add_u32 s70, s70, s71
    s_add_u32 s70, s70, s72
    s_lshl_b32 s70, s70, 10
    s_add_u32 s84, s70, 1310720
    s_lshl_b32 s70, s66, 2
    s_add_u32 s70, s70, 2
    s_mul_i32 s71, s70, 86
    s_lshr_b32 s71, s71, 8
    s_mul_i32 s71, s71, 57
    s_add_u32 s70, s70, s71
    s_add_u32 s70, s70, s72
    s_lshl_b32 s70, s70, 10
    s_add_u32 s85, s70, 1310720
    s_lshl_b32 s70, s66, 2
    s_add_u32 s70, s70, 3
    s_mul_i32 s71, s70, 86
    s_lshr_b32 s71, s71, 8
    s_mul_i32 s71, s71, 57
    s_add_u32 s70, s70, s71
    s_add_u32 s70, s70, s72
    s_lshl_b32 s70, s70, 10
    s_add_u32 s86, s70, 1310720
    s_mov_b32 s70, 3072
    s_branch L_rt_done
L_rt_none:
    s_mov_b32 s48, s30
    s_and_b32 s49, s31, 0xffff
    s_mov_b32 s50, 0x1e0000
    s_mov_b32 s51, 0x20000
    s_mov_b32 s97, 0x7fff0000
    s_mov_b32 s83, 0x7ffff000
    s_mov_b32 s84, 0x7ffff000
    s_mov_b32 s85, 0x7ffff000
    s_mov_b32 s86, 0x7ffff000
    s_mov_b32 s68, 0
    s_mov_b32 s70, 0
    s_branch L_rt_done
L_rt_w4:
    s_mul_i32 s70, s60, 60
    s_add_u32 s66, s66, s70
    s_sub_u32 s66, s66, 60
    s_mul_i32 s70, s66, 1366
    s_lshr_b32 s70, s70, 16
    s_mul_i32 s69, s70, 48
    s_sub_u32 s69, s66, s69
    s_mov_b32 s66, s70
    s_mul_i32 s70, s69, 43
    s_lshr_b32 s70, s70, 8
    s_mul_i32 s71, s70, 6
    s_sub_u32 s71, s69, s71
    s_mul_i32 s67, s70, 192
    s_mul_i32 s68, s71, 48
    s_mul_i32 s72, s71, 96
    s_sub_u32 s72, s72, 352
    s_cmp_ge_u32 s71, 4
    s_cselect_b32 s68, s72, s68
    s_cselect_b32 s72, 48, 16
    s_add_u32 s67, s67, s68
    s_mov_b32 s68, s72
    s_mov_b32 s48, s30
    s_and_b32 s49, s31, 0xffff
    s_mov_b32 s50, 0x1e0000
    s_mov_b32 s51, 0x20000
    s_mul_i32 s97, s67, 1280
    s_lshl_b32 s70, s66, 7
    s_add_u32 s97, s97, s70
    s_mul_i32 s72, s69, 5
    s_lshl_b32 s70, s66, 2
    s_add_u32 s70, s70, 0
    s_mul_i32 s71, s70, 52
    s_lshr_b32 s71, s71, 8
    s_mul_i32 s71, s71, 235
    s_add_u32 s70, s70, s71
    s_add_u32 s70, s70, s72
    s_lshl_b32 s70, s70, 10
    s_add_u32 s83, s70, 3276800
    s_lshl_b32 s70, s66, 2
    s_add_u32 s70, s70, 1
    s_mul_i32 s71, s70, 52
    s_lshr_b32 s71, s71, 8
    s_mul_i32 s71, s71, 235
    s_add_u32 s70, s70, s71
    s_add_u32 s70, s70, s72
    s_lshl_b32 s70, s70, 10
    s_add_u32 s84, s70, 3276800
    s_lshl_b32 s70, s66, 2
    s_add_u32 s70, s70, 2
    s_mul_i32 s71, s70, 52
    s_lshr_b32 s71, s71, 8
    s_mul_i32 s71, s71, 235
    s_add_u32 s70, s70, s71
    s_add_u32 s70, s70, s72
    s_lshl_b32 s70, s70, 10
    s_add_u32 s85, s70, 3276800
    s_lshl_b32 s70, s66, 2
    s_add_u32 s70, s70, 3
    s_mul_i32 s71, s70, 52
    s_lshr_b32 s71, s71, 8
    s_mul_i32 s71, s71, 235
    s_add_u32 s70, s70, s71
    s_add_u32 s70, s70, s72
    s_lshl_b32 s70, s70, 10
    s_add_u32 s86, s70, 3276800
    s_mov_b32 s70, 1280
L_rt_done:
    v_lshrrev_b32 v228, 3, v0
    v_and_b32 v229, 7, v0
    v_mul_u32_u24 v228, s70, v228
    v_lshl_add_u32 v221, v229, 4, v228
    s_lshl_b32 s71, s70, 3
    v_add_u32 v222, s71, v221
    s_mul_i32 s71, s70, s68
    v_add_u32 v223, s71, v221
    v_add_u32 v224, s71, v222
    v_lshrrev_b32 v228, 2, v0
    v_lshlrev_b32 v228, 7, v228
    v_and_b32 v229, 3, v0
    v_lshl_add_u32 v228, v229, 3, v228
    s_lshl_b32 s71, s62, 12
    s_add_u32 s71, s71, 0
    v_add_u32 v226, s71, v228
    v_lshl_add_u32 v228, s62, 4, v2
    v_lshlrev_b32 v229, 8, v228
    v_add_u32 v229, 79360, v229
    v_add_u32 v230, 0, v3
    v_xor_b32 v230, v230, v2
    v_lshl_add_u32 v210, v230, 4, v229
    v_add_u32 v230, 4, v3
    v_xor_b32 v230, v230, v2
    v_lshl_add_u32 v211, v230, 4, v229
    v_add_u32 v230, 8, v3
    v_xor_b32 v230, v230, v2
    v_lshl_add_u32 v212, v230, 4, v229
    v_add_u32 v230, 12, v3
    v_xor_b32 v230, v230, v2
    v_lshl_add_u32 v213, v230, 4, v229
    v_and_b32 v230, 32, v0
    v_lshrrev_b32 v230, 1, v230
    v_bfe_u32 v231, v0, 2, 3
    v_add_u32 v230, v230, v231
    v_mul_u32_u24 v230, 160, v230
    v_and_b32 v231, 3, v0
    v_lshl_add_u32 v230, v231, 3, v230
    v_add_u32 v209, 17920, v230
    v_min_u32 v230, 1, v2
    v_mul_u32_u24 v230, 1280, v230
    v_lshl_add_u32 v230, v3, 4, v230
    s_lshl_b32 s67, s62, 6
    s_add_u32 s67, s67, 161280
    v_add_u32 v214, s67, v230
    v_add_u32 v232, s63, v228
    v_subrev_u32 v233, 64, v232
    v_min_u32 v233, v233, v228
    v_cmp_gt_u32 vcc, 64, v232
    v_add_u32 v230, 64, v233
    s_nop 0
    v_cndmask_b32 v230, v230, v232, vcc
    v_lshlrev_b32 v230, 5, v230
    v_add_u32 v220, 0, v230
    s_mul_i32 s67, s60, 160
    v_mul_u32_u24 v233, 1280, v233
    v_add_u32 v233, 161280, v233
    v_and_b32 v234, 15, v232
    s_mov_b32 s69, 79360
    s_add_u32 s68, s67, 0
    v_lshl_add_u32 v230, v3, 3, s68
    v_lshrrev_b32 v231, 8, v230
    v_lshlrev_b32 v231, 14, v231
    v_lshl_add_u32 v231, v232, 8, v231
    v_bfe_u32 v235, v230, 4, 4
    v_xor_b32 v235, v235, v234
    v_lshl_add_u32 v231, v235, 4, v231
    v_and_b32 v235, 8, v230
    v_add3_u32 v231, v231, v235, s69
    v_add_u32 v230, v233, v230
    v_cndmask_b32 v215, v230, v231, vcc
    s_add_u32 s68, s67, 32
    v_lshl_add_u32 v230, v3, 3, s68
    v_lshrrev_b32 v231, 8, v230
    v_lshlrev_b32 v231, 14, v231
    v_lshl_add_u32 v231, v232, 8, v231
    v_bfe_u32 v235, v230, 4, 4
    v_xor_b32 v235, v235, v234
    v_lshl_add_u32 v231, v235, 4, v231
    v_and_b32 v235, 8, v230
    v_add3_u32 v231, v231, v235, s69
    v_add_u32 v230, v233, v230
    v_cndmask_b32 v216, v230, v231, vcc
    s_add_u32 s68, s67, 64
    v_lshl_add_u32 v230, v3, 3, s68
    v_lshrrev_b32 v231, 8, v230
    v_lshlrev_b32 v231, 14, v231
    v_lshl_add_u32 v231, v232, 8, v231
    v_bfe_u32 v235, v230, 4, 4
    v_xor_b32 v235, v235, v234
    v_lshl_add_u32 v231, v235, 4, v231
    v_and_b32 v235, 8, v230
    v_add3_u32 v231, v231, v235, s69
    v_add_u32 v230, v233, v230
    v_cndmask_b32 v217, v230, v231, vcc
    s_add_u32 s68, s67, 96
    v_lshl_add_u32 v230, v3, 3, s68
    v_lshrrev_b32 v231, 8, v230
    v_lshlrev_b32 v231, 14, v231
    v_lshl_add_u32 v231, v232, 8, v231
    v_bfe_u32 v235, v230, 4, 4
    v_xor_b32 v235, v235, v234
    v_lshl_add_u32 v231, v235, 4, v231
    v_and_b32 v235, 8, v230
    v_add3_u32 v231, v231, v235, s69
    v_add_u32 v230, v233, v230
    v_cndmask_b32 v218, v230, v231, vcc
    s_add_u32 s68, s67, 128
    v_lshl_add_u32 v230, v3, 3, s68
    v_lshrrev_b32 v231, 8, v230
    v_lshlrev_b32 v231, 14, v231
    v_lshl_add_u32 v231, v232, 8, v231
    v_bfe_u32 v235, v230, 4, 4
    v_xor_b32 v235, v235, v234
    v_lshl_add_u32 v231, v235, 4, v231
    v_and_b32 v235, 8, v230
    v_add3_u32 v231, v231, v235, s69
    v_add_u32 v230, v233, v230
    v_cndmask_b32 v219, v230, v231, vcc
    v_add_u32 v228, 0, v0
    v_mul_u32_u24 v229, 6554, v228
    v_lshrrev_b32 v229, 16, v229
    v_mul_u32_u24 v230, 10, v229
    v_sub_u32 v230, v228, v230
    v_mul_u32_u24 v229, 1280, v229
    v_lshl_add_u32 v248, v230, 4, v229
    v_add_u32 v228, 64, v0
    v_mul_u32_u24 v229, 6554, v228
    v_lshrrev_b32 v229, 16, v229
    v_mul_u32_u24 v230, 10, v229
    v_sub_u32 v230, v228, v230
    v_mul_u32_u24 v229, 1280, v229
    v_lshl_add_u32 v249, v230, 4, v229
    v_add_u32 v228, 128, v0
    v_mul_u32_u24 v229, 6554, v228
    v_lshrrev_b32 v229, 16, v229
    v_mul_u32_u24 v230, 10, v229
    v_sub_u32 v230, v228, v230
    v_mul_u32_u24 v229, 1280, v229
    v_lshl_add_u32 v250, v230, 4, v229
    v_add_u32 v228, 192, v0
    v_mul_u32_u24 v229, 6554, v228
    v_lshrrev_b32 v229, 16, v229
    v_mul_u32_u24 v230, 10, v229
    v_sub_u32 v230, v228, v230
    v_mul_u32_u24 v229, 1280, v229
    v_lshl_add_u32 v251, v230, 4, v229
    v_add_u32 v228, 256, v0
    v_mul_u32_u24 v229, 6554, v228
    v_lshrrev_b32 v229, 16, v229
    v_mul_u32_u24 v230, 10, v229
    v_sub_u32 v230, v228, v230
    v_mul_u32_u24 v229, 1280, v229
    v_lshl_add_u32 v252, v230, 4, v229
    v_lshrrev_b32 v228, 2, v0
    v_mul_u32_u24 v228, 160, v228
    v_and_b32 v229, 3, v0
    v_lshl_add_u32 v228, v229, 3, v228
    v_add_u32 v196, s101, v228
    v_add_u32 v197, 98304, v196
    s_mov_b32 s14, 0x22222222
    s_mov_b32 s15, 0x22222222
    s_mov_b32 s16, 0x44444444
    s_mov_b32 s17, 0x44444444
    s_mov_b32 s18, 0x88888888
    s_mov_b32 s19, 0x88888888
    s_mov_b32 s20, 0x00f0000f
    s_mov_b32 s21, 0xf0000f00
    v_lshl_add_u32 v228, s62, 4, v2
    v_lshlrev_b32 v228, 5, v228
    v_lshlrev_b32 v229, 5, v2
    v_lshl_add_u32 v229, s62, 3, v229
    v_add_u32 v198, 0, v228
    v_add_u32 v199, 2048, v229
    s_waitcnt lgkmcnt(0)
    s_mul_i32 s64, s64, 0x9e3779b1
    s_add_u32 s64, s64, 0x7f4a7c15
    s_mul_i32 s65, s65, 0x85ebca6b
    s_xor_b32 s65, s65, s64
    s_add_u32 s65, s65, 0x165667b1
    v_mov_b32 v38, s64
    v_mov_b32 v39, s65
    s_mov_b32 s8, 0
    s_add_u32 s38, s74, 0
    s_add_u32 m0, s101, 38400
    s_nop 0
    buffer_load_dwordx4 v204, s[44:47], s38 offen lds
    s_add_u32 m0, s101, 39424
    s_nop 0
    buffer_load_dwordx4 v205, s[44:47], s38 offen lds
    s_add_u32 m0, s101, 40448
    s_nop 0
    buffer_load_dwordx4 v206, s[44:47], s38 offen lds
    s_waitcnt vmcnt(10)
    s_mul_i32 s66, s62, 8704
    s_add_u32 m0, s101, 41472
    s_nop 0
    buffer_load_dwordx4 v207, s[44:47], s38 offen lds
    s_mov_b32 m0, s22
    s_add_u32 s66, s66, 0
    s_sub_u32 s22, s66, 0
    s_mov_b32 m0, s22
    v_and_b32 v142, 31, v0
    v_mul_u32_u24 v142, 272, v142
    v_lshrrev_b32 v143, 5, v0
    v_lshl_add_u32 v142, v143, 4, v142
    v_add_u32 v140, s66, v142
    s_and_b32 s66, s80, 1
    s_lshl_b32 s66, s66, 4
    s_lshr_b32 s78, s78, s66
    s_lshl_b32 s78, s78, 16
    s_lshr_b32 s79, s79, s66
    s_and_b32 s79, s79, 0xffff
    v_mov_b32 v142, s78
    v_mul_f32 v143, 0x3fb8aa3b, v142
    v_mov_b32 v144, 0x3fb8aa3b
    v_fma_f32 v144, v142, v144, -v143
    v_fmac_f32 v144, 0x32a57060, v142
    v_exp_f32 v143, v143
    v_mul_f32 v144, 0x3f317218, v144
    v_fma_f32 v143, v143, v144, v143
    v_cvt_pk_bf16_f32 v142, v143, v143
    v_and_b32 v142, 0xffff0000, v142
    v_mul_f32 v143, 0x3fb8aa3b, v142
    v_mul_f32 v144, 0x3e22f983, v142
    s_add_u32 m0, s101, 42496
    s_nop 0
    buffer_load_dwordx4 v208, s[44:47], s38 offen lds
    s_mov_b32 m0, s22
    v_readfirstlane_b32 s78, v142
    v_readfirstlane_b32 s95, v143
    v_readfirstlane_b32 s96, v144
    v_lshrrev_b32 v142, 5, v0
    s_cmp_eq_u32 s77, 1
    s_cselect_b32 s66, 0, 16
    s_cselect_b32 s67, 0, 0
    v_mul_u32_u24 v142, s66, v142
    v_add_u32 v142, s67, v142
    v_lshrrev_b32 v126, v142, v24
    v_lshrrev_b32 v127, v142, v26
    v_lshrrev_b32 v128, v142, v28
    v_lshrrev_b32 v129, v142, v30
    v_lshrrev_b32 v130, v142, v32
    v_lshrrev_b32 v131, v142, v34
    v_lshlrev_b32 v126, 16, v126
    v_lshlrev_b32 v127, 16, v127
    v_lshlrev_b32 v128, 16, v128
    v_lshlrev_b32 v129, 16, v129
    v_lshlrev_b32 v130, 16, v130
    v_lshlrev_b32 v131, 16, v131
    v_mul_f32 v126, s95, v126
    v_mul_f32 v127, s96, v127
    v_pk_mul_f32 v[128:129], v[128:129], s[78:79] op_sel_hi:[1,0]
    v_mul_f32 v143, 0x41000000, v126
    v_mul_f32 v146, 0x41000000, v127
    v_mul_f32 v144, 0x43800000, v126
    s_mov_b32 m0, s91
    s_mov_b32 exec_hi, 0xff
    buffer_load_dwordx4 v1, s[40:43], s90 offen lds
    s_mov_b32 exec_hi, -1
    s_mov_b32 m0, s22
    v_mul_f32 v147, 0x43800000, v127
    v_fract_f32 v145, v127
    v_fract_f32 v146, v146
    v_fract_f32 v147, v147
    v_exp_f32 v114, v126
    v_cos_f32 v96, v145
    v_sin_f32 v97, v145
    v_exp_f32 v116, v143
    v_cos_f32 v102, v146
    v_sin_f32 v103, v146
    v_exp_f32 v118, v144
    v_cos_f32 v106, v147
    v_sin_f32 v107, v147
    v_pk_mul_f32 v[108:109], v[130:131], v[128:129] op_sel_hi:[1,0]
    v_pk_fma_f32 v[108:109], v[130:131], v[128:129], v[108:109] op_sel:[1,1,0] op_sel_hi:[0,1,1] neg_lo:[1,0,0]
    v_pk_mul_f32 v[96:97], v[96:97], v[114:115] op_sel_hi:[1,0]
    v_pk_mul_f32 v[102:103], v[102:103], v[116:117] op_sel_hi:[1,0]
    v_pk_mul_f32 v[106:107], v[106:107], v[118:119] op_sel_hi:[1,0]
    v_pk_mul_f32 v[98:99], v[96:97], v[96:97] op_sel_hi:[1,0]
    s_mov_b32 s38, 256
    s_add_u32 m0, s100, 95744
    s_nop 0
    buffer_load_dwordx4 v200, s[40:43], s38 offen lds
    s_mov_b32 m0, s22
    v_pk_fma_f32 v[98:99], v[96:97], v[96:97], v[98:99] op_sel:[1,1,0] op_sel_hi:[0,1,1] neg_lo:[1,0,0]
    v_pk_mul_f32 v[104:105], v[102:103], v[102:103] op_sel_hi:[1,0]
    v_pk_fma_f32 v[104:105], v[102:103], v[102:103], v[104:105] op_sel:[1,1,0] op_sel_hi:[0,1,1] neg_lo:[1,0,0]
    v_pk_mul_f32 v[100:101], v[98:99], v[98:99] op_sel_hi:[1,0]
    v_pk_fma_f32 v[100:101], v[98:99], v[98:99], v[100:101] op_sel:[1,1,0] op_sel_hi:[0,1,1] neg_lo:[1,0,0]
    v_mov_b32 v122, 0x3f80
    v_cvt_pk_bf16_f32 v123, v102, v103
    ds_write_addtid_b32 v122 offset:0
    ds_write_addtid_b32 v123 offset:272
    v_pk_mul_f32 v[120:121], v[102:103], v[104:105] op_sel_hi:[1,0]
    v_pk_fma_f32 v[120:121], v[102:103], v[104:105], v[120:121] op_sel:[1,1,0] op_sel_hi:[0,1,1] neg_lo:[1,0,0]
    v_cvt_pk_bf16_f32 v124, v104, v105
    v_cvt_pk_bf16_f32 v125, v120, v121
    ds_write_addtid_b32 v124 offset:544
    ds_write_addtid_b32 v125 offset:816
    v_pk_mul_f32 v[114:115], v[104:105], v[104:105] op_sel_hi:[1,0]
    v_pk_fma_f32 v[114:115], v[104:105], v[104:105], v[114:115] op_sel:[1,1,0] op_sel_hi:[0,1,1] neg_lo:[1,0,0]
    v_pk_mul_f32 v[118:119], v[120:121], v[104:105] op_sel_hi:[1,0]
    v_pk_fma_f32 v[118:119], v[120:121], v[104:105], v[118:119] op_sel:[1,1,0] op_sel_hi:[0,1,1] neg_lo:[1,0,0]
    v_cvt_pk_bf16_f32 v122, v114, v115
    v_cvt_pk_bf16_f32 v123, v118, v119
    ds_write_addtid_b32 v122 offset:1088
    ds_write_addtid_b32 v123 offset:1360
    v_pk_mul_f32 v[116:117], v[114:115], v[104:105] op_sel_hi:[1,0]
    v_pk_fma_f32 v[116:117], v[114:115], v[104:105], v[116:117] op_sel:[1,1,0] op_sel_hi:[0,1,1] neg_lo:[1,0,0]
    v_pk_mul_f32 v[120:121], v[118:119], v[104:105] op_sel_hi:[1,0]
    v_pk_fma_f32 v[120:121], v[118:119], v[104:105], v[120:121] op_sel:[1,1,0] op_sel_hi:[0,1,1] neg_lo:[1,0,0]
    s_add_u32 m0, s100, 99840
    s_nop 0
    buffer_load_dwordx4 v201, s[40:43], s38 offen lds
    s_mov_b32 m0, s22
    v_cvt_pk_bf16_f32 v124, v116, v117
    v_cvt_pk_bf16_f32 v125, v120, v121
    ds_write_addtid_b32 v124 offset:1632
    ds_write_addtid_b32 v125 offset:1904
    v_pk_mul_f32 v[114:115], v[116:117], v[104:105] op_sel_hi:[1,0]
    v_pk_fma_f32 v[114:115], v[116:117], v[104:105], v[114:115] op_sel:[1,1,0] op_sel_hi:[0,1,1] neg_lo:[1,0,0]
    v_pk_mul_f32 v[118:119], v[120:121], v[104:105] op_sel_hi:[1,0]
    v_pk_fma_f32 v[118:119], v[120:121], v[104:105], v[118:119] op_sel:[1,1,0] op_sel_hi:[0,1,1] neg_lo:[1,0,0]
    v_cvt_pk_bf16_f32 v122, v114, v115
    v_cvt_pk_bf16_f32 v123, v118, v119
    ds_write_addtid_b32 v122 offset:2176
    ds_write_addtid_b32 v123 offset:2448
    v_pk_mul_f32 v[116:117], v[114:115], v[104:105] op_sel_hi:[1,0]
    v_pk_fma_f32 v[116:117], v[114:115], v[104:105], v[116:117] op_sel:[1,1,0] op_sel_hi:[0,1,1] neg_lo:[1,0,0]
    v_pk_mul_f32 v[120:121], v[118:119], v[104:105] op_sel_hi:[1,0]
    v_pk_fma_f32 v[120:121], v[118:119], v[104:105], v[120:121] op_sel:[1,1,0] op_sel_hi:[0,1,1] neg_lo:[1,0,0]
    v_cvt_pk_bf16_f32 v124, v116, v117
    v_cvt_pk_bf16_f32 v125, v120, v121
    ds_write_addtid_b32 v124 offset:2720
    ds_write_addtid_b32 v125 offset:2992
    v_pk_mul_f32 v[114:115], v[116:117], v[104:105] op_sel_hi:[1,0]
    v_pk_fma_f32 v[114:115], v[116:117], v[104:105], v[114:115] op_sel:[1,1,0] op_sel_hi:[0,1,1] neg_lo:[1,0,0]
    v_pk_mul_f32 v[118:119], v[120:121], v[104:105] op_sel_hi:[1,0]
    v_pk_fma_f32 v[118:119], v[120:121], v[104:105], v[118:119] op_sel:[1,1,0] op_sel_hi:[0,1,1] neg_lo:[1,0,0]
    v_cvt_pk_bf16_f32 v122, v114, v115
    v_cvt_pk_bf16_f32 v123, v118, v119
    ds_write_addtid_b32 v122 offset:3264
    ds_write_addtid_b32 v123 offset:3536
    s_add_u32 m0, s100, 103936
    s_nop 0
    buffer_load_dwordx4 v202, s[40:43], s38 offen lds
    s_mov_b32 m0, s22
    v_pk_mul_f32 v[116:117], v[114:115], v[104:105] op_sel_hi:[1,0]
    v_pk_fma_f32 v[116:117], v[114:115], v[104:105], v[116:117] op_sel:[1,1,0] op_sel_hi:[0,1,1] neg_lo:[1,0,0]
    v_pk_mul_f32 v[120:121], v[118:119], v[104:105] op_sel_hi:[1,0]
    v_pk_fma_f32 v[120:121], v[118:119], v[104:105], v[120:121] op_sel:[1,1,0] op_sel_hi:[0,1,1] neg_lo:[1,0,0]
    v_cvt_pk_bf16_f32 v124, v116, v117
    v_cvt_pk_bf16_f32 v125, v120, v121
    ds_write_addtid_b32 v124 offset:3808
    ds_write_addtid_b32 v125 offset:4080
    v_pk_mul_f32 v[114:115], v[116:117], v[104:105] op_sel_hi:[1,0]
    v_pk_fma_f32 v[114:115], v[116:117], v[104:105], v[114:115] op_sel:[1,1,0] op_sel_hi:[0,1,1] neg_lo:[1,0,0]
    v_pk_mul_f32 v[118:119], v[120:121], v[104:105] op_sel_hi:[1,0]
    v_pk_fma_f32 v[118:119], v[120:121], v[104:105], v[118:119] op_sel:[1,1,0] op_sel_hi:[0,1,1] neg_lo:[1,0,0]
    v_cvt_pk_bf16_f32 v122, v114, v115
    v_cvt_pk_bf16_f32 v123, v118, v119
    ds_write_addtid_b32 v122 offset:4352
    ds_write_addtid_b32 v123 offset:4624
    v_pk_mul_f32 v[116:117], v[114:115], v[104:105] op_sel_hi:[1,0]
    v_pk_fma_f32 v[116:117], v[114:115], v[104:105], v[116:117] op_sel:[1,1,0] op_sel_hi:[0,1,1] neg_lo:[1,0,0]
    v_pk_mul_f32 v[120:121], v[118:119], v[104:105] op_sel_hi:[1,0]
    v_pk_fma_f32 v[120:121], v[118:119], v[104:105], v[120:121] op_sel:[1,1,0] op_sel_hi:[0,1,1] neg_lo:[1,0,0]
    v_cvt_pk_bf16_f32 v124, v116, v117
    v_cvt_pk_bf16_f32 v125, v120, v121
    ds_write_addtid_b32 v124 offset:4896
    ds_write_addtid_b32 v125 offset:5168
    v_pk_mul_f32 v[114:115], v[116:117], v[104:105] op_sel_hi:[1,0]
    v_pk_fma_f32 v[114:115], v[116:117], v[104:105], v[114:115] op_sel:[1,1,0] op_sel_hi:[0,1,1] neg_lo:[1,0,0]
    v_pk_mul_f32 v[118:119], v[120:121], v[104:105] op_sel_hi:[1,0]
    s_add_u32 m0, s100, 108032
    s_nop 0
    buffer_load_dwordx4 v203, s[40:43], s38 offen lds
    s_mov_b32 m0, s22
    v_pk_fma_f32 v[118:119], v[120:121], v[104:105], v[118:119] op_sel:[1,1,0] op_sel_hi:[0,1,1] neg_lo:[1,0,0]
    v_cvt_pk_bf16_f32 v122, v114, v115
    v_cvt_pk_bf16_f32 v123, v118, v119
    ds_write_addtid_b32 v122 offset:5440
    ds_write_addtid_b32 v123 offset:5712
    v_pk_mul_f32 v[116:117], v[114:115], v[104:105] op_sel_hi:[1,0]
    v_pk_fma_f32 v[116:117], v[114:115], v[104:105], v[116:117] op_sel:[1,1,0] op_sel_hi:[0,1,1] neg_lo:[1,0,0]
    v_pk_mul_f32 v[120:121], v[118:119], v[104:105] op_sel_hi:[1,0]
    v_pk_fma_f32 v[120:121], v[118:119], v[104:105], v[120:121] op_sel:[1,1,0] op_sel_hi:[0,1,1] neg_lo:[1,0,0]
    v_cvt_pk_bf16_f32 v124, v116, v117
    v_cvt_pk_bf16_f32 v125, v120, v121
    ds_write_addtid_b32 v124 offset:5984
    ds_write_addtid_b32 v125 offset:6256
    v_pk_mul_f32 v[114:115], v[116:117], v[104:105] op_sel_hi:[1,0]
    v_pk_fma_f32 v[114:115], v[116:117], v[104:105], v[114:115] op_sel:[1,1,0] op_sel_hi:[0,1,1] neg_lo:[1,0,0]
    v_pk_mul_f32 v[118:119], v[120:121], v[104:105] op_sel_hi:[1,0]
    v_pk_fma_f32 v[118:119], v[120:121], v[104:105], v[118:119] op_sel:[1,1,0] op_sel_hi:[0,1,1] neg_lo:[1,0,0]
    v_cvt_pk_bf16_f32 v122, v114, v115
    v_cvt_pk_bf16_f32 v123, v118, v119
    ds_write_addtid_b32 v122 offset:6528
    ds_write_addtid_b32 v123 offset:6800
    v_pk_mul_f32 v[116:117], v[114:115], v[104:105] op_sel_hi:[1,0]
    v_pk_fma_f32 v[116:117], v[114:115], v[104:105], v[116:117] op_sel:[1,1,0] op_sel_hi:[0,1,1] neg_lo:[1,0,0]
    v_pk_mul_f32 v[120:121], v[118:119], v[104:105] op_sel_hi:[1,0]
    v_pk_fma_f32 v[120:121], v[118:119], v[104:105], v[120:121] op_sel:[1,1,0] op_sel_hi:[0,1,1] neg_lo:[1,0,0]
    v_cvt_pk_bf16_f32 v124, v116, v117
    v_cvt_pk_bf16_f32 v125, v120, v121
    ds_write_addtid_b32 v124 offset:7072
    s_add_u32 s38, s74, 163840
    s_add_u32 m0, s101, 58880
    s_nop 0
    buffer_load_dwordx4 v204, s[44:47], s38 offen lds
    s_mov_b32 m0, s22
    s_nop 0
    ds_write_addtid_b32 v125 offset:7344
    v_pk_mul_f32 v[114:115], v[116:117], v[104:105] op_sel_hi:[1,0]
    v_pk_fma_f32 v[114:115], v[116:117], v[104:105], v[114:115] op_sel:[1,1,0] op_sel_hi:[0,1,1] neg_lo:[1,0,0]
    v_pk_mul_f32 v[118:119], v[120:121], v[104:105] op_sel_hi:[1,0]
    v_pk_fma_f32 v[118:119], v[120:121], v[104:105], v[118:119] op_sel:[1,1,0] op_sel_hi:[0,1,1] neg_lo:[1,0,0]
    v_cvt_pk_bf16_f32 v122, v114, v115
    v_cvt_pk_bf16_f32 v123, v118, v119
    ds_write_addtid_b32 v122 offset:7616
    ds_write_addtid_b32 v123 offset:7888
    v_pk_mul_f32 v[116:117], v[114:115], v[104:105] op_sel_hi:[1,0]
    v_pk_fma_f32 v[116:117], v[114:115], v[104:105], v[116:117] op_sel:[1,1,0] op_sel_hi:[0,1,1] neg_lo:[1,0,0]
    v_pk_mul_f32 v[120:121], v[118:119], v[104:105] op_sel_hi:[1,0]
    v_pk_fma_f32 v[120:121], v[118:119], v[104:105], v[120:121] op_sel:[1,1,0] op_sel_hi:[0,1,1] neg_lo:[1,0,0]
    v_cvt_pk_bf16_f32 v124, v116, v117
    v_cvt_pk_bf16_f32 v125, v120, v121
    ds_write_addtid_b32 v124 offset:8160
    ds_write_addtid_b32 v125 offset:8432
    ds_read_b128 v[56:59], v140 offset:0
    ds_read_b128 v[60:63], v140 offset:32
    ds_read_b128 v[64:67], v140 offset:64
    ds_read_b128 v[68:71], v140 offset:96
    ds_read_b128 v[72:75], v140 offset:128
    ds_read_b128 v[76:79], v140 offset:160
    ds_read_b128 v[80:83], v140 offset:192
    ds_read_b128 v[84:87], v140 offset:224
    v_pk_mul_f32 v[110:111], v[108:109], v[106:107] op_sel_hi:[1,0]
    v_pk_fma_f32 v[110:111], v[108:109], v[106:107], v[110:111] op_sel:[1,1,0] op_sel_hi:[0,1,1] neg_lo:[1,0,0]
    s_add_u32 m0, s101, 59904
    s_nop 0
    buffer_load_dwordx4 v205, s[44:47], s38 offen lds
    s_mov_b32 m0, s22
    v_cvt_pk_bf16_f32 v122, v108, -v109
    v_cvt_pk_bf16_f32 v124, v110, -v111
    v_pk_mul_f32 v[114:115], v[108:109], v[96:97] op_sel_hi:[1,0]
    v_pk_fma_f32 v[114:115], v[108:109], v[96:97], v[114:115] op_sel:[1,1,0] op_sel_hi:[0,1,1] neg_lo:[1,0,0]
    v_pk_mul_f32 v[118:119], v[110:111], v[98:99] op_sel_hi:[1,0]
    v_pk_fma_f32 v[118:119], v[110:111], v[98:99], v[118:119] op_sel:[1,1,0] op_sel_hi:[0,1,1] neg_lo:[1,0,0]
    v_cvt_pk_bf16_f32 v123, v114, -v115
    v_cvt_pk_bf16_f32 v125, v118, -v119
    ds_write_addtid_b32 v122 offset:0
    ds_write_addtid_b32 v123 offset:272
    ds_write_addtid_b32 v124 offset:1088
    ds_write_addtid_b32 v125 offset:1360
    v_pk_mul_f32 v[116:117], v[114:115], v[96:97] op_sel_hi:[1,0]
    v_pk_fma_f32 v[116:117], v[114:115], v[96:97], v[116:117] op_sel:[1,1,0] op_sel_hi:[0,1,1] neg_lo:[1,0,0]
    v_pk_mul_f32 v[120:121], v[118:119], v[98:99] op_sel_hi:[1,0]
    v_pk_fma_f32 v[120:121], v[118:119], v[98:99], v[120:121] op_sel:[1,1,0] op_sel_hi:[0,1,1] neg_lo:[1,0,0]
    v_cvt_pk_bf16_f32 v122, v116, -v117
    v_cvt_pk_bf16_f32 v124, v120, -v121
    v_pk_mul_f32 v[114:115], v[116:117], v[96:97] op_sel_hi:[1,0]
    v_pk_fma_f32 v[114:115], v[116:117], v[96:97], v[114:115] op_sel:[1,1,0] op_sel_hi:[0,1,1] neg_lo:[1,0,0]
    v_pk_mul_f32 v[118:119], v[120:121], v[98:99] op_sel_hi:[1,0]
    v_pk_fma_f32 v[118:119], v[120:121], v[98:99], v[118:119] op_sel:[1,1,0] op_sel_hi:[0,1,1] neg_lo:[1,0,0]
    v_cvt_pk_bf16_f32 v123, v114, -v115
    v_cvt_pk_bf16_f32 v125, v118, -v119
    ds_write_addtid_b32 v122 offset:544
    ds_write_addtid_b32 v123 offset:816
    ds_write_addtid_b32 v124 offset:1632
    ds_write_addtid_b32 v125 offset:1904
    s_add_u32 m0, s101, 60928
    s_nop 0
    buffer_load_dwordx4 v206, s[44:47], s38 offen lds
    s_mov_b32 m0, s22
    v_pk_mul_f32 v[116:117], v[114:115], v[96:97] op_sel_hi:[1,0]
    v_pk_fma_f32 v[116:117], v[114:115], v[96:97], v[116:117] op_sel:[1,1,0] op_sel_hi:[0,1,1] neg_lo:[1,0,0]
    v_pk_mul_f32 v[120:121], v[118:119], v[98:99] op_sel_hi:[1,0]
    v_pk_fma_f32 v[120:121], v[118:119], v[98:99], v[120:121] op_sel:[1,1,0] op_sel_hi:[0,1,1] neg_lo:[1,0,0]
    v_cvt_pk_bf16_f32 v122, v116, -v117
    v_cvt_pk_bf16_f32 v124, v120, -v121
    ds_write_addtid_b32 v124 offset:3264
    v_pk_mul_f32 v[114:115], v[116:117], v[96:97] op_sel_hi:[1,0]
    v_pk_fma_f32 v[114:115], v[116:117], v[96:97], v[114:115] op_sel:[1,1,0] op_sel_hi:[0,1,1] neg_lo:[1,0,0]
    v_pk_mul_f32 v[112:113], v[110:111], v[106:107] op_sel_hi:[1,0]
    v_pk_fma_f32 v[112:113], v[110:111], v[106:107], v[112:113] op_sel:[1,1,0] op_sel_hi:[0,1,1] neg_lo:[1,0,0]
    v_cvt_pk_bf16_f32 v123, v114, -v115
    ds_write_addtid_b32 v122 offset:2176
    ds_write_addtid_b32 v123 offset:2448
    v_pk_mul_f32 v[116:117], v[114:115], v[96:97] op_sel_hi:[1,0]
    v_pk_fma_f32 v[116:117], v[114:115], v[96:97], v[116:117] op_sel:[1,1,0] op_sel_hi:[0,1,1] neg_lo:[1,0,0]
    v_cvt_pk_bf16_f32 v122, v116, -v117
    v_pk_mul_f32 v[114:115], v[116:117], v[96:97] op_sel_hi:[1,0]
    v_pk_fma_f32 v[114:115], v[116:117], v[96:97], v[114:115] op_sel:[1,1,0] op_sel_hi:[0,1,1] neg_lo:[1,0,0]
    v_cvt_pk_bf16_f32 v123, v114, -v115
    ds_write_addtid_b32 v122 offset:2720
    ds_write_addtid_b32 v123 offset:2992
    v_pk_mul_f32 v[114:115], v[112:113], v[100:101] op_sel_hi:[1,0]
    v_pk_fma_f32 v[114:115], v[112:113], v[100:101], v[114:115] op_sel:[1,1,0] op_sel_hi:[0,1,1] neg_lo:[1,0,0]
    v_pk_mul_f32 v[116:117], v[112:113], v[102:103] op_sel_hi:[1,0]
    v_pk_fma_f32 v[116:117], v[112:113], v[102:103], v[116:117] op_sel:[1,1,0] op_sel_hi:[0,1,1] neg_lo:[1,0,0]
    v_pk_mul_f32 v[110:111], v[112:113], v[106:107] op_sel_hi:[1,0]
    s_add_u32 m0, s101, 61952
    s_nop 0
    buffer_load_dwordx4 v207, s[44:47], s38 offen lds
    s_mov_b32 m0, s22
    v_pk_fma_f32 v[110:111], v[112:113], v[106:107], v[110:111] op_sel:[1,1,0] op_sel_hi:[0,1,1] neg_lo:[1,0,0]
    v_cvt_pk_bf16_f32 v122, v112, -v113
    v_cvt_pk_bf16_f32 v123, v114, -v115
    v_cvt_pk_bf16_f32 v124, v116, -v117
    ds_write_addtid_b32 v122 offset:4352
    ds_write_addtid_b32 v123 offset:4624
    ds_write_addtid_b32 v124 offset:4896
    v_pk_mul_f32 v[114:115], v[110:111], v[100:101] op_sel_hi:[1,0]
    v_pk_fma_f32 v[114:115], v[110:111], v[100:101], v[114:115] op_sel:[1,1,0] op_sel_hi:[0,1,1] neg_lo:[1,0,0]
    v_pk_mul_f32 v[116:117], v[110:111], v[102:103] op_sel_hi:[1,0]
    v_pk_fma_f32 v[116:117], v[110:111], v[102:103], v[116:117] op_sel:[1,1,0] op_sel_hi:[0,1,1] neg_lo:[1,0,0]
    v_pk_mul_f32 v[112:113], v[110:111], v[106:107] op_sel_hi:[1,0]
    v_pk_fma_f32 v[112:113], v[110:111], v[106:107], v[112:113] op_sel:[1,1,0] op_sel_hi:[0,1,1] neg_lo:[1,0,0]
    v_cvt_pk_bf16_f32 v122, v110, -v111
    v_cvt_pk_bf16_f32 v123, v114, -v115
    v_cvt_pk_bf16_f32 v124, v116, -v117
    ds_write_addtid_b32 v122 offset:5440
    ds_write_addtid_b32 v123 offset:5712
    ds_write_addtid_b32 v124 offset:5984
    v_pk_mul_f32 v[114:115], v[112:113], v[102:103] op_sel_hi:[1,0]
    v_pk_fma_f32 v[114:115], v[112:113], v[102:103], v[114:115] op_sel:[1,1,0] op_sel_hi:[0,1,1] neg_lo:[1,0,0]
    v_pk_mul_f32 v[110:111], v[112:113], v[106:107] op_sel_hi:[1,0]
    v_pk_fma_f32 v[110:111], v[112:113], v[106:107], v[110:111] op_sel:[1,1,0] op_sel_hi:[0,1,1] neg_lo:[1,0,0]
    v_cvt_pk_bf16_f32 v122, v112, -v113
    v_cvt_pk_bf16_f32 v123, v114, -v115
    ds_write_addtid_b32 v122 offset:6528
    ds_write_addtid_b32 v123 offset:6800
    v_pk_mul_f32 v[114:115], v[110:111], v[102:103] op_sel_hi:[1,0]
    s_add_u32 m0, s101, 62976
    s_nop 0
    buffer_load_dwordx4 v208, s[44:47], s38 offen lds
    s_mov_b32 m0, s22
    v_pk_fma_f32 v[114:115], v[110:111], v[102:103], v[114:115] op_sel:[1,1,0] op_sel_hi:[0,1,1] neg_lo:[1,0,0]
    v_pk_mul_f32 v[112:113], v[110:111], v[106:107] op_sel_hi:[1,0]
    v_pk_fma_f32 v[112:113], v[110:111], v[106:107], v[112:113] op_sel:[1,1,0] op_sel_hi:[0,1,1] neg_lo:[1,0,0]
    v_cvt_pk_bf16_f32 v124, v110, -v111
    v_cvt_pk_bf16_f32 v125, v114, -v115
    ds_write_addtid_b32 v124 offset:7072
    ds_write_addtid_b32 v125 offset:7344
    v_pk_mul_f32 v[114:115], v[112:113], v[102:103] op_sel_hi:[1,0]
    v_pk_fma_f32 v[114:115], v[112:113], v[102:103], v[114:115] op_sel:[1,1,0] op_sel_hi:[0,1,1] neg_lo:[1,0,0]
    v_pk_mul_f32 v[110:111], v[112:113], v[106:107] op_sel_hi:[1,0]
    v_pk_fma_f32 v[110:111], v[112:113], v[106:107], v[110:111] op_sel:[1,1,0] op_sel_hi:[0,1,1] neg_lo:[1,0,0]
    v_cvt_pk_bf16_f32 v122, v112, -v113
    v_cvt_pk_bf16_f32 v123, v114, -v115
    ds_write_addtid_b32 v122 offset:7616
    ds_write_addtid_b32 v123 offset:7888
    v_pk_mul_f32 v[114:115], v[110:111], v[102:103] op_sel_hi:[1,0]
    v_pk_fma_f32 v[114:115], v[110:111], v[102:103], v[114:115] op_sel:[1,1,0] op_sel_hi:[0,1,1] neg_lo:[1,0,0]
    v_cvt_pk_bf16_f32 v124, v110, -v111
    v_cvt_pk_bf16_f32 v125, v114, -v115
    ds_write_addtid_b32 v124 offset:8160
    ds_write_addtid_b32 v125 offset:8432
    ds_read_b128 v[88:91], v140 offset:0
    ds_read_b128 v[92:95], v140 offset:32
    ds_read_b128 v[96:99], v140 offset:64
    ds_read_b128 v[100:103], v140 offset:96
    s_waitcnt lgkmcnt(3)
    v_mfma_f32_32x32x16_bf16 v[40:55], v[88:91], v[56:59], 0
    s_mov_b64 exec, 0x7f
    global_load_dword v254, v246, s[26:27]
    s_mov_b64 exec, -1
    ds_read_b128 v[88:91], v140 offset:128
    s_waitcnt lgkmcnt(3)
    v_mfma_f32_32x32x16_bf16 v[40:55], v[92:95], v[60:63], v[40:55]
    ds_read_b128 v[92:95], v140 offset:160
    s_waitcnt lgkmcnt(3)
    v_mfma_f32_32x32x16_bf16 v[40:55], v[96:99], v[64:67], v[40:55]
    ds_read_b128 v[96:99], v140 offset:192
    s_mov_b32 s38, 512
    s_add_u32 m0, s100, 112128
    s_nop 0
    buffer_load_dwordx4 v200, s[40:43], s38 offen lds
    s_mov_b32 m0, s22
    s_waitcnt lgkmcnt(3)
    v_mfma_f32_32x32x16_bf16 v[40:55], v[100:103], v[68:71], v[40:55]
    ds_read_b128 v[100:103], v140 offset:224
    s_waitcnt lgkmcnt(3)
    v_mfma_f32_32x32x16_bf16 v[40:55], v[88:91], v[72:75], v[40:55]
    s_waitcnt lgkmcnt(2)
    v_mfma_f32_32x32x16_bf16 v[40:55], v[92:95], v[76:79], v[40:55]
    s_add_u32 m0, s100, 116224
    s_nop 0
    buffer_load_dwordx4 v201, s[40:43], s38 offen lds
    s_mov_b32 m0, s22
    s_waitcnt lgkmcnt(1)
    v_mfma_f32_32x32x16_bf16 v[40:55], v[96:99], v[80:83], v[40:55]
    s_waitcnt lgkmcnt(0)
    v_mfma_f32_32x32x16_bf16 v[40:55], v[100:103], v[84:87], v[40:55]
    s_add_u32 m0, s100, 120320
    s_nop 0
    buffer_load_dwordx4 v202, s[40:43], s38 offen lds
    s_mov_b32 m0, s22
    s_add_u32 m0, s100, 124416
    s_nop 0
    buffer_load_dwordx4 v203, s[40:43], s38 offen lds
    s_mov_b32 m0, s22
    s_lshl_b64 exec, 7, s82
    buffer_load_dword v254, v247, s[52:55], 0 offen
    s_mov_b64 exec, 3
    buffer_load_dword v254, v247, s[56:59], 0 offen
    s_mov_b64 exec, -1
    s_add_u32 s66, s62, s77
    s_cmp_eq_u32 s66, 2
    s_cselect_b32 s66, s62, 0
    s_cmp_eq_u32 s66, 2
    s_cbranch_scc0 L_kp_skip
    s_lshl_b32 s66, s60, 4
    s_add_u32 s66, s66, s61
    s_sub_u32 s66, s66, 16
    s_lshl_b32 s66, s66, 12
    s_add_u32 s66, s66, 786432
    buffer_store_dwordx4 v[40:43], v1, s[52:55], s66 offen offset:0 sc1
    buffer_store_dwordx4 v[44:47], v1, s[52:55], s66 offen offset:1024 sc1
    buffer_store_dwordx4 v[48:51], v1, s[52:55], s66 offen offset:2048 sc1
    buffer_store_dwordx4 v[52:55], v1, s[52:55], s66 offen offset:3072 sc1
L_kp_skip:
    v_mov_b32 v56, 0x3f803f80
    v_mov_b32 v57, 0x3f803f80
    v_mov_b32 v58, 0x3f803f80
    v_mov_b32 v59, 0x3f803f80
    s_waitcnt vmcnt(16)
    s_waitcnt lgkmcnt(0)
    s_barrier
    ds_read_b128 v[140:143], v210 offset:0
    ds_read_b128 v[144:147], v211 offset:0
    ds_read_b128 v[148:151], v212 offset:0
    ds_read_b128 v[152:155], v213 offset:0
    ds_read_b128 v[156:159], v214 offset:0
    s_waitcnt lgkmcnt(4)
    s_add_u32 s38, s74, 327680
    s_add_u32 m0, s101, 17920
    s_nop 0
    buffer_load_dwordx4 v204, s[44:47], s38 offen lds
    v_mfma_f32_16x16x32_bf16 v[160:163], v[56:59], v[140:143], 0
    ds_read_b64_tr_b16 v[100:101], v209 offset:20480
    v_mfma_f32_16x16x32_bf16 v[164:167], v[140:143], v[140:143], 0
    ds_read_b64_tr_b16 v[102:103], v209 offset:21760
    ds_read_b64_tr_b16 v[104:105], v209 offset:20512
    s_waitcnt lgkmcnt(6)
    v_mfma_f32_16x16x32_bf16 v[160:163], v[56:59], v[144:147], v[160:163]
    ds_read_b64_tr_b16 v[106:107], v209 offset:21792
    v_mfma_f32_16x16x32_bf16 v[164:167], v[144:147], v[144:147], v[164:167]
    ds_read_b64_tr_b16 v[108:109], v209 offset:20544
    ds_read_b64_tr_b16 v[110:111], v209 offset:21824
    s_waitcnt lgkmcnt(8)
    v_mfma_f32_16x16x32_bf16 v[160:163], v[56:59], v[148:151], v[160:163]
    s_add_u32 m0, s101, 18944
    s_nop 0
    buffer_load_dwordx4 v205, s[44:47], s38 offen lds
    ds_read_b64_tr_b16 v[112:113], v209 offset:20576
    v_mfma_f32_16x16x32_bf16 v[164:167], v[148:151], v[148:151], v[164:167]
    ds_read_b64_tr_b16 v[114:115], v209 offset:21856
    ds_read_b64_tr_b16 v[116:117], v209 offset:20608
    s_waitcnt lgkmcnt(10)
    v_mfma_f32_16x16x32_bf16 v[160:163], v[56:59], v[152:155], v[160:163]
    ds_read_b64_tr_b16 v[118:119], v209 offset:21888
    v_mfma_f32_16x16x32_bf16 v[164:167], v[152:155], v[152:155], v[164:167]
    s_waitcnt lgkmcnt(10)
    v_mfma_f32_16x16x32_bf16 v[168:171], v[56:59], v[156:159], 0
    v_mfma_f32_16x16x32_bf16 v[172:175], v[156:159], v[156:159], 0
    s_add_u32 m0, s101, 19968
    s_nop 0
    buffer_load_dwordx4 v206, s[44:47], s38 offen lds
    s_waitcnt lgkmcnt(6)
    v_mfma_f32_16x16x32_bf16 v[60:63], v[100:103], v[140:143], 0
    ds_read_b64_tr_b16 v[120:121], v209 offset:25600
    v_mfma_f32_16x16x32_bf16 v[80:83], v[100:103], v[56:59], 0
    ds_read_b64_tr_b16 v[122:123], v209 offset:26880
    v_mfma_f32_16x16x32_bf16 v[64:67], v[104:107], v[140:143], 0
    ds_read_b64_tr_b16 v[124:125], v209 offset:25632
    v_mfma_f32_16x16x32_bf16 v[84:87], v[104:107], v[56:59], 0
    ds_read_b64_tr_b16 v[126:127], v209 offset:26912
    s_waitcnt lgkmcnt(6)
    v_mfma_f32_16x16x32_bf16 v[68:71], v[108:111], v[140:143], 0
    s_add_u32 m0, s101, 20992
    s_nop 0
    buffer_load_dwordx4 v207, s[44:47], s38 offen lds
    ds_read_b64_tr_b16 v[128:129], v209 offset:25664
    ds_read_b64_tr_b16 v[130:131], v209 offset:26944
    v_mfma_f32_16x16x32_bf16 v[88:91], v[108:111], v[56:59], 0
    ds_read_b64_tr_b16 v[132:133], v209 offset:25696
    v_mfma_f32_16x16x32_bf16 v[72:75], v[112:115], v[140:143], 0
    ds_read_b64_tr_b16 v[134:135], v209 offset:26976
    v_mfma_f32_16x16x32_bf16 v[92:95], v[112:115], v[56:59], 0
    ds_read_b64_tr_b16 v[136:137], v209 offset:25728
    s_waitcnt lgkmcnt(9)
    v_mfma_f32_16x16x32_bf16 v[76:79], v[116:119], v[140:143], 0
    ds_read_b64_tr_b16 v[138:139], v209 offset:27008
    v_mfma_f32_16x16x32_bf16 v[96:99], v[116:119], v[56:59], 0
    s_add_u32 m0, s101, 22016
    s_nop 0
    buffer_load_dwordx4 v208, s[44:47], s38 offen lds
    s_waitcnt lgkmcnt(6)
    v_mfma_f32_16x16x32_bf16 v[60:63], v[120:123], v[144:147], v[60:63]
    ds_read_b64_tr_b16 v[100:101], v209 offset:30720
    v_mfma_f32_16x16x32_bf16 v[80:83], v[120:123], v[56:59], v[80:83]
    ds_read_b64_tr_b16 v[102:103], v209 offset:32000
    v_mfma_f32_16x16x32_bf16 v[64:67], v[124:127], v[144:147], v[64:67]
    ds_read_b64_tr_b16 v[104:105], v209 offset:30752
    v_mfma_f32_16x16x32_bf16 v[84:87], v[124:127], v[56:59], v[84:87]
    ds_read_b64_tr_b16 v[106:107], v209 offset:32032
    s_waitcnt lgkmcnt(6)
    v_mfma_f32_16x16x32_bf16 v[68:71], v[128:131], v[144:147], v[68:71]
    s_lshl_b32 s39, s62, 12
    s_add_u32 m0, s39, 0
    s_nop 0
    buffer_load_dwordx4 v221, s[48:51], s97 offen nt lds
    ds_read_b64_tr_b16 v[108:109], v209 offset:30784
    ds_read_b64_tr_b16 v[110:111], v209 offset:32064
    v_mfma_f32_16x16x32_bf16 v[88:91], v[128:131], v[56:59], v[88:91]
    ds_read_b64_tr_b16 v[112:113], v209 offset:30816
    v_mfma_f32_16x16x32_bf16 v[72:75], v[132:135], v[144:147], v[72:75]
    ds_read_b64_tr_b16 v[114:115], v209 offset:32096
    v_mfma_f32_16x16x32_bf16 v[92:95], v[132:135], v[56:59], v[92:95]
    ds_read_b64_tr_b16 v[116:117], v209 offset:30848
    s_waitcnt lgkmcnt(9)
    v_mfma_f32_16x16x32_bf16 v[76:79], v[136:139], v[144:147], v[76:79]
    ds_read_b64_tr_b16 v[118:119], v209 offset:32128
    v_mfma_f32_16x16x32_bf16 v[96:99], v[136:139], v[56:59], v[96:99]
    s_add_u32 m0, s39, 1024
    s_nop 0
    buffer_load_dwordx4 v222, s[48:51], s97 offen nt lds
    s_waitcnt lgkmcnt(6)
    v_mfma_f32_16x16x32_bf16 v[60:63], v[100:103], v[148:151], v[60:63]
    ds_read_b64_tr_b16 v[120:121], v209 offset:35840
    v_mfma_f32_16x16x32_bf16 v[80:83], v[100:103], v[56:59], v[80:83]
    ds_read_b64_tr_b16 v[122:123], v209 offset:37120
    v_mfma_f32_16x16x32_bf16 v[64:67], v[104:107], v[148:151], v[64:67]
    ds_read_b64_tr_b16 v[124:125], v209 offset:35872
    v_mfma_f32_16x16x32_bf16 v[84:87], v[104:107], v[56:59], v[84:87]
    ds_read_b64_tr_b16 v[126:127], v209 offset:37152
    s_waitcnt lgkmcnt(6)
    v_mfma_f32_16x16x32_bf16 v[68:71], v[108:111], v[148:151], v[68:71]
    s_add_u32 m0, s39, 2048
    s_nop 0
    buffer_load_dwordx4 v223, s[48:51], s97 offen nt lds
    ds_read_b64_tr_b16 v[128:129], v209 offset:35904
    ds_read_b64_tr_b16 v[130:131], v209 offset:37184
    v_mfma_f32_16x16x32_bf16 v[88:91], v[108:111], v[56:59], v[88:91]
    ds_read_b64_tr_b16 v[132:133], v209 offset:35936
    v_mfma_f32_16x16x32_bf16 v[72:75], v[112:115], v[148:151], v[72:75]
    ds_read_b64_tr_b16 v[134:135], v209 offset:37216
    v_mfma_f32_16x16x32_bf16 v[92:95], v[112:115], v[56:59], v[92:95]
    ds_read_b64_tr_b16 v[136:137], v209 offset:35968
    s_waitcnt lgkmcnt(9)
    v_mfma_f32_16x16x32_bf16 v[76:79], v[116:119], v[148:151], v[76:79]
    ds_read_b64_tr_b16 v[138:139], v209 offset:37248
    v_mfma_f32_16x16x32_bf16 v[96:99], v[116:119], v[56:59], v[96:99]
    s_add_u32 m0, s39, 3072
    s_nop 0
    buffer_load_dwordx4 v224, s[48:51], s97 offen nt lds
    s_waitcnt lgkmcnt(6)
    v_mfma_f32_16x16x32_bf16 v[60:63], v[120:123], v[152:155], v[60:63]
    v_mfma_f32_16x16x32_bf16 v[80:83], v[120:123], v[56:59], v[80:83]
    v_mfma_f32_16x16x32_bf16 v[64:67], v[124:127], v[152:155], v[64:67]
    v_mfma_f32_16x16x32_bf16 v[84:87], v[124:127], v[56:59], v[84:87]
    s_waitcnt lgkmcnt(2)
    v_mfma_f32_16x16x32_bf16 v[68:71], v[128:131], v[152:155], v[68:71]
    v_mfma_f32_16x16x32_bf16 v[88:91], v[128:131], v[56:59], v[88:91]
    v_mfma_f32_16x16x32_bf16 v[72:75], v[132:135], v[152:155], v[72:75]
    v_mfma_f32_16x16x32_bf16 v[92:95], v[132:135], v[56:59], v[92:95]
    s_waitcnt lgkmcnt(0)
    v_mfma_f32_16x16x32_bf16 v[76:79], v[136:139], v[152:155], v[76:79]
    v_mfma_f32_16x16x32_bf16 v[96:99], v[136:139], v[56:59], v[96:99]
    s_waitcnt vmcnt(16)
    s_waitcnt lgkmcnt(0)
    s_barrier
    ds_read_b128 v[140:143], v210 offset:16384
    ds_read_b128 v[144:147], v211 offset:16384
    ds_read_b128 v[148:151], v212 offset:16384
    ds_read_b128 v[152:155], v213 offset:16384
    ds_read_b128 v[156:159], v214 offset:256
    s_waitcnt lgkmcnt(4)
    s_mov_b32 s38, 768
    s_add_u32 m0, s100, 128512
    s_nop 0
    buffer_load_dwordx4 v200, s[40:43], s38 offen lds
    v_mfma_f32_16x16x32_bf16 v[160:163], v[56:59], v[140:143], v[160:163]
    ds_read_b64_tr_b16 v[100:101], v209 offset:40960
    v_mfma_f32_16x16x32_bf16 v[164:167], v[140:143], v[140:143], v[164:167]
    ds_read_b64_tr_b16 v[102:103], v209 offset:42240
    ds_read_b64_tr_b16 v[104:105], v209 offset:40992
    s_waitcnt lgkmcnt(6)
    v_mfma_f32_16x16x32_bf16 v[160:163], v[56:59], v[144:147], v[160:163]
    ds_read_b64_tr_b16 v[106:107], v209 offset:42272
    v_mfma_f32_16x16x32_bf16 v[164:167], v[144:147], v[144:147], v[164:167]
    s_add_u32 m0, s100, 132608
    s_nop 0
    buffer_load_dwordx4 v201, s[40:43], s38 offen lds
    ds_read_b64_tr_b16 v[108:109], v209 offset:41024
    ds_read_b64_tr_b16 v[110:111], v209 offset:42304
    s_waitcnt lgkmcnt(8)
    v_mfma_f32_16x16x32_bf16 v[160:163], v[56:59], v[148:151], v[160:163]
    ds_read_b64_tr_b16 v[112:113], v209 offset:41056
    v_mfma_f32_16x16x32_bf16 v[164:167], v[148:151], v[148:151], v[164:167]
    ds_read_b64_tr_b16 v[114:115], v209 offset:42336
    ds_read_b64_tr_b16 v[116:117], v209 offset:41088
    s_waitcnt lgkmcnt(10)
    v_mfma_f32_16x16x32_bf16 v[160:163], v[56:59], v[152:155], v[160:163]
    s_add_u32 m0, s100, 136704
    s_nop 0
    buffer_load_dwordx4 v202, s[40:43], s38 offen lds
    ds_read_b64_tr_b16 v[118:119], v209 offset:42368
    v_mfma_f32_16x16x32_bf16 v[164:167], v[152:155], v[152:155], v[164:167]
    s_waitcnt lgkmcnt(10)
    v_mfma_f32_16x16x32_bf16 v[168:171], v[56:59], v[156:159], v[168:171]
    v_mfma_f32_16x16x32_bf16 v[172:175], v[156:159], v[156:159], v[172:175]
    s_waitcnt lgkmcnt(6)
    v_mfma_f32_16x16x32_bf16 v[60:63], v[100:103], v[140:143], v[60:63]
    s_add_u32 m0, s100, 140800
    s_nop 0
    buffer_load_dwordx4 v203, s[40:43], s38 offen lds
    ds_read_b64_tr_b16 v[120:121], v209 offset:46080
    v_mfma_f32_16x16x32_bf16 v[80:83], v[100:103], v[56:59], v[80:83]
    ds_read_b64_tr_b16 v[122:123], v209 offset:47360
    v_mfma_f32_16x16x32_bf16 v[64:67], v[104:107], v[140:143], v[64:67]
    ds_read_b64_tr_b16 v[124:125], v209 offset:46112
    v_mfma_f32_16x16x32_bf16 v[84:87], v[104:107], v[56:59], v[84:87]
    s_add_u32 s38, s74, 491520
    s_add_u32 m0, s101, 38400
    s_nop 0
    buffer_load_dwordx4 v204, s[44:47], s38 offen lds
    ds_read_b64_tr_b16 v[126:127], v209 offset:47392
    s_waitcnt lgkmcnt(6)
    v_mfma_f32_16x16x32_bf16 v[68:71], v[108:111], v[140:143], v[68:71]
    ds_read_b64_tr_b16 v[128:129], v209 offset:46144
    ds_read_b64_tr_b16 v[130:131], v209 offset:47424
    v_mfma_f32_16x16x32_bf16 v[88:91], v[108:111], v[56:59], v[88:91]
    ds_read_b64_tr_b16 v[132:133], v209 offset:46176
    v_mfma_f32_16x16x32_bf16 v[72:75], v[112:115], v[140:143], v[72:75]
    ds_read_b64_tr_b16 v[134:135], v209 offset:47456
    v_mfma_f32_16x16x32_bf16 v[92:95], v[112:115], v[56:59], v[92:95]
    s_add_u32 m0, s101, 39424
    s_nop 0
    buffer_load_dwordx4 v205, s[44:47], s38 offen lds
    ds_read_b64_tr_b16 v[136:137], v209 offset:46208
    s_waitcnt lgkmcnt(9)
    v_mfma_f32_16x16x32_bf16 v[76:79], v[116:119], v[140:143], v[76:79]
    ds_read_b64_tr_b16 v[138:139], v209 offset:47488
    v_mfma_f32_16x16x32_bf16 v[96:99], v[116:119], v[56:59], v[96:99]
    s_waitcnt lgkmcnt(6)
    v_mfma_f32_16x16x32_bf16 v[60:63], v[120:123], v[144:147], v[60:63]
    s_add_u32 m0, s101, 40448
    s_nop 0
    buffer_load_dwordx4 v206, s[44:47], s38 offen lds
    ds_read_b64_tr_b16 v[100:101], v209 offset:51200
    v_mfma_f32_16x16x32_bf16 v[80:83], v[120:123], v[56:59], v[80:83]
    ds_read_b64_tr_b16 v[102:103], v209 offset:52480
    v_mfma_f32_16x16x32_bf16 v[64:67], v[124:127], v[144:147], v[64:67]
    ds_read_b64_tr_b16 v[104:105], v209 offset:51232
    v_mfma_f32_16x16x32_bf16 v[84:87], v[124:127], v[56:59], v[84:87]
    ds_read_b64_tr_b16 v[106:107], v209 offset:52512
    s_waitcnt lgkmcnt(6)
    v_mfma_f32_16x16x32_bf16 v[68:71], v[128:131], v[144:147], v[68:71]
    s_add_u32 m0, s101, 41472
    s_nop 0
    buffer_load_dwordx4 v207, s[44:47], s38 offen lds
    ds_read_b64_tr_b16 v[108:109], v209 offset:51264
    ds_read_b64_tr_b16 v[110:111], v209 offset:52544
    v_mfma_f32_16x16x32_bf16 v[88:91], v[128:131], v[56:59], v[88:91]
    ds_read_b64_tr_b16 v[112:113], v209 offset:51296
    v_mfma_f32_16x16x32_bf16 v[72:75], v[132:135], v[144:147], v[72:75]
    ds_read_b64_tr_b16 v[114:115], v209 offset:52576
    v_mfma_f32_16x16x32_bf16 v[92:95], v[132:135], v[56:59], v[92:95]
    s_add_u32 m0, s101, 42496
    s_nop 0
    buffer_load_dwordx4 v208, s[44:47], s38 offen lds
    ds_read_b64_tr_b16 v[116:117], v209 offset:51328
    s_waitcnt lgkmcnt(9)
    v_mfma_f32_16x16x32_bf16 v[76:79], v[136:139], v[144:147], v[76:79]
    ds_read_b64_tr_b16 v[118:119], v209 offset:52608
    v_mfma_f32_16x16x32_bf16 v[96:99], v[136:139], v[56:59], v[96:99]
    s_waitcnt lgkmcnt(6)
    v_mfma_f32_16x16x32_bf16 v[60:63], v[100:103], v[148:151], v[60:63]
    s_mov_b32 s38, 1024
    s_add_u32 m0, s100, 144896
    s_nop 0
    buffer_load_dwordx4 v200, s[40:43], s38 offen lds
    ds_read_b64_tr_b16 v[120:121], v209 offset:56320
    v_mfma_f32_16x16x32_bf16 v[80:83], v[100:103], v[56:59], v[80:83]
    ds_read_b64_tr_b16 v[122:123], v209 offset:57600
    v_mfma_f32_16x16x32_bf16 v[64:67], v[104:107], v[148:151], v[64:67]
    ds_read_b64_tr_b16 v[124:125], v209 offset:56352
    v_mfma_f32_16x16x32_bf16 v[84:87], v[104:107], v[56:59], v[84:87]
    ds_read_b64_tr_b16 v[126:127], v209 offset:57632
    s_waitcnt lgkmcnt(6)
    v_mfma_f32_16x16x32_bf16 v[68:71], v[108:111], v[148:151], v[68:71]
    s_add_u32 m0, s100, 148992
    s_nop 0
    buffer_load_dwordx4 v201, s[40:43], s38 offen lds
    ds_read_b64_tr_b16 v[128:129], v209 offset:56384
    ds_read_b64_tr_b16 v[130:131], v209 offset:57664
    v_mfma_f32_16x16x32_bf16 v[88:91], v[108:111], v[56:59], v[88:91]
    ds_read_b64_tr_b16 v[132:133], v209 offset:56416
    v_mfma_f32_16x16x32_bf16 v[72:75], v[112:115], v[148:151], v[72:75]
    ds_read_b64_tr_b16 v[134:135], v209 offset:57696
    v_mfma_f32_16x16x32_bf16 v[92:95], v[112:115], v[56:59], v[92:95]
    s_add_u32 m0, s100, 153088
    s_nop 0
    buffer_load_dwordx4 v202, s[40:43], s38 offen lds
    ds_read_b64_tr_b16 v[136:137], v209 offset:56448
    s_waitcnt lgkmcnt(9)
    v_mfma_f32_16x16x32_bf16 v[76:79], v[116:119], v[148:151], v[76:79]
    ds_read_b64_tr_b16 v[138:139], v209 offset:57728
    v_mfma_f32_16x16x32_bf16 v[96:99], v[116:119], v[56:59], v[96:99]
    s_waitcnt lgkmcnt(6)
    v_mfma_f32_16x16x32_bf16 v[60:63], v[120:123], v[152:155], v[60:63]
    v_mfma_f32_16x16x32_bf16 v[80:83], v[120:123], v[56:59], v[80:83]
    s_add_u32 m0, s100, 157184
    s_nop 0
    buffer_load_dwordx4 v203, s[40:43], s38 offen lds
    v_mfma_f32_16x16x32_bf16 v[64:67], v[124:127], v[152:155], v[64:67]
    v_mfma_f32_16x16x32_bf16 v[84:87], v[124:127], v[56:59], v[84:87]
    s_waitcnt lgkmcnt(2)
    v_mfma_f32_16x16x32_bf16 v[68:71], v[128:131], v[152:155], v[68:71]
    v_mfma_f32_16x16x32_bf16 v[88:91], v[128:131], v[56:59], v[88:91]
    v_mfma_f32_16x16x32_bf16 v[72:75], v[132:135], v[152:155], v[72:75]
    v_mfma_f32_16x16x32_bf16 v[92:95], v[132:135], v[56:59], v[92:95]
    s_waitcnt lgkmcnt(0)
    v_mfma_f32_16x16x32_bf16 v[76:79], v[136:139], v[152:155], v[76:79]
    v_mfma_f32_16x16x32_bf16 v[96:99], v[136:139], v[56:59], v[96:99]
    s_waitcnt vmcnt(13)
    ds_read_b64_tr_b16 v[176:177], v226 offset:0
    ds_read_b64_tr_b16 v[178:179], v226 offset:2048
    ds_read_b64_tr_b16 v[180:181], v226 offset:32
    ds_read_b64_tr_b16 v[182:183], v226 offset:2080
    ds_read_b64_tr_b16 v[184:185], v226 offset:64
    ds_read_b64_tr_b16 v[186:187], v226 offset:2112
    ds_read_b64_tr_b16 v[188:189], v226 offset:96
    ds_read_b64_tr_b16 v[190:191], v226 offset:2144
    s_waitcnt lgkmcnt(0)
    s_barrier
    ds_read_b128 v[140:143], v210 offset:32768
    ds_read_b128 v[144:147], v211 offset:32768
    ds_read_b128 v[148:151], v212 offset:32768
    ds_read_b128 v[152:155], v213 offset:32768
    ds_read_b128 v[156:159], v214 offset:512
    s_waitcnt lgkmcnt(4)
    s_add_u32 s38, s74, 655360
    s_add_u32 m0, s101, 58880
    s_nop 0
    buffer_load_dwordx4 v204, s[44:47], s38 offen lds
    v_mfma_f32_16x16x32_bf16 v[160:163], v[56:59], v[140:143], v[160:163]
    ds_read_b64_tr_b16 v[100:101], v209 offset:0
    v_mfma_f32_16x16x32_bf16 v[164:167], v[140:143], v[140:143], v[164:167]
    ds_read_b64_tr_b16 v[102:103], v209 offset:1280
    ds_read_b64_tr_b16 v[104:105], v209 offset:32
    s_waitcnt lgkmcnt(6)
    v_mfma_f32_16x16x32_bf16 v[160:163], v[56:59], v[144:147], v[160:163]
    ds_read_b64_tr_b16 v[106:107], v209 offset:1312
    v_mfma_f32_16x16x32_bf16 v[164:167], v[144:147], v[144:147], v[164:167]
    ds_read_b64_tr_b16 v[108:109], v209 offset:64
    ds_read_b64_tr_b16 v[110:111], v209 offset:1344
    s_waitcnt lgkmcnt(8)
    v_mfma_f32_16x16x32_bf16 v[160:163], v[56:59], v[148:151], v[160:163]
    s_add_u32 m0, s101, 59904
    s_nop 0
    buffer_load_dwordx4 v205, s[44:47], s38 offen lds
    ds_read_b64_tr_b16 v[112:113], v209 offset:96
    v_mfma_f32_16x16x32_bf16 v[164:167], v[148:151], v[148:151], v[164:167]
    ds_read_b64_tr_b16 v[114:115], v209 offset:1376
    ds_read_b64_tr_b16 v[116:117], v209 offset:128
    s_waitcnt lgkmcnt(10)
    v_mfma_f32_16x16x32_bf16 v[160:163], v[56:59], v[152:155], v[160:163]
    ds_read_b64_tr_b16 v[118:119], v209 offset:1408
    v_mfma_f32_16x16x32_bf16 v[164:167], v[152:155], v[152:155], v[164:167]
    s_waitcnt lgkmcnt(10)
    v_mfma_f32_16x16x32_bf16 v[168:171], v[56:59], v[156:159], v[168:171]
    v_mfma_f32_16x16x32_bf16 v[172:175], v[156:159], v[156:159], v[172:175]
    s_add_u32 m0, s101, 60928
    s_nop 0
    buffer_load_dwordx4 v206, s[44:47], s38 offen lds
    s_waitcnt lgkmcnt(6)
    v_mfma_f32_16x16x32_bf16 v[60:63], v[100:103], v[140:143], v[60:63]
    ds_read_b64_tr_b16 v[120:121], v209 offset:5120
    v_mfma_f32_16x16x32_bf16 v[80:83], v[100:103], v[56:59], v[80:83]
    ds_read_b64_tr_b16 v[122:123], v209 offset:6400
    v_mfma_f32_16x16x32_bf16 v[64:67], v[104:107], v[140:143], v[64:67]
    ds_read_b64_tr_b16 v[124:125], v209 offset:5152
    v_mfma_f32_16x16x32_bf16 v[84:87], v[104:107], v[56:59], v[84:87]
    ds_read_b64_tr_b16 v[126:127], v209 offset:6432
    s_waitcnt lgkmcnt(6)
    v_mfma_f32_16x16x32_bf16 v[68:71], v[108:111], v[140:143], v[68:71]
    s_add_u32 m0, s101, 61952
    s_nop 0
    buffer_load_dwordx4 v207, s[44:47], s38 offen lds
    ds_read_b64_tr_b16 v[128:129], v209 offset:5184
    ds_read_b64_tr_b16 v[130:131], v209 offset:6464
    v_mfma_f32_16x16x32_bf16 v[88:91], v[108:111], v[56:59], v[88:91]
    ds_read_b64_tr_b16 v[132:133], v209 offset:5216
    v_mfma_f32_16x16x32_bf16 v[72:75], v[112:115], v[140:143], v[72:75]
    ds_read_b64_tr_b16 v[134:135], v209 offset:6496
    v_mfma_f32_16x16x32_bf16 v[92:95], v[112:115], v[56:59], v[92:95]
    ds_read_b64_tr_b16 v[136:137], v209 offset:5248
    s_waitcnt lgkmcnt(9)
    v_mfma_f32_16x16x32_bf16 v[76:79], v[116:119], v[140:143], v[76:79]
    ds_read_b64_tr_b16 v[138:139], v209 offset:6528
    v_mfma_f32_16x16x32_bf16 v[96:99], v[116:119], v[56:59], v[96:99]
    s_add_u32 m0, s101, 62976
    s_nop 0
    buffer_load_dwordx4 v208, s[44:47], s38 offen lds
    s_waitcnt lgkmcnt(6)
    v_mfma_f32_16x16x32_bf16 v[60:63], v[120:123], v[144:147], v[60:63]
    ds_read_b64_tr_b16 v[100:101], v209 offset:10240
    v_mfma_f32_16x16x32_bf16 v[80:83], v[120:123], v[56:59], v[80:83]
    ds_read_b64_tr_b16 v[102:103], v209 offset:11520
    v_mfma_f32_16x16x32_bf16 v[64:67], v[124:127], v[144:147], v[64:67]
    ds_read_b64_tr_b16 v[104:105], v209 offset:10272
    v_mfma_f32_16x16x32_bf16 v[84:87], v[124:127], v[56:59], v[84:87]
    ds_read_b64_tr_b16 v[106:107], v209 offset:11552
    s_waitcnt lgkmcnt(6)
    v_mfma_f32_16x16x32_bf16 v[68:71], v[128:131], v[144:147], v[68:71]
    buffer_store_dwordx4 v[176:179], v1, s[52:55], s83 offen sc1
    ds_read_b64_tr_b16 v[108:109], v209 offset:10304
    ds_read_b64_tr_b16 v[110:111], v209 offset:11584
    v_mfma_f32_16x16x32_bf16 v[88:91], v[128:131], v[56:59], v[88:91]
    ds_read_b64_tr_b16 v[112:113], v209 offset:10336
    v_mfma_f32_16x16x32_bf16 v[72:75], v[132:135], v[144:147], v[72:75]
    ds_read_b64_tr_b16 v[114:115], v209 offset:11616
    v_mfma_f32_16x16x32_bf16 v[92:95], v[132:135], v[56:59], v[92:95]
    ds_read_b64_tr_b16 v[116:117], v209 offset:10368
    s_waitcnt lgkmcnt(9)
    v_mfma_f32_16x16x32_bf16 v[76:79], v[136:139], v[144:147], v[76:79]
    ds_read_b64_tr_b16 v[118:119], v209 offset:11648
    v_mfma_f32_16x16x32_bf16 v[96:99], v[136:139], v[56:59], v[96:99]
    buffer_store_dwordx4 v[180:183], v1, s[52:55], s84 offen sc1
    s_waitcnt lgkmcnt(6)
    v_mfma_f32_16x16x32_bf16 v[60:63], v[100:103], v[148:151], v[60:63]
    ds_read_b64_tr_b16 v[120:121], v209 offset:15360
    v_mfma_f32_16x16x32_bf16 v[80:83], v[100:103], v[56:59], v[80:83]
    ds_read_b64_tr_b16 v[122:123], v209 offset:16640
    v_mfma_f32_16x16x32_bf16 v[64:67], v[104:107], v[148:151], v[64:67]
    ds_read_b64_tr_b16 v[124:125], v209 offset:15392
    v_mfma_f32_16x16x32_bf16 v[84:87], v[104:107], v[56:59], v[84:87]
    ds_read_b64_tr_b16 v[126:127], v209 offset:16672
    s_waitcnt lgkmcnt(6)
    v_mfma_f32_16x16x32_bf16 v[68:71], v[108:111], v[148:151], v[68:71]
    buffer_store_dwordx4 v[184:187], v1, s[52:55], s85 offen sc1
    ds_read_b64_tr_b16 v[128:129], v209 offset:15424
    ds_read_b64_tr_b16 v[130:131], v209 offset:16704
    v_mfma_f32_16x16x32_bf16 v[88:91], v[108:111], v[56:59], v[88:91]
    ds_read_b64_tr_b16 v[132:133], v209 offset:15456
    v_mfma_f32_16x16x32_bf16 v[72:75], v[112:115], v[148:151], v[72:75]
    ds_read_b64_tr_b16 v[134:135], v209 offset:16736
    v_mfma_f32_16x16x32_bf16 v[92:95], v[112:115], v[56:59], v[92:95]
    ds_read_b64_tr_b16 v[136:137], v209 offset:15488
    s_waitcnt lgkmcnt(9)
    v_mfma_f32_16x16x32_bf16 v[76:79], v[116:119], v[148:151], v[76:79]
    ds_read_b64_tr_b16 v[138:139], v209 offset:16768
    v_mfma_f32_16x16x32_bf16 v[96:99], v[116:119], v[56:59], v[96:99]
    buffer_store_dwordx4 v[188:191], v1, s[52:55], s86 offen sc1
    s_waitcnt lgkmcnt(6)
    v_mfma_f32_16x16x32_bf16 v[60:63], v[120:123], v[152:155], v[60:63]
    v_mfma_f32_16x16x32_bf16 v[80:83], v[120:123], v[56:59], v[80:83]
    v_mfma_f32_16x16x32_bf16 v[64:67], v[124:127], v[152:155], v[64:67]
    v_mfma_f32_16x16x32_bf16 v[84:87], v[124:127], v[56:59], v[84:87]
    s_waitcnt lgkmcnt(2)
    v_mfma_f32_16x16x32_bf16 v[68:71], v[128:131], v[152:155], v[68:71]
    v_mfma_f32_16x16x32_bf16 v[88:91], v[128:131], v[56:59], v[88:91]
    v_mfma_f32_16x16x32_bf16 v[72:75], v[132:135], v[152:155], v[72:75]
    v_mfma_f32_16x16x32_bf16 v[92:95], v[132:135], v[56:59], v[92:95]
    s_waitcnt lgkmcnt(0)
    v_mfma_f32_16x16x32_bf16 v[76:79], v[136:139], v[152:155], v[76:79]
    v_mfma_f32_16x16x32_bf16 v[96:99], v[136:139], v[56:59], v[96:99]
    s_waitcnt vmcnt(9)
    s_waitcnt lgkmcnt(0)
    s_barrier
    ds_read_b128 v[140:143], v210 offset:49152
    ds_read_b128 v[144:147], v211 offset:49152
    ds_read_b128 v[148:151], v212 offset:49152
    ds_read_b128 v[152:155], v213 offset:49152
    ds_read_b128 v[156:159], v214 offset:768
    s_waitcnt lgkmcnt(4)
    s_mov_b32 s44, s26
    s_and_b32 s45, s27, 0xffff
    s_mov_b32 s46, 0xc8000
    s_mov_b32 s47, 0x20000
    s_mul_i32 s74, s62, 204800
    s_mul_i32 s39, s60, 160
    s_add_u32 s74, s74, s39
    s_add_u32 s38, s74, 40960
    s_add_u32 m0, s101, 17920
    s_nop 0
    buffer_load_dwordx4 v248, s[44:47], s38 offen lds
    v_mfma_f32_16x16x32_bf16 v[160:163], v[56:59], v[140:143], v[160:163]
    ds_read_b64_tr_b16 v[100:101], v209 offset:20480
    v_mfma_f32_16x16x32_bf16 v[164:167], v[140:143], v[140:143], v[164:167]
    ds_read_b64_tr_b16 v[102:103], v209 offset:21760
    ds_read_b64_tr_b16 v[104:105], v209 offset:20512
    s_waitcnt lgkmcnt(6)
    v_mfma_f32_16x16x32_bf16 v[160:163], v[56:59], v[144:147], v[160:163]
    ds_read_b64_tr_b16 v[106:107], v209 offset:21792
    v_mfma_f32_16x16x32_bf16 v[164:167], v[144:147], v[144:147], v[164:167]
    ds_read_b64_tr_b16 v[108:109], v209 offset:20544
    ds_read_b64_tr_b16 v[110:111], v209 offset:21824
    s_waitcnt lgkmcnt(8)
    v_mfma_f32_16x16x32_bf16 v[160:163], v[56:59], v[148:151], v[160:163]
    ds_read_b64_tr_b16 v[112:113], v209 offset:20576
    v_mfma_f32_16x16x32_bf16 v[164:167], v[148:151], v[148:151], v[164:167]
    ds_read_b64_tr_b16 v[114:115], v209 offset:21856
    ds_read_b64_tr_b16 v[116:117], v209 offset:20608
    s_waitcnt lgkmcnt(10)
    v_mfma_f32_16x16x32_bf16 v[160:163], v[56:59], v[152:155], v[160:163]
    ds_read_b64_tr_b16 v[118:119], v209 offset:21888
    v_mfma_f32_16x16x32_bf16 v[164:167], v[152:155], v[152:155], v[164:167]
    s_waitcnt lgkmcnt(10)
    v_mfma_f32_16x16x32_bf16 v[168:171], v[56:59], v[156:159], v[168:171]
    s_add_u32 m0, s101, 18944
    s_nop 0
    buffer_load_dwordx4 v249, s[44:47], s38 offen lds
    v_mfma_f32_16x16x32_bf16 v[172:175], v[156:159], v[156:159], v[172:175]
    s_waitcnt lgkmcnt(6)
    v_mfma_f32_16x16x32_bf16 v[60:63], v[100:103], v[140:143], v[60:63]
    ds_read_b64_tr_b16 v[120:121], v209 offset:25600
    v_mfma_f32_16x16x32_bf16 v[80:83], v[100:103], v[56:59], v[80:83]
    ds_read_b64_tr_b16 v[122:123], v209 offset:26880
    v_mfma_f32_16x16x32_bf16 v[64:67], v[104:107], v[140:143], v[64:67]
    ds_read_b64_tr_b16 v[124:125], v209 offset:25632
    v_mfma_f32_16x16x32_bf16 v[84:87], v[104:107], v[56:59], v[84:87]
    ds_read_b64_tr_b16 v[126:127], v209 offset:26912
    s_waitcnt lgkmcnt(6)
    v_mfma_f32_16x16x32_bf16 v[68:71], v[108:111], v[140:143], v[68:71]
    v_mov_b32 v240, 0
    ds_read_b64_tr_b16 v[128:129], v209 offset:25664
    ds_read_b64_tr_b16 v[130:131], v209 offset:26944
    v_mfma_f32_16x16x32_bf16 v[88:91], v[108:111], v[56:59], v[88:91]
    ds_read_b64_tr_b16 v[132:133], v209 offset:25696
    v_mfma_f32_16x16x32_bf16 v[72:75], v[112:115], v[140:143], v[72:75]
    v_mov_b32 v241, 0
    ds_read_b64_tr_b16 v[134:135], v209 offset:26976
    v_mfma_f32_16x16x32_bf16 v[92:95], v[112:115], v[56:59], v[92:95]
    s_add_u32 m0, s101, 19968
    s_nop 0
    buffer_load_dwordx4 v250, s[44:47], s38 offen lds
    ds_read_b64_tr_b16 v[136:137], v209 offset:25728
    s_waitcnt lgkmcnt(9)
    v_mfma_f32_16x16x32_bf16 v[76:79], v[116:119], v[140:143], v[76:79]
    v_mov_b32 v242, 0
    ds_read_b64_tr_b16 v[138:139], v209 offset:27008
    v_mfma_f32_16x16x32_bf16 v[96:99], v[116:119], v[56:59], v[96:99]
    v_mov_b32 v243, 0
    s_waitcnt lgkmcnt(6)
    v_mfma_f32_16x16x32_bf16 v[60:63], v[120:123], v[144:147], v[60:63]
    ds_read_b64_tr_b16 v[100:101], v209 offset:30720
    v_mfma_f32_16x16x32_bf16 v[80:83], v[120:123], v[56:59], v[80:83]
    ds_read_b64_tr_b16 v[102:103], v209 offset:32000
    v_mfma_f32_16x16x32_bf16 v[64:67], v[124:127], v[144:147], v[64:67]
    ds_read_b64_tr_b16 v[104:105], v209 offset:30752
    v_mfma_f32_16x16x32_bf16 v[84:87], v[124:127], v[56:59], v[84:87]
    s_mov_b64 exec, 0xffff
    ds_write_b128 v198, v[240:243]
    ds_write_b128 v198, v[240:243] offset:16
    s_mov_b64 exec, -1
    ds_read_b64_tr_b16 v[106:107], v209 offset:32032
    s_waitcnt lgkmcnt(8)
    v_mfma_f32_16x16x32_bf16 v[68:71], v[128:131], v[144:147], v[68:71]
    ds_read_b64_tr_b16 v[108:109], v209 offset:30784
    ds_read_b64_tr_b16 v[110:111], v209 offset:32064
    v_mfma_f32_16x16x32_bf16 v[88:91], v[128:131], v[56:59], v[88:91]
    ds_read_b64_tr_b16 v[112:113], v209 offset:30816
    v_mfma_f32_16x16x32_bf16 v[72:75], v[132:135], v[144:147], v[72:75]
    s_add_u32 m0, s101, 20992
    s_nop 0
    buffer_load_dwordx4 v251, s[44:47], s38 offen lds
    ds_read_b64_tr_b16 v[114:115], v209 offset:32096
    v_mfma_f32_16x16x32_bf16 v[92:95], v[132:135], v[56:59], v[92:95]
    s_lshl_b32 s66, s61, 2
    ds_read_b64_tr_b16 v[116:117], v209 offset:30848
    s_waitcnt lgkmcnt(11)
    v_mfma_f32_16x16x32_bf16 v[76:79], v[136:139], v[144:147], v[76:79]
    ds_read_b64_tr_b16 v[118:119], v209 offset:32128
    v_mfma_f32_16x16x32_bf16 v[96:99], v[136:139], v[56:59], v[96:99]
    s_add_u32 s66, s66, s62
    s_waitcnt lgkmcnt(6)
    v_mfma_f32_16x16x32_bf16 v[60:63], v[100:103], v[148:151], v[60:63]
    ds_read_b64_tr_b16 v[120:121], v209 offset:35840
    v_mfma_f32_16x16x32_bf16 v[80:83], v[100:103], v[56:59], v[80:83]
    s_mul_i32 s66, s66, 20
    ds_read_b64_tr_b16 v[122:123], v209 offset:37120
    v_mfma_f32_16x16x32_bf16 v[64:67], v[104:107], v[148:151], v[64:67]
    s_lshr_b32 s67, s60, 1
    ds_read_b64_tr_b16 v[124:125], v209 offset:35872
    v_mfma_f32_16x16x32_bf16 v[84:87], v[104:107], v[56:59], v[84:87]
    ds_read_b64_tr_b16 v[126:127], v209 offset:37152
    s_waitcnt lgkmcnt(6)
    v_mfma_f32_16x16x32_bf16 v[68:71], v[108:111], v[148:151], v[68:71]
    s_mul_i32 s67, s67, 5
    ds_read_b64_tr_b16 v[128:129], v209 offset:35904
    ds_read_b64_tr_b16 v[130:131], v209 offset:37184
    v_mfma_f32_16x16x32_bf16 v[88:91], v[108:111], v[56:59], v[88:91]
    s_add_u32 m0, s101, 22016
    s_nop 0
    buffer_load_dwordx4 v252, s[44:47], s38 offen lds
    ds_read_b64_tr_b16 v[132:133], v209 offset:35936
    v_mfma_f32_16x16x32_bf16 v[72:75], v[112:115], v[148:151], v[72:75]
    s_add_u32 s66, s66, s67
    ds_read_b64_tr_b16 v[134:135], v209 offset:37216
    v_mfma_f32_16x16x32_bf16 v[92:95], v[112:115], v[56:59], v[92:95]
    s_lshl_b32 s66, s66, 10
    ds_read_b64_tr_b16 v[136:137], v209 offset:35968
    s_waitcnt lgkmcnt(9)
    v_mfma_f32_16x16x32_bf16 v[76:79], v[116:119], v[148:151], v[76:79]
    ds_read_b64_tr_b16 v[138:139], v209 offset:37248
    v_mfma_f32_16x16x32_bf16 v[96:99], v[116:119], v[56:59], v[96:99]
    s_add_u32 s66, s66, 5242880
    s_waitcnt lgkmcnt(6)
    v_mfma_f32_16x16x32_bf16 v[60:63], v[120:123], v[152:155], v[60:63]
    s_and_b32 s69, s60, 1
    v_mfma_f32_16x16x32_bf16 v[80:83], v[120:123], v[56:59], v[80:83]
    v_mfma_f32_16x16x32_bf16 v[64:67], v[124:127], v[152:155], v[64:67]
    s_lshl_b32 s67, s69, 11
    v_mfma_f32_16x16x32_bf16 v[84:87], v[124:127], v[56:59], v[84:87]
    s_waitcnt lgkmcnt(2)
    v_mfma_f32_16x16x32_bf16 v[68:71], v[128:131], v[152:155], v[68:71]
    s_add_u32 s67, s67, s66
    v_mfma_f32_16x16x32_bf16 v[88:91], v[128:131], v[56:59], v[88:91]
    s_lshl_b32 s68, s69, 9
    v_mfma_f32_16x16x32_bf16 v[72:75], v[132:135], v[152:155], v[72:75]
    v_mfma_f32_16x16x32_bf16 v[92:95], v[132:135], v[56:59], v[92:95]
    s_add_u32 s68, s68, s66
    s_waitcnt lgkmcnt(0)
    v_mfma_f32_16x16x32_bf16 v[76:79], v[136:139], v[152:155], v[76:79]
    v_mfma_f32_16x16x32_bf16 v[96:99], v[136:139], v[56:59], v[96:99]
    s_add_u32 s68, s68, 4096
    ds_read_b64 v[4:5], v215
    ds_read_b64 v[6:7], v216
    ds_read_b64 v[8:9], v217
    ds_read_b64 v[10:11], v218
    ds_read_b64 v[12:13], v219
    s_waitcnt vmcnt(5)
    s_waitcnt lgkmcnt(0)
    s_barrier
    s_cmp_eq_u32 s62, 3
    s_cbranch_scc0 L_g1_skip
    s_lshl_b32 s70, s60, 5
    s_add_u32 s70, s70, s61
    s_lshl_b32 s70, s70, 7
    s_add_u32 s70, s70, 4096
    s_mov_b64 exec, 65535
    buffer_store_dwordx2 v[38:39], v36, s[52:55], s70 offen sc1
    s_mov_b64 exec, -1
L_g1_skip:
    v_add_u32 v210, 16384, v210
    v_add_u32 v211, 16384, v211
    v_add_u32 v212, 16384, v212
    v_add_u32 v213, 16384, v213
    ds_read_b128 v[140:143], v210 offset:49152
    ds_read_b128 v[144:147], v211 offset:49152
    ds_read_b128 v[148:151], v212 offset:49152
    ds_read_b128 v[152:155], v213 offset:49152
    ds_read_b128 v[156:159], v214 offset:1024
    s_waitcnt lgkmcnt(4)
    s_add_u32 s38, s74, 0
    s_add_u32 m0, s101, 99840
    s_nop 0
    buffer_load_dwordx4 v248, s[44:47], s38 offen lds
    v_mfma_f32_16x16x32_bf16 v[160:163], v[56:59], v[140:143], v[160:163]
    ds_read_b64_tr_b16 v[100:101], v209 offset:40960
    v_mfma_f32_16x16x32_bf16 v[164:167], v[140:143], v[140:143], v[164:167]
    ds_read_b64_tr_b16 v[102:103], v209 offset:42240
    ds_read_b64_tr_b16 v[104:105], v209 offset:40992
    s_waitcnt lgkmcnt(6)
    v_mfma_f32_16x16x32_bf16 v[160:163], v[56:59], v[144:147], v[160:163]
    ds_read_b64_tr_b16 v[106:107], v209 offset:42272
    v_mfma_f32_16x16x32_bf16 v[164:167], v[144:147], v[144:147], v[164:167]
    ds_read_b64_tr_b16 v[108:109], v209 offset:41024
    ds_read_b64_tr_b16 v[110:111], v209 offset:42304
    s_waitcnt lgkmcnt(8)
    v_mfma_f32_16x16x32_bf16 v[160:163], v[56:59], v[148:151], v[160:163]
    ds_read_b64_tr_b16 v[112:113], v209 offset:41056
    v_mfma_f32_16x16x32_bf16 v[164:167], v[148:151], v[148:151], v[164:167]
    ds_read_b64_tr_b16 v[114:115], v209 offset:42336
    ds_read_b64_tr_b16 v[116:117], v209 offset:41088
    s_waitcnt lgkmcnt(10)
    v_mfma_f32_16x16x32_bf16 v[160:163], v[56:59], v[152:155], v[160:163]
    ds_read_b64_tr_b16 v[118:119], v209 offset:42368
    v_mfma_f32_16x16x32_bf16 v[164:167], v[152:155], v[152:155], v[164:167]
    s_waitcnt lgkmcnt(10)
    v_mfma_f32_16x16x32_bf16 v[168:171], v[56:59], v[156:159], v[168:171]
    s_add_u32 m0, s101, 100864
    s_nop 0
    buffer_load_dwordx4 v249, s[44:47], s38 offen lds
    v_mfma_f32_16x16x32_bf16 v[172:175], v[156:159], v[156:159], v[172:175]
    s_waitcnt lgkmcnt(6)
    v_mfma_f32_16x16x32_bf16 v[60:63], v[100:103], v[140:143], v[60:63]
    ds_read_b64_tr_b16 v[120:121], v209 offset:46080
    v_mfma_f32_16x16x32_bf16 v[80:83], v[100:103], v[56:59], v[80:83]
    ds_read_b64_tr_b16 v[122:123], v209 offset:47360
    v_mfma_f32_16x16x32_bf16 v[64:67], v[104:107], v[140:143], v[64:67]
    v_cndmask_b32 v164, v164, v165, s[14:15]
    ds_read_b64_tr_b16 v[124:125], v209 offset:46112
    v_mfma_f32_16x16x32_bf16 v[84:87], v[104:107], v[56:59], v[84:87]
    v_cndmask_b32 v169, v172, v173, s[14:15]
    v_cndmask_b32 v164, v164, v166, s[16:17]
    ds_read_b64_tr_b16 v[126:127], v209 offset:47392
    s_waitcnt lgkmcnt(6)
    v_mfma_f32_16x16x32_bf16 v[68:71], v[108:111], v[140:143], v[68:71]
    v_cndmask_b32 v164, v164, v167, s[18:19]
    ds_read_b64_tr_b16 v[128:129], v209 offset:46144
    ds_read_b64_tr_b16 v[130:131], v209 offset:47424
    v_mfma_f32_16x16x32_bf16 v[88:91], v[108:111], v[56:59], v[88:91]
    v_cndmask_b32 v161, 0, v164, s[20:21]
    ds_read_b64_tr_b16 v[132:133], v209 offset:46176
    v_mfma_f32_16x16x32_bf16 v[72:75], v[112:115], v[140:143], v[72:75]
    v_mov_b32 v228, v161
    s_nop 1
    v_permlane16_swap_b32 v161, v228
    ds_read_b64_tr_b16 v[134:135], v209 offset:47456
    v_mfma_f32_16x16x32_bf16 v[92:95], v[112:115], v[56:59], v[92:95]
    s_add_u32 m0, s101, 101888
    s_nop 0
    buffer_load_dwordx4 v250, s[44:47], s38 offen lds
    v_add_f32 v161, v161, v228
    ds_read_b64_tr_b16 v[136:137], v209 offset:46208
    s_waitcnt lgkmcnt(9)
    v_mfma_f32_16x16x32_bf16 v[76:79], v[116:119], v[140:143], v[76:79]
    v_mov_b32 v228, v161
    s_nop 1
    v_permlane32_swap_b32 v161, v228
    ds_read_b64_tr_b16 v[138:139], v209 offset:47488
    v_mfma_f32_16x16x32_bf16 v[96:99], v[116:119], v[56:59], v[96:99]
    v_add_f32 v161, v161, v228
    s_waitcnt lgkmcnt(6)
    v_mfma_f32_16x16x32_bf16 v[60:63], v[120:123], v[144:147], v[60:63]
    ds_read_b64_tr_b16 v[100:101], v209 offset:51200
    v_mfma_f32_16x16x32_bf16 v[80:83], v[120:123], v[56:59], v[80:83]
    s_mov_b64 exec, 0xffff
    ds_write_b64 v198, v[160:161]
    s_mov_b64 exec, 3
    ds_write_b64 v199, v[168:169]
    s_mov_b64 exec, -1
    ds_read_b64_tr_b16 v[102:103], v209 offset:52480
    v_mfma_f32_16x16x32_bf16 v[64:67], v[124:127], v[144:147], v[64:67]
    ds_read_b64_tr_b16 v[104:105], v209 offset:51232
    v_mfma_f32_16x16x32_bf16 v[84:87], v[124:127], v[56:59], v[84:87]
    ds_read_b64_tr_b16 v[106:107], v209 offset:52512
    s_waitcnt lgkmcnt(8)
    v_mfma_f32_16x16x32_bf16 v[68:71], v[128:131], v[144:147], v[68:71]
    v_mul_f32 v230, 0x3acccccd, v160
    v_mul_f32 v232, 0x3acccccd, v161
    ds_read_b64_tr_b16 v[108:109], v209 offset:51264
    ds_read_b64_tr_b16 v[110:111], v209 offset:52544
    v_mfma_f32_16x16x32_bf16 v[88:91], v[128:131], v[56:59], v[88:91]
    v_fma_f32 v232, -v230, v230, v232
    ds_read_b64_tr_b16 v[112:113], v209 offset:51296
    v_mfma_f32_16x16x32_bf16 v[72:75], v[132:135], v[144:147], v[72:75]
    s_add_u32 m0, s101, 102912
    s_nop 0
    buffer_load_dwordx4 v251, s[44:47], s38 offen lds
    v_max_f32 v232, 0, v232
    ds_read_b64_tr_b16 v[114:115], v209 offset:52576
    v_mfma_f32_16x16x32_bf16 v[92:95], v[132:135], v[56:59], v[92:95]
    v_cvt_pk_bf16_f32 v228, v232, v232
    v_and_b32 v228, 0xffff0000, v228
    ds_read_b64_tr_b16 v[116:117], v209 offset:51328
    s_waitcnt lgkmcnt(11)
    v_mfma_f32_16x16x32_bf16 v[76:79], v[136:139], v[144:147], v[76:79]
    v_add_f32 v228, 0x3727c5ac, v228
    ds_read_b64_tr_b16 v[118:119], v209 offset:52608
    v_mfma_f32_16x16x32_bf16 v[96:99], v[136:139], v[56:59], v[96:99]
    v_cvt_pk_bf16_f32 v228, v228, v228
    v_and_b32 v228, 0xffff0000, v228
    s_waitcnt lgkmcnt(6)
    v_mfma_f32_16x16x32_bf16 v[60:63], v[100:103], v[148:151], v[60:63]
    ds_read_b64_tr_b16 v[120:121], v209 offset:56320
    v_mfma_f32_16x16x32_bf16 v[80:83], v[100:103], v[56:59], v[80:83]
    v_sqrt_f32 v228, v228
    ds_read_b64_tr_b16 v[122:123], v209 offset:57600
    v_mfma_f32_16x16x32_bf16 v[64:67], v[104:107], v[148:151], v[64:67]
    v_cvt_pk_bf16_f32 v233, v228, v228
    v_and_b32 v233, 0xffff0000, v233
    ds_read_b64_tr_b16 v[124:125], v209 offset:56352
    v_mfma_f32_16x16x32_bf16 v[84:87], v[104:107], v[56:59], v[84:87]
    ds_read_b64_tr_b16 v[126:127], v209 offset:57632
    s_waitcnt lgkmcnt(6)
    v_mfma_f32_16x16x32_bf16 v[68:71], v[108:111], v[148:151], v[68:71]
    v_rcp_f32 v234, v233
    ds_read_b64_tr_b16 v[128:129], v209 offset:56384
    ds_read_b64_tr_b16 v[130:131], v209 offset:57664
    v_mfma_f32_16x16x32_bf16 v[88:91], v[108:111], v[56:59], v[88:91]
    s_add_u32 m0, s101, 103936
    s_nop 0
    buffer_load_dwordx4 v252, s[44:47], s38 offen lds
    v_mul_f32 v232, v232, v234
    v_mul_f32 v232, v232, v234
    ds_read_b64_tr_b16 v[132:133], v209 offset:56416
    v_mfma_f32_16x16x32_bf16 v[72:75], v[112:115], v[148:151], v[72:75]
    v_cvt_pk_bf16_f32 v228, v232, v232
    ds_read_b64_tr_b16 v[134:135], v209 offset:57696
    v_mfma_f32_16x16x32_bf16 v[92:95], v[112:115], v[56:59], v[92:95]
    v_and_b32 v228, 0xffff0000, v228
    ds_read_b64_tr_b16 v[136:137], v209 offset:56448
    s_waitcnt lgkmcnt(9)
    v_mfma_f32_16x16x32_bf16 v[76:79], v[116:119], v[148:151], v[76:79]
    v_add_f32 v228, 0x3727c5ac, v228
    v_cvt_pk_bf16_f32 v228, v228, v228
    ds_read_b64_tr_b16 v[138:139], v209 offset:57728
    v_mfma_f32_16x16x32_bf16 v[96:99], v[116:119], v[56:59], v[96:99]
    v_and_b32 v228, 0xffff0000, v228
    s_waitcnt lgkmcnt(6)
    v_mfma_f32_16x16x32_bf16 v[60:63], v[120:123], v[152:155], v[60:63]
    v_sqrt_f32 v228, v228
    v_mfma_f32_16x16x32_bf16 v[80:83], v[120:123], v[56:59], v[80:83]
    v_cvt_pk_bf16_f32 v238, v228, v228
    v_mfma_f32_16x16x32_bf16 v[64:67], v[124:127], v[152:155], v[64:67]
    v_and_b32 v238, 0xffff0000, v238
    v_mfma_f32_16x16x32_bf16 v[84:87], v[124:127], v[56:59], v[84:87]
    v_mul_f32 v238, v238, v233
    s_waitcnt lgkmcnt(2)
    v_mfma_f32_16x16x32_bf16 v[68:71], v[128:131], v[152:155], v[68:71]
    v_rcp_f32 v234, v238
    v_mfma_f32_16x16x32_bf16 v[88:91], v[128:131], v[56:59], v[88:91]
    v_mul_f32 v228, v234, v234
    v_mfma_f32_16x16x32_bf16 v[72:75], v[132:135], v[152:155], v[72:75]
    v_mul_f32 v237, 0xc0135761, v234
    v_mul_f32 v228, 0x3d372713, v228
    v_mfma_f32_16x16x32_bf16 v[92:95], v[132:135], v[56:59], v[92:95]
    v_mul_f32 v236, v228, v237
    s_waitcnt lgkmcnt(0)
    v_mfma_f32_16x16x32_bf16 v[76:79], v[136:139], v[152:155], v[76:79]
    v_mfma_f32_16x16x32_bf16 v[96:99], v[136:139], v[56:59], v[96:99]
    v_pk_fma_f32 v[60:61], v[80:81], v[230:231], v[60:61] op_sel_hi:[1,0,1] neg_lo:[0,1,0] neg_hi:[0,1,0]
    v_pk_fma_f32 v[62:63], v[82:83], v[230:231], v[62:63] op_sel_hi:[1,0,1] neg_lo:[0,1,0] neg_hi:[0,1,0]
    v_pk_fma_f32 v[64:65], v[84:85], v[230:231], v[64:65] op_sel_hi:[1,0,1] neg_lo:[0,1,0] neg_hi:[0,1,0]
    v_pk_fma_f32 v[66:67], v[86:87], v[230:231], v[66:67] op_sel_hi:[1,0,1] neg_lo:[0,1,0] neg_hi:[0,1,0]
    v_pk_mul_f32 v[240:241], v[60:61], v[60:61]
    v_pk_mul_f32 v[242:243], v[62:63], v[62:63]
    v_pk_mul_f32 v[244:245], v[64:65], v[64:65]
    v_pk_mul_f32 v[246:247], v[66:67], v[66:67]
    v_pk_fma_f32 v[240:241], v[240:241], v[236:237], v[236:237] op_sel:[0,0,1] op_sel_hi:[1,0,1]
    v_pk_fma_f32 v[242:243], v[242:243], v[236:237], v[236:237] op_sel:[0,0,1] op_sel_hi:[1,0,1]
    v_pk_fma_f32 v[244:245], v[244:245], v[236:237], v[236:237] op_sel:[0,0,1] op_sel_hi:[1,0,1]
    v_pk_fma_f32 v[246:247], v[246:247], v[236:237], v[236:237] op_sel:[0,0,1] op_sel_hi:[1,0,1]
    v_pk_mul_f32 v[240:241], v[240:241], v[60:61]
    v_pk_mul_f32 v[242:243], v[242:243], v[62:63]
    v_pk_mul_f32 v[244:245], v[244:245], v[64:65]
    v_pk_mul_f32 v[246:247], v[246:247], v[66:67]
    v_exp_f32 v240, v240
    v_exp_f32 v241, v241
    v_exp_f32 v242, v242
    v_exp_f32 v243, v243
    v_exp_f32 v244, v244
    v_exp_f32 v245, v245
    v_exp_f32 v246, v246
    v_exp_f32 v247, v247
    v_pk_fma_f32 v[240:241], v[240:241], v[238:239], v[238:239] op_sel_hi:[1,0,0]
    v_pk_fma_f32 v[242:243], v[242:243], v[238:239], v[238:239] op_sel_hi:[1,0,0]
    v_pk_fma_f32 v[244:245], v[244:245], v[238:239], v[238:239] op_sel_hi:[1,0,0]
    v_pk_fma_f32 v[246:247], v[246:247], v[238:239], v[238:239] op_sel_hi:[1,0,0]
    v_rcp_f32 v240, v240
    v_rcp_f32 v241, v241
    v_rcp_f32 v242, v242
    v_rcp_f32 v243, v243
    v_rcp_f32 v244, v244
    v_rcp_f32 v245, v245
    v_rcp_f32 v246, v246
    v_rcp_f32 v247, v247
    v_pk_mul_f32 v[240:241], v[60:61], v[240:241]
    v_pk_mul_f32 v[242:243], v[62:63], v[242:243]
    v_pk_mul_f32 v[244:245], v[64:65], v[244:245]
    v_pk_mul_f32 v[246:247], v[66:67], v[246:247]
    v_cvt_pk_bf16_f32 v100, v240, v241
    v_cvt_pk_bf16_f32 v101, v242, v243
    v_cvt_pk_bf16_f32 v102, v244, v245
    v_cvt_pk_bf16_f32 v103, v246, v247
    buffer_store_dwordx4 v[100:103], v1, s[52:55], s67 offen offset:0 sc1
    v_pk_fma_f32 v[68:69], v[88:89], v[230:231], v[68:69] op_sel_hi:[1,0,1] neg_lo:[0,1,0] neg_hi:[0,1,0]
    v_pk_fma_f32 v[70:71], v[90:91], v[230:231], v[70:71] op_sel_hi:[1,0,1] neg_lo:[0,1,0] neg_hi:[0,1,0]
    v_pk_fma_f32 v[72:73], v[92:93], v[230:231], v[72:73] op_sel_hi:[1,0,1] neg_lo:[0,1,0] neg_hi:[0,1,0]
    v_pk_fma_f32 v[74:75], v[94:95], v[230:231], v[74:75] op_sel_hi:[1,0,1] neg_lo:[0,1,0] neg_hi:[0,1,0]
    v_pk_mul_f32 v[240:241], v[68:69], v[68:69]
    v_pk_mul_f32 v[242:243], v[70:71], v[70:71]
    v_pk_mul_f32 v[244:245], v[72:73], v[72:73]
    v_pk_mul_f32 v[246:247], v[74:75], v[74:75]
    v_pk_fma_f32 v[240:241], v[240:241], v[236:237], v[236:237] op_sel:[0,0,1] op_sel_hi:[1,0,1]
    v_pk_fma_f32 v[242:243], v[242:243], v[236:237], v[236:237] op_sel:[0,0,1] op_sel_hi:[1,0,1]
    v_pk_fma_f32 v[244:245], v[244:245], v[236:237], v[236:237] op_sel:[0,0,1] op_sel_hi:[1,0,1]
    v_pk_fma_f32 v[246:247], v[246:247], v[236:237], v[236:237] op_sel:[0,0,1] op_sel_hi:[1,0,1]
    v_pk_mul_f32 v[240:241], v[240:241], v[68:69]
    v_pk_mul_f32 v[242:243], v[242:243], v[70:71]
    v_pk_mul_f32 v[244:245], v[244:245], v[72:73]
    v_pk_mul_f32 v[246:247], v[246:247], v[74:75]
    v_exp_f32 v240, v240
    v_exp_f32 v241, v241
    v_exp_f32 v242, v242
    v_exp_f32 v243, v243
    v_exp_f32 v244, v244
    v_exp_f32 v245, v245
    v_exp_f32 v246, v246
    v_exp_f32 v247, v247
    v_pk_fma_f32 v[240:241], v[240:241], v[238:239], v[238:239] op_sel_hi:[1,0,0]
    v_pk_fma_f32 v[242:243], v[242:243], v[238:239], v[238:239] op_sel_hi:[1,0,0]
    v_pk_fma_f32 v[244:245], v[244:245], v[238:239], v[238:239] op_sel_hi:[1,0,0]
    v_pk_fma_f32 v[246:247], v[246:247], v[238:239], v[238:239] op_sel_hi:[1,0,0]
    v_rcp_f32 v240, v240
    v_rcp_f32 v241, v241
    v_rcp_f32 v242, v242
    v_rcp_f32 v243, v243
    v_rcp_f32 v244, v244
    v_rcp_f32 v245, v245
    v_rcp_f32 v246, v246
    v_rcp_f32 v247, v247
    v_pk_mul_f32 v[240:241], v[68:69], v[240:241]
    v_pk_mul_f32 v[242:243], v[70:71], v[242:243]
    v_pk_mul_f32 v[244:245], v[72:73], v[244:245]
    v_pk_mul_f32 v[246:247], v[74:75], v[246:247]
    v_cvt_pk_bf16_f32 v104, v240, v241
    v_cvt_pk_bf16_f32 v105, v242, v243
    v_cvt_pk_bf16_f32 v106, v244, v245
    v_cvt_pk_bf16_f32 v107, v246, v247
    buffer_store_dwordx4 v[104:107], v1, s[52:55], s67 offen offset:1024 sc1
    v_pk_fma_f32 v[76:77], v[96:97], v[230:231], v[76:77] op_sel_hi:[1,0,1] neg_lo:[0,1,0] neg_hi:[0,1,0]
    v_pk_fma_f32 v[78:79], v[98:99], v[230:231], v[78:79] op_sel_hi:[1,0,1] neg_lo:[0,1,0] neg_hi:[0,1,0]
    v_pk_mul_f32 v[240:241], v[76:77], v[76:77]
    v_pk_mul_f32 v[242:243], v[78:79], v[78:79]
    v_pk_fma_f32 v[240:241], v[240:241], v[236:237], v[236:237] op_sel:[0,0,1] op_sel_hi:[1,0,1]
    v_pk_fma_f32 v[242:243], v[242:243], v[236:237], v[236:237] op_sel:[0,0,1] op_sel_hi:[1,0,1]
    v_pk_mul_f32 v[240:241], v[240:241], v[76:77]
    v_pk_mul_f32 v[242:243], v[242:243], v[78:79]
    v_exp_f32 v240, v240
    v_exp_f32 v241, v241
    v_exp_f32 v242, v242
    v_exp_f32 v243, v243
    v_pk_fma_f32 v[240:241], v[240:241], v[238:239], v[238:239] op_sel_hi:[1,0,0]
    v_pk_fma_f32 v[242:243], v[242:243], v[238:239], v[238:239] op_sel_hi:[1,0,0]
    v_rcp_f32 v240, v240
    v_rcp_f32 v241, v241
    v_rcp_f32 v242, v242
    v_rcp_f32 v243, v243
    v_pk_mul_f32 v[240:241], v[76:77], v[240:241]
    v_pk_mul_f32 v[242:243], v[78:79], v[242:243]
    v_cvt_pk_bf16_f32 v108, v240, v241
    v_cvt_pk_bf16_f32 v109, v242, v243
    buffer_store_dwordx2 v[108:109], v36, s[52:55], s68 offen sc1
    s_waitcnt lgkmcnt(0)
    s_barrier
    s_lshl_b32 s9, s60, 2
    s_add_u32 s9, s9, s62
    s_lshl_b32 s9, s9, 10
    s_add_u32 s9, s9, 4096
    v_lshrrev_b32 v208, 3, v0
    v_lshlrev_b32 v208, 7, v208
    buffer_load_dwordx2 v[210:211], v208, s[52:55], s9 offen sc1
    ds_read_b128 v[60:63], v220
    ds_read_b128 v[64:67], v220 offset:16
    s_add_u32 s66, s101, 79360
    v_mul_u32_u24 v240, 168, v2
    v_lshl_add_u32 v240, v3, 3, v240
    v_add_u32 v240, s66, v240
    v_lshrrev_b32 v241, 2, v0
    v_mul_u32_u24 v241, 168, v241
    v_and_b32 v242, 3, v0
    v_lshl_add_u32 v241, v242, 3, v241
    v_add_u32 v241, s66, v241
    s_lshl_b32 s66, s62, 5
    s_add_u32 s66, s66, 2176
    v_mul_u32_u24 v242, 144, v2
    v_lshl_add_u32 v242, v3, 3, v242
    s_add_u32 s38, s74, 102400
    s_add_u32 m0, s101, 38400
    s_nop 0
    buffer_load_dwordx4 v248, s[44:47], s38 offen lds
    v_add_u32 v242, s66, v242
    s_waitcnt lgkmcnt(0)
    v_pk_add_f32 v[60:61], v[60:61], v[62:63]
    v_pk_add_f32 v[64:65], v[64:65], v[66:67]
    v_pk_add_f32 v[60:61], v[60:61], v[64:65]
    v_mul_f32 v230, 0x3acccccd, v60
    v_mul_f32 v232, 0x3acccccd, v61
    v_fma_f32 v232, -v230, v230, v232
    v_max_f32 v232, 0, v232
    v_cvt_pk_bf16_f32 v228, v232, v232
    v_and_b32 v228, 0xffff0000, v228
    v_add_f32 v228, 0x3727c5ac, v228
    v_cvt_pk_bf16_f32 v228, v228, v228
    v_and_b32 v228, 0xffff0000, v228
    v_sqrt_f32 v228, v228
    s_nop 0
    v_cvt_pk_bf16_f32 v233, v228, v228
    v_and_b32 v233, 0xffff0000, v233
    v_cvt_pk_bf16_f32 v230, v230, v230
    v_and_b32 v230, 0xffff0000, v230
    v_rcp_f32 v234, v233
    v_lshlrev_b32 v80, 16, v4
    v_and_b32 v81, 0xffff0000, v4
    v_lshlrev_b32 v82, 16, v5
    v_and_b32 v83, 0xffff0000, v5
    v_lshlrev_b32 v84, 16, v6
    v_and_b32 v85, 0xffff0000, v6
    v_lshlrev_b32 v86, 16, v7
    v_and_b32 v87, 0xffff0000, v7
    v_lshlrev_b32 v88, 16, v8
    v_and_b32 v89, 0xffff0000, v8
    v_lshlrev_b32 v90, 16, v9
    s_add_u32 m0, s101, 39424
    s_nop 0
    buffer_load_dwordx4 v249, s[44:47], s38 offen lds
    v_and_b32 v91, 0xffff0000, v9
    v_lshlrev_b32 v92, 16, v10
    v_and_b32 v93, 0xffff0000, v10
    v_lshlrev_b32 v94, 16, v11
    v_and_b32 v95, 0xffff0000, v11
    v_lshlrev_b32 v96, 16, v12
    v_and_b32 v97, 0xffff0000, v12
    v_lshlrev_b32 v98, 16, v13
    v_and_b32 v99, 0xffff0000, v13
    v_pk_add_f32 v[80:81], v[80:81], v[230:231] op_sel_hi:[1,0] neg_lo:[0,1] neg_hi:[0,1]
    v_pk_add_f32 v[82:83], v[82:83], v[230:231] op_sel_hi:[1,0] neg_lo:[0,1] neg_hi:[0,1]
    v_pk_add_f32 v[84:85], v[84:85], v[230:231] op_sel_hi:[1,0] neg_lo:[0,1] neg_hi:[0,1]
    v_pk_add_f32 v[86:87], v[86:87], v[230:231] op_sel_hi:[1,0] neg_lo:[0,1] neg_hi:[0,1]
    v_pk_add_f32 v[88:89], v[88:89], v[230:231] op_sel_hi:[1,0] neg_lo:[0,1] neg_hi:[0,1]
    v_pk_add_f32 v[90:91], v[90:91], v[230:231] op_sel_hi:[1,0] neg_lo:[0,1] neg_hi:[0,1]
    v_pk_add_f32 v[92:93], v[92:93], v[230:231] op_sel_hi:[1,0] neg_lo:[0,1] neg_hi:[0,1]
    v_pk_add_f32 v[94:95], v[94:95], v[230:231] op_sel_hi:[1,0] neg_lo:[0,1] neg_hi:[0,1]
    v_pk_add_f32 v[96:97], v[96:97], v[230:231] op_sel_hi:[1,0] neg_lo:[0,1] neg_hi:[0,1]
    v_pk_add_f32 v[98:99], v[98:99], v[230:231] op_sel_hi:[1,0] neg_lo:[0,1] neg_hi:[0,1]
    v_cvt_pk_bf16_f32 v14, v80, v81
    v_cvt_pk_bf16_f32 v15, v82, v83
    v_cvt_pk_bf16_f32 v16, v84, v85
    v_cvt_pk_bf16_f32 v17, v86, v87
    v_cvt_pk_bf16_f32 v18, v88, v89
    v_cvt_pk_bf16_f32 v19, v90, v91
    v_cvt_pk_bf16_f32 v20, v92, v93
    v_cvt_pk_bf16_f32 v21, v94, v95
    v_cvt_pk_bf16_f32 v22, v96, v97
    v_cvt_pk_bf16_f32 v23, v98, v99
    v_lshlrev_b32 v80, 16, v14
    v_and_b32 v81, 0xffff0000, v14
    v_lshlrev_b32 v82, 16, v15
    s_add_u32 m0, s101, 40448
    s_nop 0
    buffer_load_dwordx4 v250, s[44:47], s38 offen lds
    v_and_b32 v83, 0xffff0000, v15
    v_lshlrev_b32 v84, 16, v16
    v_and_b32 v85, 0xffff0000, v16
    v_lshlrev_b32 v86, 16, v17
    v_and_b32 v87, 0xffff0000, v17
    v_lshlrev_b32 v88, 16, v18
    v_and_b32 v89, 0xffff0000, v18
    v_lshlrev_b32 v90, 16, v19
    v_and_b32 v91, 0xffff0000, v19
    v_lshlrev_b32 v92, 16, v20
    v_and_b32 v93, 0xffff0000, v20
    v_lshlrev_b32 v94, 16, v21
    v_and_b32 v95, 0xffff0000, v21
    v_lshlrev_b32 v96, 16, v22
    v_and_b32 v97, 0xffff0000, v22
    v_lshlrev_b32 v98, 16, v23
    v_and_b32 v99, 0xffff0000, v23
    v_pk_mul_f32 v[80:81], v[80:81], v[234:235] op_sel_hi:[1,0]
    v_pk_mul_f32 v[82:83], v[82:83], v[234:235] op_sel_hi:[1,0]
    v_pk_mul_f32 v[84:85], v[84:85], v[234:235] op_sel_hi:[1,0]
    v_pk_mul_f32 v[86:87], v[86:87], v[234:235] op_sel_hi:[1,0]
    v_pk_mul_f32 v[88:89], v[88:89], v[234:235] op_sel_hi:[1,0]
    v_pk_mul_f32 v[90:91], v[90:91], v[234:235] op_sel_hi:[1,0]
    v_pk_mul_f32 v[92:93], v[92:93], v[234:235] op_sel_hi:[1,0]
    v_pk_mul_f32 v[94:95], v[94:95], v[234:235] op_sel_hi:[1,0]
    v_pk_mul_f32 v[96:97], v[96:97], v[234:235] op_sel_hi:[1,0]
    v_pk_mul_f32 v[98:99], v[98:99], v[234:235] op_sel_hi:[1,0]
    v_cvt_pk_bf16_f32 v14, v80, v81
    v_cvt_pk_bf16_f32 v15, v82, v83
    v_cvt_pk_bf16_f32 v16, v84, v85
    v_cvt_pk_bf16_f32 v17, v86, v87
    v_cvt_pk_bf16_f32 v18, v88, v89
    v_cvt_pk_bf16_f32 v19, v90, v91
    s_add_u32 m0, s101, 41472
    s_nop 0
    buffer_load_dwordx4 v251, s[44:47], s38 offen lds
    v_cvt_pk_bf16_f32 v20, v92, v93
    v_cvt_pk_bf16_f32 v21, v94, v95
    v_cvt_pk_bf16_f32 v22, v96, v97
    v_cvt_pk_bf16_f32 v23, v98, v99
    ds_write_b64 v240, v[14:15] offset:0
    ds_write_b64 v240, v[16:17] offset:32
    ds_write_b64 v240, v[18:19] offset:64
    ds_write_b64 v240, v[20:21] offset:96
    ds_write_b64 v240, v[22:23] offset:128
    ds_read_b64_tr_b16 v[60:61], v241 offset:0
    ds_read_b64_tr_b16 v[62:63], v241 offset:32
    ds_read_b64_tr_b16 v[64:65], v241 offset:64
    ds_read_b64_tr_b16 v[66:67], v241 offset:96
    ds_read_b64_tr_b16 v[68:69], v241 offset:128
    s_lshl_b32 s89, s60, 2
    s_add_u32 s89, s89, s62
    s_mul_i32 s89, s89, 61440
    s_add_u32 s89, s89, 1310720
    s_waitcnt vmcnt(8)
    ds_read_b64_tr_b16 a[0:1], v197 offset:1536
    ds_read_b64_tr_b16 a[2:3], v197 offset:4096
    ds_read_b64_tr_b16 a[4:5], v197 offset:1568
    ds_read_b64_tr_b16 a[6:7], v197 offset:4128
    ds_read_b64_tr_b16 a[8:9], v197 offset:1600
    ds_read_b64_tr_b16 a[10:11], v197 offset:4160
    ds_read_b64_tr_b16 a[12:13], v197 offset:1632
    ds_read_b64_tr_b16 a[14:15], v197 offset:4192
    ds_read_b64_tr_b16 a[16:17], v197 offset:1664
    ds_read_b64_tr_b16 a[18:19], v197 offset:4224
    s_waitcnt lgkmcnt(14)
    ds_write_b64 v242, v[60:61] offset:0
    s_waitcnt lgkmcnt(14)
    s_add_u32 m0, s101, 42496
    s_nop 0
    buffer_load_dwordx4 v252, s[44:47], s38 offen lds
    ds_write_b64 v242, v[62:63] offset:2304
    s_waitcnt lgkmcnt(14)
    ds_write_b64 v242, v[64:65] offset:4608
    s_waitcnt lgkmcnt(14)
    ds_write_b64 v242, v[66:67] offset:6912
    s_waitcnt lgkmcnt(14)
    ds_write_b64 v242, v[68:69] offset:9216
    s_add_u32 s38, s74, 143360
    s_add_u32 m0, s101, 120320
    s_nop 0
    buffer_load_dwordx4 v248, s[44:47], s38 offen lds
    s_add_u32 m0, s101, 121344
    s_nop 0
    buffer_load_dwordx4 v249, s[44:47], s38 offen lds
    s_waitcnt vmcnt(8)
    s_lshl_b32 s66, s61, 3
    s_add_u32 s66, s66, s60
    s_lshl_b32 s66, s66, 2
    s_add_u32 s66, s66, s62
    s_lshl_b32 s66, s66, 7
    s_add_u32 s66, s66, 151552
    s_mov_b64 exec, 65535
    buffer_store_dwordx2 v[38:39], v36, s[52:55], s66 offen sc1
    s_mov_b64 exec, -1
    s_waitcnt vmcnt(8)
    v_cmp_ne_u64 vcc, s[64:65], v[210:211]
    s_cbranch_vccz L_chk_1_ok
    s_mov_b32 s82, 0
L_chk_1:
    s_sleep 1
    buffer_load_dwordx2 v[210:211], v208, s[52:55], s9 offen sc1
    s_add_u32 s82, s82, 1
    s_cmp_gt_u32 s82, 0x40000
    s_waitcnt vmcnt(0)
    s_cbranch_scc1 L_chk_1_ok
    v_cmp_ne_u64 vcc, s[64:65], v[210:211]
    s_cbranch_vccnz L_chk_1
L_chk_1_ok:
    s_waitcnt lgkmcnt(0)
    s_barrier
    v_lshrrev_b32 v228, 3, v0
    v_and_b32 v229, 7, v0
    v_mul_u32_u24 v230, 144, v228
    v_lshl_add_u32 v230, v229, 4, v230
    s_mul_i32 s66, s62, 1152
    s_add_u32 s66, s66, 2176
    v_add_u32 v230, s66, v230
    ds_read_b128 v[64:67], v230 offset:0
    ds_read_b128 v[68:71], v230 offset:4608
    ds_read_b128 v[72:75], v230 offset:9216
    v_lshlrev_b32 v228, 12, v228
    v_lshl_add_u32 v228, v229, 4, v228
    s_mul_i32 s66, s60, 10
    s_add_u32 s66, s66, s62
    s_lshl_b32 s66, s66, 15
    s_lshl_b32 s67, s61, 7
    s_add_u32 s66, s66, s67
    s_add_u32 s66, s66, 16777216
    s_waitcnt lgkmcnt(2)
    buffer_store_dwordx4 v[64:67], v228, s[52:55], s66 offen sc1
    s_add_u32 s66, s66, 131072
    s_waitcnt lgkmcnt(1)
    buffer_store_dwordx4 v[68:71], v228, s[52:55], s66 offen sc1
    s_add_u32 s66, s66, 131072
    s_waitcnt lgkmcnt(0)
    s_cmp_lt_u32 s62, 2
    s_cselect_b32 s66, s66, 0x7ffff000
    buffer_store_dwordx4 v[72:75], v228, s[52:55], s66 offen sc1
    s_cmp_eq_u32 s62, 3
    s_cbranch_scc0 L_dfl_2
    v_add_u32 v142, 13696, v1
    ds_write_b128 v142, v[40:43] offset:0
    ds_write_b128 v142, v[44:47] offset:1024
    ds_write_b128 v142, v[48:51] offset:2048
    ds_write_b128 v142, v[52:55] offset:3072
    v_mov_b32 v40, 0
    v_mov_b32 v41, 0
    v_mov_b32 v42, 0
    v_mov_b32 v43, 0
    v_mov_b32 v44, 0
    v_mov_b32 v45, 0
    v_mov_b32 v46, 0
    v_mov_b32 v47, 0
    v_mov_b32 v48, 0
    v_mov_b32 v49, 0
    v_mov_b32 v50, 0
    v_mov_b32 v51, 0
    v_mov_b32 v52, 0
    v_mov_b32 v53, 0
    v_mov_b32 v54, 0
    v_mov_b32 v55, 0
L_dfl_2:
    s_waitcnt lgkmcnt(0)
    s_add_u32 s66, s62, s77
    s_cmp_eq_u32 s66, 3
    s_cselect_b32 s23, s62, 0
    s_cmp_eq_u32 s23, 2
    s_cbranch_scc0 L_kpl_skip
    s_lshl_b32 s66, s60, 4
    s_add_u32 s66, s66, s61
    s_sub_u32 s66, s66, 0
    s_lshl_b32 s66, s66, 12
    s_add_u32 s66, s66, 786432
    buffer_load_dwordx4 v[150:153], v1, s[52:55], s66 offen offset:0 sc1
    buffer_load_dwordx4 v[154:157], v1, s[52:55], s66 offen offset:1024 sc1
    buffer_load_dwordx4 v[158:161], v1, s[52:55], s66 offen offset:2048 sc1
    buffer_load_dwordx4 v[162:165], v1, s[52:55], s66 offen offset:3072 sc1
L_kpl_skip:
    s_mul_i32 s66, s62, 8704
    s_add_u32 m0, s101, 122368
    s_nop 0
    buffer_load_dwordx4 v250, s[44:47], s38 offen lds
    s_mov_b32 m0, s22
    s_add_u32 s66, s66, 79360
    s_sub_u32 s22, s66, 40960
    s_mov_b32 m0, s22
    v_and_b32 v142, 31, v0
    v_mul_u32_u24 v142, 272, v142
    v_lshrrev_b32 v143, 5, v0
    v_lshl_add_u32 v142, v143, 4, v142
    v_add_u32 v140, s66, v142
    s_and_b32 s66, s81, 1
    s_lshl_b32 s66, s66, 4
    s_lshr_b32 s78, s87, s66
    s_lshl_b32 s78, s78, 16
    v_mov_b32 v142, s78
    v_mul_f32 v143, 0x3fb8aa3b, v142
    v_mov_b32 v144, 0x3fb8aa3b
    v_fma_f32 v144, v142, v144, -v143
    v_fmac_f32 v144, 0x32a57060, v142
    v_exp_f32 v143, v143
    v_mul_f32 v144, 0x3f317218, v144
    v_fma_f32 v143, v143, v144, v143
    v_cvt_pk_bf16_f32 v142, v143, v143
    v_and_b32 v142, 0xffff0000, v142
    v_mul_f32 v143, 0x3fb8aa3b, v142
    v_mul_f32 v144, 0x3e22f983, v142
    v_readfirstlane_b32 s78, v142
    v_readfirstlane_b32 s95, v143
    v_readfirstlane_b32 s96, v144
    ds_read_b64_tr_b16 a[20:21], v196 offset:17920
    ds_read_b64_tr_b16 a[22:23], v196 offset:20480
    ds_read_b64_tr_b16 a[24:25], v196 offset:17952
    s_add_u32 m0, s101, 123392
    s_nop 0
    buffer_load_dwordx4 v251, s[44:47], s38 offen lds
    s_mov_b32 m0, s22
    ds_read_b64_tr_b16 a[26:27], v196 offset:20512
    ds_read_b64_tr_b16 a[28:29], v196 offset:17984
    ds_read_b64_tr_b16 a[30:31], v196 offset:20544
    ds_read_b64_tr_b16 a[32:33], v196 offset:18016
    ds_read_b64_tr_b16 a[34:35], v196 offset:20576
    ds_read_b64_tr_b16 a[36:37], v196 offset:18048
    ds_read_b64_tr_b16 a[38:39], v196 offset:20608
    v_lshrrev_b32 v142, 5, v0
    s_cmp_eq_u32 s77, 1
    s_cselect_b32 s66, 0, 16
    s_cselect_b32 s67, 16, 0
    v_mul_u32_u24 v142, s66, v142
    v_add_u32 v142, s67, v142
    v_lshrrev_b32 v126, v142, v25
    v_lshrrev_b32 v127, v142, v27
    v_lshrrev_b32 v128, v142, v29
    v_lshrrev_b32 v129, v142, v31
    v_lshrrev_b32 v130, v142, v33
    v_lshrrev_b32 v131, v142, v35
    v_lshlrev_b32 v126, 16, v126
    v_lshlrev_b32 v127, 16, v127
    v_lshlrev_b32 v128, 16, v128
    v_lshlrev_b32 v129, 16, v129
    v_lshlrev_b32 v130, 16, v130
    v_lshlrev_b32 v131, 16, v131
    v_mul_f32 v126, s95, v126
    v_mul_f32 v127, s96, v127
    v_pk_mul_f32 v[128:129], v[128:129], s[78:79] op_sel_hi:[1,0]
    v_mul_f32 v143, 0x41000000, v126
    v_mul_f32 v146, 0x41000000, v127
    v_mul_f32 v144, 0x43800000, v126
    v_mul_f32 v147, 0x43800000, v127
    s_add_u32 m0, s101, 124416
    s_nop 0
    buffer_load_dwordx4 v252, s[44:47], s38 offen lds
    s_mov_b32 m0, s22
    v_fract_f32 v145, v127
    v_fract_f32 v146, v146
    v_fract_f32 v147, v147
    v_exp_f32 v114, v126
    v_cos_f32 v96, v145
    v_sin_f32 v97, v145
    v_exp_f32 v116, v143
    v_cos_f32 v102, v146
    v_sin_f32 v103, v146
    v_exp_f32 v118, v144
    v_cos_f32 v106, v147
    v_sin_f32 v107, v147
    v_pk_mul_f32 v[108:109], v[130:131], v[128:129] op_sel_hi:[1,0]
    v_pk_fma_f32 v[108:109], v[130:131], v[128:129], v[108:109] op_sel:[1,1,0] op_sel_hi:[0,1,1] neg_lo:[1,0,0]
    v_pk_mul_f32 v[96:97], v[96:97], v[114:115] op_sel_hi:[1,0]
    v_pk_mul_f32 v[102:103], v[102:103], v[116:117] op_sel_hi:[1,0]
    v_pk_mul_f32 v[106:107], v[106:107], v[118:119] op_sel_hi:[1,0]
    v_pk_mul_f32 v[98:99], v[96:97], v[96:97] op_sel_hi:[1,0]
    v_pk_fma_f32 v[98:99], v[96:97], v[96:97], v[98:99] op_sel:[1,1,0] op_sel_hi:[0,1,1] neg_lo:[1,0,0]
    v_pk_mul_f32 v[104:105], v[102:103], v[102:103] op_sel_hi:[1,0]
    v_pk_fma_f32 v[104:105], v[102:103], v[102:103], v[104:105] op_sel:[1,1,0] op_sel_hi:[0,1,1] neg_lo:[1,0,0]
    v_pk_mul_f32 v[100:101], v[98:99], v[98:99] op_sel_hi:[1,0]
    v_pk_fma_f32 v[100:101], v[98:99], v[98:99], v[100:101] op_sel:[1,1,0] op_sel_hi:[0,1,1] neg_lo:[1,0,0]
    v_mov_b32 v122, 0x3f80
    v_cmp_le_u32 vcc, 32, v0
    v_add_u32 v253, 81920, v250
    s_nop 0
    v_cndmask_b32 v250, v250, v253, vcc
    v_add_u32 v251, 81920, v251
    v_add_u32 v252, 81920, v252
    s_add_u32 s38, s74, 81920
    s_add_u32 m0, s101, 58880
    s_nop 0
    buffer_load_dwordx4 v248, s[44:47], s38 offen lds
    s_mov_b32 m0, s22
    v_cvt_pk_bf16_f32 v123, v102, v103
    ds_write_addtid_b32 v122 offset:40960
    ds_write_addtid_b32 v123 offset:41232
    v_pk_mul_f32 v[120:121], v[102:103], v[104:105] op_sel_hi:[1,0]
    v_pk_fma_f32 v[120:121], v[102:103], v[104:105], v[120:121] op_sel:[1,1,0] op_sel_hi:[0,1,1] neg_lo:[1,0,0]
    v_cvt_pk_bf16_f32 v124, v104, v105
    v_cvt_pk_bf16_f32 v125, v120, v121
    ds_write_addtid_b32 v124 offset:41504
    ds_write_addtid_b32 v125 offset:41776
    v_pk_mul_f32 v[114:115], v[104:105], v[104:105] op_sel_hi:[1,0]
    v_pk_fma_f32 v[114:115], v[104:105], v[104:105], v[114:115] op_sel:[1,1,0] op_sel_hi:[0,1,1] neg_lo:[1,0,0]
    v_pk_mul_f32 v[118:119], v[120:121], v[104:105] op_sel_hi:[1,0]
    v_pk_fma_f32 v[118:119], v[120:121], v[104:105], v[118:119] op_sel:[1,1,0] op_sel_hi:[0,1,1] neg_lo:[1,0,0]
    v_cvt_pk_bf16_f32 v122, v114, v115
    v_cvt_pk_bf16_f32 v123, v118, v119
    ds_write_addtid_b32 v122 offset:42048
    ds_write_addtid_b32 v123 offset:42320
    v_pk_mul_f32 v[116:117], v[114:115], v[104:105] op_sel_hi:[1,0]
    v_pk_fma_f32 v[116:117], v[114:115], v[104:105], v[116:117] op_sel:[1,1,0] op_sel_hi:[0,1,1] neg_lo:[1,0,0]
    v_pk_mul_f32 v[120:121], v[118:119], v[104:105] op_sel_hi:[1,0]
    v_pk_fma_f32 v[120:121], v[118:119], v[104:105], v[120:121] op_sel:[1,1,0] op_sel_hi:[0,1,1] neg_lo:[1,0,0]
    v_cvt_pk_bf16_f32 v124, v116, v117
    v_cvt_pk_bf16_f32 v125, v120, v121
    ds_write_addtid_b32 v124 offset:42592
    ds_write_addtid_b32 v125 offset:42864
    v_pk_mul_f32 v[114:115], v[116:117], v[104:105] op_sel_hi:[1,0]
    v_pk_fma_f32 v[114:115], v[116:117], v[104:105], v[114:115] op_sel:[1,1,0] op_sel_hi:[0,1,1] neg_lo:[1,0,0]
    v_pk_mul_f32 v[118:119], v[120:121], v[104:105] op_sel_hi:[1,0]
    v_pk_fma_f32 v[118:119], v[120:121], v[104:105], v[118:119] op_sel:[1,1,0] op_sel_hi:[0,1,1] neg_lo:[1,0,0]
    v_cvt_pk_bf16_f32 v122, v114, v115
    v_cvt_pk_bf16_f32 v123, v118, v119
    ds_write_addtid_b32 v122 offset:43136
    s_add_u32 m0, s101, 59904
    s_nop 0
    buffer_load_dwordx4 v249, s[44:47], s38 offen lds
    s_mov_b32 m0, s22
    s_nop 0
    ds_write_addtid_b32 v123 offset:43408
    v_pk_mul_f32 v[116:117], v[114:115], v[104:105] op_sel_hi:[1,0]
    v_pk_fma_f32 v[116:117], v[114:115], v[104:105], v[116:117] op_sel:[1,1,0] op_sel_hi:[0,1,1] neg_lo:[1,0,0]
    v_pk_mul_f32 v[120:121], v[118:119], v[104:105] op_sel_hi:[1,0]
    v_pk_fma_f32 v[120:121], v[118:119], v[104:105], v[120:121] op_sel:[1,1,0] op_sel_hi:[0,1,1] neg_lo:[1,0,0]
    v_cvt_pk_bf16_f32 v124, v116, v117
    v_cvt_pk_bf16_f32 v125, v120, v121
    ds_write_addtid_b32 v124 offset:43680
    ds_write_addtid_b32 v125 offset:43952
    v_pk_mul_f32 v[114:115], v[116:117], v[104:105] op_sel_hi:[1,0]
    v_pk_fma_f32 v[114:115], v[116:117], v[104:105], v[114:115] op_sel:[1,1,0] op_sel_hi:[0,1,1] neg_lo:[1,0,0]
    v_pk_mul_f32 v[118:119], v[120:121], v[104:105] op_sel_hi:[1,0]
    v_pk_fma_f32 v[118:119], v[120:121], v[104:105], v[118:119] op_sel:[1,1,0] op_sel_hi:[0,1,1] neg_lo:[1,0,0]
    v_cvt_pk_bf16_f32 v122, v114, v115
    v_cvt_pk_bf16_f32 v123, v118, v119
    ds_write_addtid_b32 v122 offset:44224
    ds_write_addtid_b32 v123 offset:44496
    v_pk_mul_f32 v[116:117], v[114:115], v[104:105] op_sel_hi:[1,0]
    v_pk_fma_f32 v[116:117], v[114:115], v[104:105], v[116:117] op_sel:[1,1,0] op_sel_hi:[0,1,1] neg_lo:[1,0,0]
    v_pk_mul_f32 v[120:121], v[118:119], v[104:105] op_sel_hi:[1,0]
    v_pk_fma_f32 v[120:121], v[118:119], v[104:105], v[120:121] op_sel:[1,1,0] op_sel_hi:[0,1,1] neg_lo:[1,0,0]
    v_cvt_pk_bf16_f32 v124, v116, v117
    v_cvt_pk_bf16_f32 v125, v120, v121
    ds_write_addtid_b32 v124 offset:44768
    ds_write_addtid_b32 v125 offset:45040
    v_pk_mul_f32 v[114:115], v[116:117], v[104:105] op_sel_hi:[1,0]
    v_pk_fma_f32 v[114:115], v[116:117], v[104:105], v[114:115] op_sel:[1,1,0] op_sel_hi:[0,1,1] neg_lo:[1,0,0]
    v_pk_mul_f32 v[118:119], v[120:121], v[104:105] op_sel_hi:[1,0]
    v_pk_fma_f32 v[118:119], v[120:121], v[104:105], v[118:119] op_sel:[1,1,0] op_sel_hi:[0,1,1] neg_lo:[1,0,0]
    v_cvt_pk_bf16_f32 v122, v114, v115
    v_cvt_pk_bf16_f32 v123, v118, v119
    ds_write_addtid_b32 v122 offset:45312
    ds_write_addtid_b32 v123 offset:45584
    s_add_u32 m0, s101, 60928
    s_nop 0
    buffer_load_dwordx4 v250, s[44:47], s38 offen lds
    s_mov_b32 m0, s22
    v_pk_mul_f32 v[116:117], v[114:115], v[104:105] op_sel_hi:[1,0]
    v_pk_fma_f32 v[116:117], v[114:115], v[104:105], v[116:117] op_sel:[1,1,0] op_sel_hi:[0,1,1] neg_lo:[1,0,0]
    v_pk_mul_f32 v[120:121], v[118:119], v[104:105] op_sel_hi:[1,0]
    v_pk_fma_f32 v[120:121], v[118:119], v[104:105], v[120:121] op_sel:[1,1,0] op_sel_hi:[0,1,1] neg_lo:[1,0,0]
    v_cvt_pk_bf16_f32 v124, v116, v117
    v_cvt_pk_bf16_f32 v125, v120, v121
    ds_write_addtid_b32 v124 offset:45856
    ds_write_addtid_b32 v125 offset:46128
    v_pk_mul_f32 v[114:115], v[116:117], v[104:105] op_sel_hi:[1,0]
    v_pk_fma_f32 v[114:115], v[116:117], v[104:105], v[114:115] op_sel:[1,1,0] op_sel_hi:[0,1,1] neg_lo:[1,0,0]
    v_pk_mul_f32 v[118:119], v[120:121], v[104:105] op_sel_hi:[1,0]
    v_pk_fma_f32 v[118:119], v[120:121], v[104:105], v[118:119] op_sel:[1,1,0] op_sel_hi:[0,1,1] neg_lo:[1,0,0]
    v_cvt_pk_bf16_f32 v122, v114, v115
    v_cvt_pk_bf16_f32 v123, v118, v119
    ds_write_addtid_b32 v122 offset:46400
    ds_write_addtid_b32 v123 offset:46672
    v_pk_mul_f32 v[116:117], v[114:115], v[104:105] op_sel_hi:[1,0]
    v_pk_fma_f32 v[116:117], v[114:115], v[104:105], v[116:117] op_sel:[1,1,0] op_sel_hi:[0,1,1] neg_lo:[1,0,0]
    v_pk_mul_f32 v[120:121], v[118:119], v[104:105] op_sel_hi:[1,0]
    v_pk_fma_f32 v[120:121], v[118:119], v[104:105], v[120:121] op_sel:[1,1,0] op_sel_hi:[0,1,1] neg_lo:[1,0,0]
    v_cvt_pk_bf16_f32 v124, v116, v117
    v_cvt_pk_bf16_f32 v125, v120, v121
    ds_write_addtid_b32 v124 offset:46944
    ds_write_addtid_b32 v125 offset:47216
    v_pk_mul_f32 v[114:115], v[116:117], v[104:105] op_sel_hi:[1,0]
    v_pk_fma_f32 v[114:115], v[116:117], v[104:105], v[114:115] op_sel:[1,1,0] op_sel_hi:[0,1,1] neg_lo:[1,0,0]
    v_pk_mul_f32 v[118:119], v[120:121], v[104:105] op_sel_hi:[1,0]
    v_pk_fma_f32 v[118:119], v[120:121], v[104:105], v[118:119] op_sel:[1,1,0] op_sel_hi:[0,1,1] neg_lo:[1,0,0]
    v_cvt_pk_bf16_f32 v122, v114, v115
    v_cvt_pk_bf16_f32 v123, v118, v119
    ds_write_addtid_b32 v122 offset:47488
    ds_write_addtid_b32 v123 offset:47760
    s_add_u32 m0, s101, 61952
    s_nop 0
    buffer_load_dwordx4 v251, s[44:47], s38 offen lds
    s_mov_b32 m0, s22
    v_pk_mul_f32 v[116:117], v[114:115], v[104:105] op_sel_hi:[1,0]
    v_pk_fma_f32 v[116:117], v[114:115], v[104:105], v[116:117] op_sel:[1,1,0] op_sel_hi:[0,1,1] neg_lo:[1,0,0]
    v_pk_mul_f32 v[120:121], v[118:119], v[104:105] op_sel_hi:[1,0]
    v_pk_fma_f32 v[120:121], v[118:119], v[104:105], v[120:121] op_sel:[1,1,0] op_sel_hi:[0,1,1] neg_lo:[1,0,0]
    v_cvt_pk_bf16_f32 v124, v116, v117
    v_cvt_pk_bf16_f32 v125, v120, v121
    ds_write_addtid_b32 v124 offset:48032
    ds_write_addtid_b32 v125 offset:48304
    v_pk_mul_f32 v[114:115], v[116:117], v[104:105] op_sel_hi:[1,0]
    v_pk_fma_f32 v[114:115], v[116:117], v[104:105], v[114:115] op_sel:[1,1,0] op_sel_hi:[0,1,1] neg_lo:[1,0,0]
    v_pk_mul_f32 v[118:119], v[120:121], v[104:105] op_sel_hi:[1,0]
    v_pk_fma_f32 v[118:119], v[120:121], v[104:105], v[118:119] op_sel:[1,1,0] op_sel_hi:[0,1,1] neg_lo:[1,0,0]
    v_cvt_pk_bf16_f32 v122, v114, v115
    s_add_u32 m0, s101, 62976
    s_nop 0
    buffer_load_dwordx4 v252, s[44:47], s38 offen lds
    s_mov_b32 m0, s22
    buffer_load_dwordx4 a[100:103], v1, s[52:55], s89 offen offset:0 sc1
    buffer_load_dwordx4 a[104:107], v1, s[52:55], s89 offen offset:1024 sc1
    s_waitcnt vmcnt(10)
    s_barrier
    s_cmp_eq_u32 s62, 3
    s_cbranch_scc0 L_g2_skip
    s_lshl_b32 s66, s60, 5
    s_add_u32 s66, s66, s61
    s_lshl_b32 s66, s66, 7
    s_add_u32 s66, s66, 36864
    s_mov_b64 exec, 65535
    buffer_store_dwordx2 v[38:39], v36, s[52:55], s66 offen sc1
    s_mov_b64 exec, -1
L_g2_skip:
    buffer_load_dwordx4 a[108:111], v1, s[52:55], s89 offen offset:2048 sc1
    ds_read_b64_tr_b16 a[40:41], v196 offset:38400
    ds_read_b64_tr_b16 a[42:43], v196 offset:40960
    ds_read_b64_tr_b16 a[44:45], v196 offset:38432
    ds_read_b64_tr_b16 a[46:47], v196 offset:40992
    ds_read_b64_tr_b16 a[48:49], v196 offset:38464
    ds_read_b64_tr_b16 a[50:51], v196 offset:41024
    ds_read_b64_tr_b16 a[52:53], v196 offset:38496
    ds_read_b64_tr_b16 a[54:55], v196 offset:41056
    ds_read_b64_tr_b16 a[56:57], v196 offset:38528
    ds_read_b64_tr_b16 a[58:59], v196 offset:41088
    v_cvt_pk_bf16_f32 v123, v118, v119
    ds_write_addtid_b32 v122 offset:48576
    ds_write_addtid_b32 v123 offset:48848
    v_pk_mul_f32 v[116:117], v[114:115], v[104:105] op_sel_hi:[1,0]
    v_pk_fma_f32 v[116:117], v[114:115], v[104:105], v[116:117] op_sel:[1,1,0] op_sel_hi:[0,1,1] neg_lo:[1,0,0]
    v_pk_mul_f32 v[120:121], v[118:119], v[104:105] op_sel_hi:[1,0]
    v_pk_fma_f32 v[120:121], v[118:119], v[104:105], v[120:121] op_sel:[1,1,0] op_sel_hi:[0,1,1] neg_lo:[1,0,0]
    v_cvt_pk_bf16_f32 v124, v116, v117
    v_cvt_pk_bf16_f32 v125, v120, v121
    ds_write_addtid_b32 v124 offset:49120
    ds_write_addtid_b32 v125 offset:49392
    ds_read_b128 v[56:59], v140 offset:0
    ds_read_b128 v[60:63], v140 offset:32
    buffer_load_dwordx4 a[112:115], v1, s[52:55], s89 offen offset:3072 sc1
    ds_read_b128 v[64:67], v140 offset:64
    ds_read_b128 v[68:71], v140 offset:96
    ds_read_b128 v[72:75], v140 offset:128
    ds_read_b128 v[76:79], v140 offset:160
    ds_read_b128 v[80:83], v140 offset:192
    ds_read_b128 v[84:87], v140 offset:224
    v_pk_mul_f32 v[110:111], v[108:109], v[106:107] op_sel_hi:[1,0]
    v_pk_fma_f32 v[110:111], v[108:109], v[106:107], v[110:111] op_sel:[1,1,0] op_sel_hi:[0,1,1] neg_lo:[1,0,0]
    v_cvt_pk_bf16_f32 v122, v108, -v109
    v_cvt_pk_bf16_f32 v124, v110, -v111
    v_pk_mul_f32 v[114:115], v[108:109], v[96:97] op_sel_hi:[1,0]
    v_pk_fma_f32 v[114:115], v[108:109], v[96:97], v[114:115] op_sel:[1,1,0] op_sel_hi:[0,1,1] neg_lo:[1,0,0]
    v_pk_mul_f32 v[118:119], v[110:111], v[98:99] op_sel_hi:[1,0]
    v_pk_fma_f32 v[118:119], v[110:111], v[98:99], v[118:119] op_sel:[1,1,0] op_sel_hi:[0,1,1] neg_lo:[1,0,0]
    v_cvt_pk_bf16_f32 v123, v114, -v115
    v_cvt_pk_bf16_f32 v125, v118, -v119
    ds_write_addtid_b32 v122 offset:40960
    ds_write_addtid_b32 v123 offset:41232
    ds_write_addtid_b32 v124 offset:42048
    ds_write_addtid_b32 v125 offset:42320
    v_pk_mul_f32 v[116:117], v[114:115], v[96:97] op_sel_hi:[1,0]
    v_pk_fma_f32 v[116:117], v[114:115], v[96:97], v[116:117] op_sel:[1,1,0] op_sel_hi:[0,1,1] neg_lo:[1,0,0]
    v_pk_mul_f32 v[120:121], v[118:119], v[98:99] op_sel_hi:[1,0]
    v_pk_fma_f32 v[120:121], v[118:119], v[98:99], v[120:121] op_sel:[1,1,0] op_sel_hi:[0,1,1] neg_lo:[1,0,0]
    s_add_u32 s89, s89, 4096
    buffer_load_dwordx4 a[116:119], v1, s[52:55], s89 offen offset:0 sc1
    v_cvt_pk_bf16_f32 v122, v116, -v117
    v_cvt_pk_bf16_f32 v124, v120, -v121
    v_pk_mul_f32 v[114:115], v[116:117], v[96:97] op_sel_hi:[1,0]
    v_pk_fma_f32 v[114:115], v[116:117], v[96:97], v[114:115] op_sel:[1,1,0] op_sel_hi:[0,1,1] neg_lo:[1,0,0]
    v_pk_mul_f32 v[118:119], v[120:121], v[98:99] op_sel_hi:[1,0]
    v_pk_fma_f32 v[118:119], v[120:121], v[98:99], v[118:119] op_sel:[1,1,0] op_sel_hi:[0,1,1] neg_lo:[1,0,0]
    v_cvt_pk_bf16_f32 v123, v114, -v115
    v_cvt_pk_bf16_f32 v125, v118, -v119
    ds_write_addtid_b32 v122 offset:41504
    ds_write_addtid_b32 v123 offset:41776
    s_waitcnt vmcnt(10)
    ds_read_b64_tr_b16 a[60:61], v197 offset:22016
    ds_read_b64_tr_b16 a[62:63], v197 offset:24576
    ds_read_b64_tr_b16 a[64:65], v197 offset:22048
    ds_read_b64_tr_b16 a[66:67], v197 offset:24608
    ds_read_b64_tr_b16 a[68:69], v197 offset:22080
    ds_read_b64_tr_b16 a[70:71], v197 offset:24640
    ds_read_b64_tr_b16 a[72:73], v197 offset:22112
    ds_read_b64_tr_b16 a[74:75], v197 offset:24672
    ds_read_b64_tr_b16 a[76:77], v197 offset:22144
    ds_read_b64_tr_b16 a[78:79], v197 offset:24704
    ds_write_addtid_b32 v124 offset:42592
    ds_write_addtid_b32 v125 offset:42864
    v_pk_mul_f32 v[116:117], v[114:115], v[96:97] op_sel_hi:[1,0]
    buffer_load_dwordx4 a[120:123], v1, s[52:55], s89 offen offset:1024 sc1
    v_pk_fma_f32 v[116:117], v[114:115], v[96:97], v[116:117] op_sel:[1,1,0] op_sel_hi:[0,1,1] neg_lo:[1,0,0]
    v_pk_mul_f32 v[120:121], v[118:119], v[98:99] op_sel_hi:[1,0]
    v_pk_fma_f32 v[120:121], v[118:119], v[98:99], v[120:121] op_sel:[1,1,0] op_sel_hi:[0,1,1] neg_lo:[1,0,0]
    v_cvt_pk_bf16_f32 v122, v116, -v117
    v_cvt_pk_bf16_f32 v124, v120, -v121
    ds_write_addtid_b32 v124 offset:44224
    v_pk_mul_f32 v[114:115], v[116:117], v[96:97] op_sel_hi:[1,0]
    v_pk_fma_f32 v[114:115], v[116:117], v[96:97], v[114:115] op_sel:[1,1,0] op_sel_hi:[0,1,1] neg_lo:[1,0,0]
    v_pk_mul_f32 v[112:113], v[110:111], v[106:107] op_sel_hi:[1,0]
    v_pk_fma_f32 v[112:113], v[110:111], v[106:107], v[112:113] op_sel:[1,1,0] op_sel_hi:[0,1,1] neg_lo:[1,0,0]
    v_cvt_pk_bf16_f32 v123, v114, -v115
    ds_write_addtid_b32 v122 offset:43136
    ds_write_addtid_b32 v123 offset:43408
    v_pk_mul_f32 v[116:117], v[114:115], v[96:97] op_sel_hi:[1,0]
    v_pk_fma_f32 v[116:117], v[114:115], v[96:97], v[116:117] op_sel:[1,1,0] op_sel_hi:[0,1,1] neg_lo:[1,0,0]
    v_cvt_pk_bf16_f32 v122, v116, -v117
    v_pk_mul_f32 v[114:115], v[116:117], v[96:97] op_sel_hi:[1,0]
    v_pk_fma_f32 v[114:115], v[116:117], v[96:97], v[114:115] op_sel:[1,1,0] op_sel_hi:[0,1,1] neg_lo:[1,0,0]
    v_cvt_pk_bf16_f32 v123, v114, -v115
    ds_write_addtid_b32 v122 offset:43680
    ds_write_addtid_b32 v123 offset:43952
    v_pk_mul_f32 v[114:115], v[112:113], v[100:101] op_sel_hi:[1,0]
    v_pk_fma_f32 v[114:115], v[112:113], v[100:101], v[114:115] op_sel:[1,1,0] op_sel_hi:[0,1,1] neg_lo:[1,0,0]
    buffer_load_dwordx4 a[124:127], v1, s[52:55], s89 offen offset:2048 sc1
    v_pk_mul_f32 v[116:117], v[112:113], v[102:103] op_sel_hi:[1,0]
    v_pk_fma_f32 v[116:117], v[112:113], v[102:103], v[116:117] op_sel:[1,1,0] op_sel_hi:[0,1,1] neg_lo:[1,0,0]
    v_pk_mul_f32 v[110:111], v[112:113], v[106:107] op_sel_hi:[1,0]
    v_pk_fma_f32 v[110:111], v[112:113], v[106:107], v[110:111] op_sel:[1,1,0] op_sel_hi:[0,1,1] neg_lo:[1,0,0]
    v_cvt_pk_bf16_f32 v122, v112, -v113
    v_cvt_pk_bf16_f32 v123, v114, -v115
    v_cvt_pk_bf16_f32 v124, v116, -v117
    ds_write_addtid_b32 v122 offset:45312
    ds_write_addtid_b32 v123 offset:45584
    ds_write_addtid_b32 v124 offset:45856
    v_pk_mul_f32 v[114:115], v[110:111], v[100:101] op_sel_hi:[1,0]
    v_pk_fma_f32 v[114:115], v[110:111], v[100:101], v[114:115] op_sel:[1,1,0] op_sel_hi:[0,1,1] neg_lo:[1,0,0]
    v_pk_mul_f32 v[116:117], v[110:111], v[102:103] op_sel_hi:[1,0]
    v_pk_fma_f32 v[116:117], v[110:111], v[102:103], v[116:117] op_sel:[1,1,0] op_sel_hi:[0,1,1] neg_lo:[1,0,0]
    v_pk_mul_f32 v[112:113], v[110:111], v[106:107] op_sel_hi:[1,0]
    v_pk_fma_f32 v[112:113], v[110:111], v[106:107], v[112:113] op_sel:[1,1,0] op_sel_hi:[0,1,1] neg_lo:[1,0,0]
    v_cvt_pk_bf16_f32 v122, v110, -v111
    v_cvt_pk_bf16_f32 v123, v114, -v115
    v_cvt_pk_bf16_f32 v124, v116, -v117
    ds_write_addtid_b32 v122 offset:46400
    ds_write_addtid_b32 v123 offset:46672
    ds_write_addtid_b32 v124 offset:46944
    v_pk_mul_f32 v[114:115], v[112:113], v[102:103] op_sel_hi:[1,0]
    v_pk_fma_f32 v[114:115], v[112:113], v[102:103], v[114:115] op_sel:[1,1,0] op_sel_hi:[0,1,1] neg_lo:[1,0,0]
    buffer_load_dwordx4 a[128:131], v1, s[52:55], s89 offen offset:3072 sc1
    v_pk_mul_f32 v[110:111], v[112:113], v[106:107] op_sel_hi:[1,0]
    v_pk_fma_f32 v[110:111], v[112:113], v[106:107], v[110:111] op_sel:[1,1,0] op_sel_hi:[0,1,1] neg_lo:[1,0,0]
    v_cvt_pk_bf16_f32 v122, v112, -v113
    v_cvt_pk_bf16_f32 v123, v114, -v115
    ds_write_addtid_b32 v122 offset:47488
    ds_write_addtid_b32 v123 offset:47760
    v_pk_mul_f32 v[114:115], v[110:111], v[102:103] op_sel_hi:[1,0]
    v_pk_fma_f32 v[114:115], v[110:111], v[102:103], v[114:115] op_sel:[1,1,0] op_sel_hi:[0,1,1] neg_lo:[1,0,0]
    v_pk_mul_f32 v[112:113], v[110:111], v[106:107] op_sel_hi:[1,0]
    v_pk_fma_f32 v[112:113], v[110:111], v[106:107], v[112:113] op_sel:[1,1,0] op_sel_hi:[0,1,1] neg_lo:[1,0,0]
    v_cvt_pk_bf16_f32 v124, v110, -v111
    v_cvt_pk_bf16_f32 v125, v114, -v115
    s_waitcnt vmcnt(8)
    ds_read_b64_tr_b16 a[80:81], v196 offset:58880
    ds_read_b64_tr_b16 a[82:83], v196 offset:61440
    ds_read_b64_tr_b16 a[84:85], v196 offset:58912
    ds_read_b64_tr_b16 a[86:87], v196 offset:61472
    ds_read_b64_tr_b16 a[88:89], v196 offset:58944
    ds_read_b64_tr_b16 a[90:91], v196 offset:61504
    ds_read_b64_tr_b16 a[92:93], v196 offset:58976
    ds_read_b64_tr_b16 a[94:95], v196 offset:61536
    ds_read_b64_tr_b16 a[96:97], v196 offset:59008
    ds_read_b64_tr_b16 a[98:99], v196 offset:61568
    s_add_u32 s89, s89, 4096
    buffer_load_dwordx4 a[132:135], v1, s[52:55], s89 offen offset:0 sc1
    buffer_load_dwordx4 a[136:139], v1, s[52:55], s89 offen offset:1024 sc1
    buffer_load_dwordx4 a[140:143], v1, s[52:55], s89 offen offset:2048 sc1
    buffer_load_dwordx4 a[144:147], v1, s[52:55], s89 offen offset:3072 sc1
    s_lshl_b32 s75, s61, 2
    s_add_u32 s75, s75, s62
    s_lshl_b32 s75, s75, 10
    s_add_u32 s75, s75, 151552
    v_lshrrev_b32 v200, 3, v0
    v_lshlrev_b32 v200, 7, v200
    buffer_load_dwordx2 v[202:203], v200, s[52:55], s75 offen sc1
    s_lshl_b32 s74, s60, 2
    s_add_u32 s74, s74, s62
    s_lshl_b32 s74, s74, 10
    s_add_u32 s74, s74, 36864
    v_lshrrev_b32 v204, 3, v0
    v_lshlrev_b32 v204, 7, v204
    buffer_load_dwordx2 v[206:207], v204, s[52:55], s74 offen sc1
    ds_write_addtid_b32 v124 offset:48032
    ds_write_addtid_b32 v125 offset:48304
    v_pk_mul_f32 v[114:115], v[112:113], v[102:103] op_sel_hi:[1,0]
    v_pk_fma_f32 v[114:115], v[112:113], v[102:103], v[114:115] op_sel:[1,1,0] op_sel_hi:[0,1,1] neg_lo:[1,0,0]
    v_pk_mul_f32 v[110:111], v[112:113], v[106:107] op_sel_hi:[1,0]
    v_pk_fma_f32 v[110:111], v[112:113], v[106:107], v[110:111] op_sel:[1,1,0] op_sel_hi:[0,1,1] neg_lo:[1,0,0]
    v_cvt_pk_bf16_f32 v122, v112, -v113
    v_cvt_pk_bf16_f32 v123, v114, -v115
    ds_write_addtid_b32 v122 offset:48576
    ds_write_addtid_b32 v123 offset:48848
    v_pk_mul_f32 v[114:115], v[110:111], v[102:103] op_sel_hi:[1,0]
    v_pk_fma_f32 v[114:115], v[110:111], v[102:103], v[114:115] op_sel:[1,1,0] op_sel_hi:[0,1,1] neg_lo:[1,0,0]
    v_cvt_pk_bf16_f32 v124, v110, -v111
    v_cvt_pk_bf16_f32 v125, v114, -v115
    ds_write_addtid_b32 v124 offset:49120
    ds_write_addtid_b32 v125 offset:49392
    ds_read_b128 v[88:91], v140 offset:0
    ds_read_b128 v[92:95], v140 offset:32
    ds_read_b128 v[96:99], v140 offset:64
    ds_read_b128 v[100:103], v140 offset:96
    s_waitcnt lgkmcnt(3)
    v_mfma_f32_32x32x16_bf16 v[40:55], v[88:91], v[56:59], v[40:55]
    ds_read_b128 v[88:91], v140 offset:128
    s_waitcnt lgkmcnt(3)
    v_mfma_f32_32x32x16_bf16 v[40:55], v[92:95], v[60:63], v[40:55]
    ds_read_b128 v[92:95], v140 offset:160
    s_waitcnt lgkmcnt(3)
    v_mfma_f32_32x32x16_bf16 v[40:55], v[96:99], v[64:67], v[40:55]
    ds_read_b128 v[96:99], v140 offset:192
    s_waitcnt lgkmcnt(3)
    v_mfma_f32_32x32x16_bf16 v[40:55], v[100:103], v[68:71], v[40:55]
    ds_read_b128 v[100:103], v140 offset:224
    s_waitcnt lgkmcnt(3)
    v_mfma_f32_32x32x16_bf16 v[40:55], v[88:91], v[72:75], v[40:55]
    s_waitcnt lgkmcnt(2)
    v_mfma_f32_32x32x16_bf16 v[40:55], v[92:95], v[76:79], v[40:55]
    s_waitcnt lgkmcnt(1)
    v_mfma_f32_32x32x16_bf16 v[40:55], v[96:99], v[80:83], v[40:55]
    s_waitcnt lgkmcnt(0)
    v_mfma_f32_32x32x16_bf16 v[40:55], v[100:103], v[84:87], v[40:55]
    s_cmp_eq_u32 s62, 3
    s_cbranch_scc0 L_dfl_3
    v_add_u32 v142, 114176, v1
    s_nop 8
    ds_write_b128 v142, v[40:43] offset:0
    ds_write_b128 v142, v[44:47] offset:1024
    ds_write_b128 v142, v[48:51] offset:2048
    ds_write_b128 v142, v[52:55] offset:3072
L_dfl_3:
    s_waitcnt lgkmcnt(0)
    s_cmp_eq_u32 s23, 2
    s_cbranch_scc0 L_kpa_skip
    s_nop 6
    v_pk_add_f32 v[40:41], v[40:41], v[150:151]
    v_pk_add_f32 v[42:43], v[42:43], v[152:153]
    v_pk_add_f32 v[44:45], v[44:45], v[154:155]
    v_pk_add_f32 v[46:47], v[46:47], v[156:157]
    v_pk_add_f32 v[48:49], v[48:49], v[158:159]
    v_pk_add_f32 v[50:51], v[50:51], v[160:161]
    v_pk_add_f32 v[52:53], v[52:53], v[162:163]
    v_pk_add_f32 v[54:55], v[54:55], v[164:165]
L_kpa_skip:
    s_barrier
    s_add_u32 s4, s62, 1
    s_and_b32 s4, s4, 3
    s_lshl_b32 s66, s61, 2
    s_add_u32 s4, s4, s66
    s_lshl_b32 s4, s4, 2
    s_add_u32 s4, s4, s62
    s_mul_i32 s4, s4, 5120
    s_add_u32 s4, s4, 5242880
    s_add_u32 s5, s62, 2
    s_and_b32 s5, s5, 3
    s_lshl_b32 s66, s61, 2
    s_add_u32 s5, s5, s66
    s_lshl_b32 s5, s5, 2
    s_add_u32 s5, s5, s62
    s_mul_i32 s5, s5, 5120
    s_add_u32 s5, s5, 5242880
    s_add_u32 s6, s62, 3
    s_and_b32 s6, s6, 3
    s_lshl_b32 s66, s61, 2
    s_add_u32 s6, s6, s66
    s_lshl_b32 s6, s6, 2
    s_add_u32 s6, s6, s62
    s_mul_i32 s6, s6, 5120
    s_add_u32 s6, s6, 5242880
    s_add_u32 s7, s62, 4
    s_and_b32 s7, s7, 3
    s_lshl_b32 s66, s61, 2
    s_add_u32 s7, s7, s66
    s_lshl_b32 s7, s7, 2
    s_add_u32 s7, s7, s62
    s_mul_i32 s7, s7, 5120
    s_add_u32 s7, s7, 5242880
    s_waitcnt vmcnt(1)
    v_cmp_ne_u64 vcc, s[64:65], v[202:203]
    s_cbranch_vccz L_chk_4_ok
    s_mov_b32 s82, 0
L_chk_4:
    s_sleep 1
    buffer_load_dwordx2 v[202:203], v200, s[52:55], s75 offen sc1
    s_add_u32 s82, s82, 1
    s_cmp_gt_u32 s82, 0x40000
    s_waitcnt vmcnt(0)
    s_cbranch_scc1 L_chk_4_ok
    v_cmp_ne_u64 vcc, s[64:65], v[202:203]
    s_cbranch_vccnz L_chk_4
L_chk_4_ok:
    buffer_load_dwordx4 v[120:123], v1, s[52:55], s4 offen offset:0 sc1
    buffer_load_dwordx4 v[124:127], v1, s[52:55], s4 offen offset:1024 sc1
    buffer_load_dwordx4 v[128:131], v1, s[52:55], s4 offen offset:2048 sc1
    buffer_load_dwordx4 v[132:135], v1, s[52:55], s4 offen offset:3072 sc1
    s_add_u32 s4, s4, 4096
    buffer_load_dwordx2 v[136:137], v36, s[52:55], s4 offen offset:0 sc1
    s_and_b32 s66, s62, 1
    buffer_load_dwordx2 v[138:139], v36, s[52:55], s4 offen offset:512 sc1
    s_mul_i32 s66, s66, 100480
    s_add_u32 s66, s66, 13696
    v_add_u32 v104, s66, v1
    ds_read_b128 v[72:75], v104 offset:0
    ds_read_b128 v[76:79], v104 offset:1024
    ds_read_b128 v[80:83], v104 offset:2048
    ds_read_b128 v[84:87], v104 offset:3072
    buffer_load_dwordx4 v[140:143], v1, s[52:55], s5 offen offset:0 sc1
    s_waitcnt lgkmcnt(0)
    s_cmp_lt_u32 s62, 2
    s_cselect_b64 exec, -1, 0
    v_pk_add_f32 v[40:41], v[40:41], v[72:73]
    v_pk_add_f32 v[42:43], v[42:43], v[74:75]
    v_pk_add_f32 v[44:45], v[44:45], v[76:77]
    v_pk_add_f32 v[46:47], v[46:47], v[78:79]
    v_pk_add_f32 v[48:49], v[48:49], v[80:81]
    v_pk_add_f32 v[50:51], v[50:51], v[82:83]
    v_pk_add_f32 v[52:53], v[52:53], v[84:85]
    v_pk_add_f32 v[54:55], v[54:55], v[86:87]
    s_mov_b64 exec, -1
    buffer_load_dwordx4 v[144:147], v1, s[52:55], s5 offen offset:1024 sc1
    s_mul_i32 s66, s62, 8320
    s_add_u32 s66, s66, 125056
    s_cmp_eq_u32 s62, 3
    s_cselect_b32 s66, 88064, s66
    buffer_load_dwordx4 v[148:151], v1, s[52:55], s5 offen offset:2048 sc1
    v_and_b32 v104, 31, v0
    v_lshlrev_b32 v104, 4, v104
    v_lshrrev_b32 v105, 5, v0
    v_lshl_add_u32 v106, v105, 9, v104
    v_lshl_add_u32 v107, v105, 10, v104
    s_add_u32 s67, s66, 3056
    buffer_load_dwordx4 v[152:155], v1, s[52:55], s5 offen offset:3072 sc1
    v_sub_u32 v106, s67, v106
    s_add_u32 s67, s66, 1520
    v_sub_u32 v107, s67, v107
    v_and_b32 v104, 1, v0
    v_cmp_eq_u32 vcc, 0, v104
    v_lshl_add_u32 v104, v0, 2, s66
    v_mov_b32 v105, 0
    s_mov_b64 exec, 0xffff
    ds_write_b32 v104, v105 offset:4096
    ds_write_b32 v104, v105 offset:8256
    s_mov_b64 exec, -1
    s_add_u32 s5, s5, 4096
    buffer_load_dwordx2 v[156:157], v36, s[52:55], s5 offen offset:0 sc1
    s_mov_b32 exec_hi, 0
    v_cvt_pk_bf16_f32 v56, v47, v46
    v_cvt_pk_bf16_f32 v57, v45, v44
    v_cvt_pk_bf16_f32 v58, v43, v42
    v_cvt_pk_bf16_f32 v59, v41, v40
    s_mov_b32 exec_lo, 0
    s_mov_b32 exec_hi, -1
    v_cvt_pk_bf16_f32 v56, v44, v43
    v_cvt_pk_bf16_f32 v57, v42, v42
    v_cvt_pk_bf16_f32 v58, v42, v41
    v_cvt_pk_bf16_f32 v59, v40, v40
    s_mov_b32 exec_lo, -1
    buffer_load_dwordx2 v[158:159], v36, s[52:55], s5 offen offset:512 sc1
    buffer_load_dwordx4 v[160:163], v1, s[52:55], s6 offen offset:0 sc1
    ds_write_b128 v106, v[56:59] offset:1024
    v_cvt_pk_bf16_f32 v60, v50, v50
    v_cvt_pk_bf16_f32 v61, v49, v49
    v_cvt_pk_bf16_f32 v62, v49, v48
    v_cvt_pk_bf16_f32 v63, v48, v48
    ds_write_b128 v106, v[60:63]
    v_cndmask_b32 v108, v53, v52, vcc
    buffer_load_dwordx4 v[164:167], v1, s[52:55], s6 offen offset:1024 sc1
    v_cvt_pk_bf16_f32 v64, v53, v53
    v_cvt_pk_bf16_f32 v65, v53, v108
    v_cvt_pk_bf16_f32 v66, v52, v52
    v_cvt_pk_bf16_f32 v67, v52, v52
    ds_write_b128 v107, v[64:67] offset:512
    v_cndmask_b32 v108, v55, v54, vcc
    v_cvt_pk_bf16_f32 v68, v55, v55
    v_cvt_pk_bf16_f32 v69, v55, v108
    buffer_load_dwordx4 v[168:171], v1, s[52:55], s6 offen offset:2048 sc1
    v_cvt_pk_bf16_f32 v70, v54, v54
    v_cvt_pk_bf16_f32 v71, v54, v54
    ds_write_b128 v107, v[68:71] offset:0
    v_add_u32 v104, s66, v1
    ds_read_b128 v[72:75], v104 offset:0
    ds_read_b32 v76, v104 offset:16
    ds_read_b128 v[80:83], v104 offset:1024
    buffer_load_dwordx4 v[172:175], v1, s[52:55], s6 offen offset:3072 sc1
    ds_read_b32 v84, v104 offset:1040
    ds_read_b128 v[88:91], v104 offset:2048
    ds_read_b32 v92, v104 offset:2064
    ds_read_b128 v[96:99], v104 offset:3072
    ds_read_b32 v100, v104 offset:3088
    s_waitcnt lgkmcnt(6)
    v_alignbit_b32 v72, v73, v72, 16
    v_alignbit_b32 v73, v74, v73, 16
    s_add_u32 s6, s6, 4096
    buffer_load_dwordx2 v[176:177], v36, s[52:55], s6 offen offset:0 sc1
    v_alignbit_b32 v74, v75, v74, 16
    v_alignbit_b32 v75, v76, v75, 16
    ds_write_b128 v104, v[72:75] offset:4160
    s_waitcnt lgkmcnt(5)
    v_alignbit_b32 v80, v81, v80, 16
    v_alignbit_b32 v81, v82, v81, 16
    v_alignbit_b32 v82, v83, v82, 16
    buffer_load_dwordx2 v[178:179], v36, s[52:55], s6 offen offset:512 sc1
    v_alignbit_b32 v83, v84, v83, 16
    ds_write_b128 v104, v[80:83] offset:5184
    s_waitcnt lgkmcnt(4)
    v_alignbit_b32 v88, v89, v88, 16
    v_alignbit_b32 v89, v90, v89, 16
    v_alignbit_b32 v90, v91, v90, 16
    v_alignbit_b32 v91, v92, v91, 16
    ds_write_b128 v104, v[88:91] offset:6208
    buffer_load_dwordx4 v[180:183], v1, s[52:55], s7 offen offset:0 sc1
    s_waitcnt lgkmcnt(3)
    v_alignbit_b32 v96, v97, v96, 16
    v_alignbit_b32 v97, v98, v97, 16
    v_alignbit_b32 v98, v99, v98, 16
    v_alignbit_b32 v99, v100, v99, 16
    ds_write_b128 v104, v[96:99] offset:7232
    buffer_load_dwordx4 v[184:187], v1, s[52:55], s7 offen offset:1024 sc1
    buffer_load_dwordx4 v[188:191], v1, s[52:55], s7 offen offset:2048 sc1
    buffer_load_dwordx4 v[192:195], v1, s[52:55], s7 offen offset:3072 sc1
    s_add_u32 s7, s7, 4096
    buffer_load_dwordx2 v[196:197], v36, s[52:55], s7 offen offset:0 sc1
    buffer_load_dwordx2 v[198:199], v36, s[52:55], s7 offen offset:512 sc1
    s_waitcnt vmcnt(24)
    v_cmp_ne_u64 vcc, s[64:65], v[206:207]
    s_cbranch_vccz L_chk_5_ok
    s_mov_b32 s82, 0
L_chk_5:
    s_sleep 1
    buffer_load_dwordx2 v[206:207], v204, s[52:55], s74 offen sc1
    s_add_u32 s82, s82, 1
    s_cmp_gt_u32 s82, 0x40000
    s_waitcnt vmcnt(0)
    s_cbranch_scc1 L_chk_5_ok
    v_cmp_ne_u64 vcc, s[64:65], v[206:207]
    s_cbranch_vccnz L_chk_5
L_chk_5_ok:
    s_barrier
    s_cmp_eq_u32 s77, 0
    s_cbranch_scc1 L_u_skip
    s_mul_i32 s67, s62, 4608
    s_add_u32 s67, s67, 150016
    s_add_u32 m0, s67, 480
    s_lshl_b32 s66, s76, 12
    s_add_u32 s66, s66, 16777216
    buffer_load_dwordx4 v1, s[52:55], s66 offen offset:0 sc1 lds
    buffer_load_dwordx4 v1, s[52:55], s66 offen offset:1024 sc1 lds
    buffer_load_dwordx4 v1, s[52:55], s66 offen offset:2048 sc1 lds
    buffer_load_dwordx4 v1, s[52:55], s66 offen offset:3072 sc1 lds
    v_add_u32 v222, s67, v36
    v_mov_b32 v224, 0
    v_mov_b32 v225, 0
    s_mov_b32 exec_hi, 0xfffffff
    ds_write_b64 v222, v[224:225]
    s_mov_b32 exec_hi, -1
    s_waitcnt lgkmcnt(0)
L_u_skip:
    s_add_u32 s89, s89, 4096
    buffer_load_dwordx4 a[148:151], v1, s[52:55], s89 offen offset:0 sc1
    s_mul_i32 s66, s62, 15360
    s_add_u32 s66, s66, 26112
    v_add_u32 v221, s66, v1
    s_waitcnt vmcnt(24)
    v_mfma_f32_16x16x32_bf16 v[40:43], a[0:3], v[120:123], 0
    v_mfma_f32_16x16x32_bf16 v[44:47], a[4:7], v[120:123], 0
    v_mfma_f32_16x16x32_bf16 v[48:51], a[8:11], v[120:123], 0
    v_mfma_f32_16x16x32_bf16 v[52:55], a[12:15], v[120:123], 0
    v_mfma_f32_16x16x32_bf16 v[56:59], a[16:19], v[120:123], 0
    s_waitcnt vmcnt(23)
    v_mfma_f32_16x16x32_bf16 v[40:43], a[20:23], v[124:127], v[40:43]
    v_mfma_f32_16x16x32_bf16 v[44:47], a[24:27], v[124:127], v[44:47]
    v_mfma_f32_16x16x32_bf16 v[48:51], a[28:31], v[124:127], v[48:51]
    v_mfma_f32_16x16x32_bf16 v[52:55], a[32:35], v[124:127], v[52:55]
    v_mfma_f32_16x16x32_bf16 v[56:59], a[36:39], v[124:127], v[56:59]
    s_waitcnt vmcnt(22)
    v_mfma_f32_16x16x32_bf16 v[40:43], a[40:43], v[128:131], v[40:43]
    v_mfma_f32_16x16x32_bf16 v[44:47], a[44:47], v[128:131], v[44:47]
    v_mfma_f32_16x16x32_bf16 v[48:51], a[48:51], v[128:131], v[48:51]
    v_mfma_f32_16x16x32_bf16 v[52:55], a[52:55], v[128:131], v[52:55]
    v_mfma_f32_16x16x32_bf16 v[56:59], a[56:59], v[128:131], v[56:59]
    s_waitcnt vmcnt(21)
    v_mfma_f32_16x16x32_bf16 v[40:43], a[60:63], v[132:135], v[40:43]
    v_mfma_f32_16x16x32_bf16 v[44:47], a[64:67], v[132:135], v[44:47]
    v_mfma_f32_16x16x32_bf16 v[48:51], a[68:71], v[132:135], v[48:51]
    v_mfma_f32_16x16x32_bf16 v[52:55], a[72:75], v[132:135], v[52:55]
    v_mfma_f32_16x16x32_bf16 v[56:59], a[76:79], v[132:135], v[56:59]
    s_waitcnt vmcnt(19)
    v_mfma_f32_16x16x32_bf16 v[40:43], a[80:83], v[136:139], v[40:43]
    v_mfma_f32_16x16x32_bf16 v[44:47], a[84:87], v[136:139], v[44:47]
    v_mfma_f32_16x16x32_bf16 v[48:51], a[88:91], v[136:139], v[48:51]
    v_mfma_f32_16x16x32_bf16 v[52:55], a[92:95], v[136:139], v[52:55]
    v_mfma_f32_16x16x32_bf16 v[56:59], a[96:99], v[136:139], v[56:59]
    s_waitcnt vmcnt(18)
    buffer_load_dwordx4 a[152:155], v1, s[52:55], s89 offen offset:1024 sc1
    v_mfma_f32_16x16x32_bf16 v[60:63], a[0:3], v[140:143], 0
    v_mfma_f32_16x16x32_bf16 v[64:67], a[4:7], v[140:143], 0
    v_mfma_f32_16x16x32_bf16 v[68:71], a[8:11], v[140:143], 0
    v_mfma_f32_16x16x32_bf16 v[72:75], a[12:15], v[140:143], 0
    s_add_u32 s66, s62, 1
    v_mfma_f32_16x16x32_bf16 v[76:79], a[16:19], v[140:143], 0
    s_waitcnt vmcnt(18)
    v_mfma_f32_16x16x32_bf16 v[60:63], a[20:23], v[144:147], v[60:63]
    s_and_b32 s66, s66, 3
    v_mfma_f32_16x16x32_bf16 v[64:67], a[24:27], v[144:147], v[64:67]
    buffer_load_dwordx4 a[156:159], v1, s[52:55], s89 offen offset:2048 sc1
    v_mfma_f32_16x16x32_bf16 v[68:71], a[28:31], v[144:147], v[68:71]
    s_mul_i32 s66, s66, 15360
    v_mfma_f32_16x16x32_bf16 v[72:75], a[32:35], v[144:147], v[72:75]
    v_mfma_f32_16x16x32_bf16 v[76:79], a[36:39], v[144:147], v[76:79]
    s_waitcnt vmcnt(18)
    v_mfma_f32_16x16x32_bf16 v[60:63], a[40:43], v[148:151], v[60:63]
    s_add_u32 s66, s66, 26112
    v_mfma_f32_16x16x32_bf16 v[64:67], a[44:47], v[148:151], v[64:67]
    v_mfma_f32_16x16x32_bf16 v[68:71], a[48:51], v[148:151], v[68:71]
    buffer_load_dwordx4 a[160:163], v1, s[52:55], s89 offen offset:3072 sc1
    v_add_u32 v220, s66, v1
    v_mfma_f32_16x16x32_bf16 v[72:75], a[52:55], v[148:151], v[72:75]
    v_mfma_f32_16x16x32_bf16 v[76:79], a[56:59], v[148:151], v[76:79]
    ds_write_b128 v220, v[40:43] offset:0
    s_waitcnt vmcnt(18)
    v_mfma_f32_16x16x32_bf16 v[60:63], a[60:63], v[152:155], v[60:63]
    v_mfma_f32_16x16x32_bf16 v[64:67], a[64:67], v[152:155], v[64:67]
    ds_write_b128 v220, v[44:47] offset:1024
    v_mfma_f32_16x16x32_bf16 v[68:71], a[68:71], v[152:155], v[68:71]
    v_mfma_f32_16x16x32_bf16 v[72:75], a[72:75], v[152:155], v[72:75]
    s_add_u32 s89, s89, 4096
    buffer_load_dwordx4 a[164:167], v1, s[52:55], s89 offen offset:0 sc1
    v_mfma_f32_16x16x32_bf16 v[76:79], a[76:79], v[152:155], v[76:79]
    ds_write_b128 v220, v[48:51] offset:2048
    s_waitcnt vmcnt(17)
    v_mfma_f32_16x16x32_bf16 v[60:63], a[80:83], v[156:159], v[60:63]
    v_mfma_f32_16x16x32_bf16 v[64:67], a[84:87], v[156:159], v[64:67]
    ds_write_b128 v220, v[52:55] offset:3072
    v_mfma_f32_16x16x32_bf16 v[68:71], a[88:91], v[156:159], v[68:71]
    v_mfma_f32_16x16x32_bf16 v[72:75], a[92:95], v[156:159], v[72:75]
    ds_write_b128 v220, v[56:59] offset:4096
    v_mfma_f32_16x16x32_bf16 v[76:79], a[96:99], v[156:159], v[76:79]
    s_waitcnt vmcnt(16)
    buffer_load_dwordx4 a[168:171], v1, s[52:55], s89 offen offset:1024 sc1
    v_mfma_f32_16x16x32_bf16 v[40:43], a[0:3], v[160:163], 0
    v_mfma_f32_16x16x32_bf16 v[44:47], a[4:7], v[160:163], 0
    v_mfma_f32_16x16x32_bf16 v[48:51], a[8:11], v[160:163], 0
    s_add_u32 s66, s62, 2
    v_mfma_f32_16x16x32_bf16 v[52:55], a[12:15], v[160:163], 0
    s_and_b32 s66, s66, 3
    s_mul_i32 s66, s66, 15360
    v_mfma_f32_16x16x32_bf16 v[56:59], a[16:19], v[160:163], 0
    s_add_u32 s66, s66, 31232
    s_waitcnt vmcnt(16)
    v_mfma_f32_16x16x32_bf16 v[40:43], a[20:23], v[164:167], v[40:43]
    v_add_u32 v220, s66, v1
    v_mfma_f32_16x16x32_bf16 v[44:47], a[24:27], v[164:167], v[44:47]
    buffer_load_dwordx4 a[172:175], v1, s[52:55], s89 offen offset:2048 sc1
    ds_write_b128 v220, v[60:63] offset:0
    ds_write_b128 v220, v[64:67] offset:1024
    v_mfma_f32_16x16x32_bf16 v[48:51], a[28:31], v[164:167], v[48:51]
    ds_write_b128 v220, v[68:71] offset:2048
    v_mfma_f32_16x16x32_bf16 v[52:55], a[32:35], v[164:167], v[52:55]
    ds_write_b128 v220, v[72:75] offset:3072
    v_mfma_f32_16x16x32_bf16 v[56:59], a[36:39], v[164:167], v[56:59]
    ds_write_b128 v220, v[76:79] offset:4096
    s_waitcnt vmcnt(16)
    v_mfma_f32_16x16x32_bf16 v[40:43], a[40:43], v[168:171], v[40:43]
    v_lshlrev_b32 v60, 16, v14
    v_and_b32 v61, 0xffff0000, v14
    v_mfma_f32_16x16x32_bf16 v[44:47], a[44:47], v[168:171], v[44:47]
    v_lshlrev_b32 v62, 16, v15
    v_mfma_f32_16x16x32_bf16 v[48:51], a[48:51], v[168:171], v[48:51]
    buffer_load_dwordx4 a[176:179], v1, s[52:55], s89 offen offset:3072 sc1
    v_and_b32 v63, 0xffff0000, v15
    v_mfma_f32_16x16x32_bf16 v[52:55], a[52:55], v[168:171], v[52:55]
    v_lshlrev_b32 v64, 16, v16
    v_and_b32 v65, 0xffff0000, v16
    v_mfma_f32_16x16x32_bf16 v[56:59], a[56:59], v[168:171], v[56:59]
    v_lshlrev_b32 v66, 16, v17
    s_waitcnt vmcnt(16)
    v_mfma_f32_16x16x32_bf16 v[40:43], a[60:63], v[172:175], v[40:43]
    v_and_b32 v67, 0xffff0000, v17
    v_mfma_f32_16x16x32_bf16 v[44:47], a[64:67], v[172:175], v[44:47]
    v_lshlrev_b32 v68, 16, v18
    v_and_b32 v69, 0xffff0000, v18
    v_mfma_f32_16x16x32_bf16 v[48:51], a[68:71], v[172:175], v[48:51]
    v_lshlrev_b32 v70, 16, v19
    v_mfma_f32_16x16x32_bf16 v[52:55], a[72:75], v[172:175], v[52:55]
    s_add_u32 s89, s89, 4096
    buffer_load_dwordx4 a[180:183], v1, s[52:55], s89 offen offset:0 sc1
    v_and_b32 v71, 0xffff0000, v19
    v_mfma_f32_16x16x32_bf16 v[56:59], a[76:79], v[172:175], v[56:59]
    v_lshlrev_b32 v72, 16, v20
    s_waitcnt vmcnt(15)
    v_mfma_f32_16x16x32_bf16 v[40:43], a[80:83], v[176:179], v[40:43]
    v_and_b32 v73, 0xffff0000, v20
    v_lshlrev_b32 v74, 16, v21
    v_mfma_f32_16x16x32_bf16 v[44:47], a[84:87], v[176:179], v[44:47]
    v_and_b32 v75, 0xffff0000, v21
    v_mfma_f32_16x16x32_bf16 v[48:51], a[88:91], v[176:179], v[48:51]
    v_lshlrev_b32 v76, 16, v22
    v_mfma_f32_16x16x32_bf16 v[52:55], a[92:95], v[176:179], v[52:55]
    v_and_b32 v77, 0xffff0000, v22
    v_lshlrev_b32 v78, 16, v23
    v_mfma_f32_16x16x32_bf16 v[56:59], a[96:99], v[176:179], v[56:59]
    v_and_b32 v79, 0xffff0000, v23
    s_waitcnt vmcnt(14)
    v_mfma_f32_16x16x32_bf16 v[60:63], a[0:3], v[180:183], v[60:63]
    v_mfma_f32_16x16x32_bf16 v[64:67], a[4:7], v[180:183], v[64:67]
    s_add_u32 s66, s62, 3
    s_and_b32 s66, s66, 3
    v_mfma_f32_16x16x32_bf16 v[68:71], a[8:11], v[180:183], v[68:71]
    s_mul_i32 s66, s66, 15360
    s_add_u32 s66, s66, 36352
    v_mfma_f32_16x16x32_bf16 v[72:75], a[12:15], v[180:183], v[72:75]
    v_add_u32 v220, s66, v1
    ds_write_b128 v220, v[40:43] offset:0
    ds_write_b128 v220, v[44:47] offset:1024
    v_mfma_f32_16x16x32_bf16 v[76:79], a[16:19], v[180:183], v[76:79]
    ds_write_b128 v220, v[48:51] offset:2048
    ds_write_b128 v220, v[52:55] offset:3072
    s_waitcnt vmcnt(13)
    v_mfma_f32_16x16x32_bf16 v[60:63], a[20:23], v[184:187], v[60:63]
    ds_write_b128 v220, v[56:59] offset:4096
    s_lshl_b32 s4, s61, 2
    v_mfma_f32_16x16x32_bf16 v[64:67], a[24:27], v[184:187], v[64:67]
    s_add_u32 s4, s4, s62
    s_mul_i32 s4, s4, 20
    v_mfma_f32_16x16x32_bf16 v[68:71], a[28:31], v[184:187], v[68:71]
    s_lshr_b32 s5, s60, 1
    s_mul_i32 s5, s5, 5
    v_mfma_f32_16x16x32_bf16 v[72:75], a[32:35], v[184:187], v[72:75]
    s_add_u32 s4, s4, s5
    s_lshl_b32 s4, s4, 10
    v_mfma_f32_16x16x32_bf16 v[76:79], a[36:39], v[184:187], v[76:79]
    s_add_u32 s4, s4, 7864320
    s_and_b32 s7, s60, 1
    s_lshl_b32 s5, s7, 11
    s_waitcnt vmcnt(12)
    v_mfma_f32_16x16x32_bf16 v[60:63], a[40:43], v[188:191], v[60:63]
    s_add_u32 s5, s5, s4
    s_lshl_b32 s6, s7, 9
    v_mfma_f32_16x16x32_bf16 v[64:67], a[44:47], v[188:191], v[64:67]
    s_add_u32 s6, s6, s4
    s_add_u32 s6, s6, 4096
    v_mfma_f32_16x16x32_bf16 v[68:71], a[48:51], v[188:191], v[68:71]
    v_mfma_f32_16x16x32_bf16 v[72:75], a[52:55], v[188:191], v[72:75]
    v_mfma_f32_16x16x32_bf16 v[76:79], a[56:59], v[188:191], v[76:79]
    s_waitcnt vmcnt(8)
    s_waitcnt lgkmcnt(0)
    s_barrier
    buffer_load_dwordx4 a[184:187], v1, s[52:55], s89 offen offset:1024 sc1
    v_mfma_f32_16x16x32_bf16 v[60:63], a[60:63], v[192:195], v[60:63]
    ds_read_b128 v[80:83], v221 offset:0
    ds_read_b128 v[84:87], v221 offset:1024
    v_mfma_f32_16x16x32_bf16 v[64:67], a[64:67], v[192:195], v[64:67]
    ds_read_b128 v[88:91], v221 offset:2048
    v_mfma_f32_16x16x32_bf16 v[68:71], a[68:71], v[192:195], v[68:71]
    buffer_load_dwordx4 a[188:191], v1, s[52:55], s89 offen offset:2048 sc1
    ds_read_b128 v[92:95], v221 offset:3072
    ds_read_b128 v[96:99], v221 offset:4096
    v_mfma_f32_16x16x32_bf16 v[72:75], a[72:75], v[192:195], v[72:75]
    ds_read_b128 v[100:103], v221 offset:5120
    v_mfma_f32_16x16x32_bf16 v[76:79], a[76:79], v[192:195], v[76:79]
    buffer_load_dwordx4 a[192:195], v1, s[52:55], s89 offen offset:3072 sc1
    ds_read_b128 v[104:107], v221 offset:6144
    ds_read_b128 v[108:111], v221 offset:7168
    v_mfma_f32_16x16x32_bf16 v[60:63], a[80:83], v[196:199], v[60:63]
    ds_read_b128 v[112:115], v221 offset:8192
    v_mfma_f32_16x16x32_bf16 v[64:67], a[84:87], v[196:199], v[64:67]
    ds_read_b128 v[116:119], v221 offset:9216
    ds_read_b128 v[120:123], v221 offset:10240
    v_mfma_f32_16x16x32_bf16 v[68:71], a[88:91], v[196:199], v[68:71]
    s_add_u32 s89, s89, 4096
    buffer_load_dwordx4 a[196:199], v1, s[52:55], s89 offen offset:0 sc1
    ds_read_b128 v[124:127], v221 offset:11264
    v_mfma_f32_16x16x32_bf16 v[72:75], a[92:95], v[196:199], v[72:75]
    ds_read_b128 v[128:131], v221 offset:12288
    ds_read_b128 v[132:135], v221 offset:13312
    v_mfma_f32_16x16x32_bf16 v[76:79], a[96:99], v[196:199], v[76:79]
    buffer_load_dwordx4 a[200:203], v1, s[52:55], s89 offen offset:1024 sc1
    ds_read_b128 v[136:139], v221 offset:14336
    s_waitcnt lgkmcnt(5)
    v_pk_add_f32 v[80:81], v[80:81], v[100:101]
    v_pk_add_f32 v[82:83], v[82:83], v[102:103]
    v_pk_add_f32 v[84:85], v[84:85], v[104:105]
    v_pk_add_f32 v[86:87], v[86:87], v[106:107]
    v_pk_add_f32 v[88:89], v[88:89], v[108:109]
    v_pk_add_f32 v[90:91], v[90:91], v[110:111]
    v_pk_add_f32 v[92:93], v[92:93], v[112:113]
    v_pk_add_f32 v[94:95], v[94:95], v[114:115]
    v_pk_add_f32 v[96:97], v[96:97], v[116:117]
    v_pk_add_f32 v[98:99], v[98:99], v[118:119]
    s_waitcnt lgkmcnt(0)
    s_barrier
    v_pk_add_f32 v[60:61], v[60:61], v[120:121]
    v_pk_add_f32 v[62:63], v[62:63], v[122:123]
    v_pk_add_f32 v[64:65], v[64:65], v[124:125]
    v_pk_add_f32 v[66:67], v[66:67], v[126:127]
    v_pk_add_f32 v[68:69], v[68:69], v[128:129]
    v_pk_add_f32 v[70:71], v[70:71], v[130:131]
    v_pk_add_f32 v[72:73], v[72:73], v[132:133]
    v_pk_add_f32 v[74:75], v[74:75], v[134:135]
    v_pk_add_f32 v[76:77], v[76:77], v[136:137]
    v_pk_add_f32 v[78:79], v[78:79], v[138:139]
    v_pk_add_f32 v[60:61], v[60:61], v[80:81]
    v_pk_add_f32 v[62:63], v[62:63], v[82:83]
    v_pk_add_f32 v[64:65], v[64:65], v[84:85]
    v_pk_add_f32 v[66:67], v[66:67], v[86:87]
    v_cvt_pk_bf16_f32 v14, v60, v61
    v_cvt_pk_bf16_f32 v15, v62, v63
    v_cvt_pk_bf16_f32 v16, v64, v65
    v_cvt_pk_bf16_f32 v17, v66, v67
    buffer_store_dwordx4 v[14:17], v1, s[52:55], s5 offen offset:0 sc1
    v_pk_add_f32 v[68:69], v[68:69], v[88:89]
    v_pk_add_f32 v[70:71], v[70:71], v[90:91]
    v_pk_add_f32 v[72:73], v[72:73], v[92:93]
    v_pk_add_f32 v[74:75], v[74:75], v[94:95]
    v_cvt_pk_bf16_f32 v18, v68, v69
    v_cvt_pk_bf16_f32 v19, v70, v71
    v_cvt_pk_bf16_f32 v20, v72, v73
    v_cvt_pk_bf16_f32 v21, v74, v75
    buffer_store_dwordx4 v[18:21], v1, s[52:55], s5 offen offset:1024 sc1
    v_pk_add_f32 v[76:77], v[76:77], v[96:97]
    v_pk_add_f32 v[78:79], v[78:79], v[98:99]
    v_cvt_pk_bf16_f32 v22, v76, v77
    v_cvt_pk_bf16_f32 v23, v78, v79
    buffer_store_dwordx2 v[22:23], v36, s[52:55], s6 offen sc1
    v_mov_b32 v222, 0
    v_mov_b32 v223, 0
    v_mov_b32 v224, 0x3f803f80
    v_dot2c_f32_bf16 v222, v14, v224
    v_dot2c_f32_bf16 v223, v14, v14
    v_dot2c_f32_bf16 v222, v15, v224
    v_dot2c_f32_bf16 v223, v15, v15
    v_dot2c_f32_bf16 v222, v16, v224
    v_dot2c_f32_bf16 v223, v16, v16
    v_dot2c_f32_bf16 v222, v17, v224
    v_dot2c_f32_bf16 v223, v17, v17
    v_dot2c_f32_bf16 v222, v18, v224
    v_dot2c_f32_bf16 v223, v18, v18
    v_dot2c_f32_bf16 v222, v19, v224
    v_dot2c_f32_bf16 v223, v19, v19
    v_dot2c_f32_bf16 v222, v20, v224
    v_dot2c_f32_bf16 v223, v20, v20
    v_dot2c_f32_bf16 v222, v21, v224
    v_dot2c_f32_bf16 v223, v21, v21
    v_dot2c_f32_bf16 v222, v22, v224
    v_dot2c_f32_bf16 v223, v22, v22
    v_dot2c_f32_bf16 v222, v23, v224
    v_dot2c_f32_bf16 v223, v23, v23
    s_lshl_b32 s66, s61, 3
    s_add_u32 s66, s66, s60
    s_lshl_b32 s66, s66, 2
    s_add_u32 s66, s66, s62
    s_lshl_b32 s66, s66, 7
    s_add_u32 s66, s66, 655360
    v_mov_b32 v226, v222
    v_mov_b32 v227, v223
    s_nop 0
    v_permlane16_swap_b32 v222, v226
    v_permlane16_swap_b32 v223, v227
    v_add_f32 v222, v222, v226
    v_add_f32 v223, v223, v227
    v_mov_b32 v226, v222
    v_mov_b32 v227, v223
    s_nop 0
    v_permlane32_swap_b32 v222, v226
    v_permlane32_swap_b32 v223, v227
    v_add_f32 v222, v222, v226
    v_add_f32 v223, v223, v227
    s_mov_b64 exec, 0xffff
    buffer_store_dwordx2 v[222:223], v36, s[52:55], s66 offen sc1
    s_mov_b64 exec, -1
    v_and_b32 v148, 1, v0
    v_xor_b32 v148, 1, v148
    v_mul_u32_u24 v148, 4160, v148
    v_and_b32 v149, 14, v0
    v_lshlrev_b32 v149, 1, v149
    v_sub_u32 v148, v148, v149
    v_lshl_add_u32 v136, v3, 4, v148
    v_lshlrev_b32 v148, 5, v2
    v_lshl_add_u32 v137, v3, 4, v148
    s_mul_i32 s12, s62, 8320
    s_mul_i32 s13, s62, 4608
    s_add_u32 s12, s12, 128604
    s_add_u32 s13, s13, 150464
    s_cmp_eq_u32 s62, 3
    s_cselect_b32 s12, 128220, s12
    s_cselect_b32 s13, 150080, s13
    v_add_u32 v152, s12, v136
    v_add_u32 v160, s13, v137
    v_subrev_u32 v153, 1024, v152
    v_subrev_u32 v154, 2048, v152
    v_subrev_u32 v155, 3072, v152
    ds_read_b128 v[132:135], v160 offset:3584
    ds_read2_b32 v[72:73], v152 offset0:128 offset1:129
    ds_read2_b32 v[74:75], v152 offset0:130 offset1:131
    ds_read_b128 v[128:131], v160 offset:3072
    ds_read2_b32 v[76:77], v152 offset0:0 offset1:1
    ds_read2_b32 v[78:79], v152 offset0:2 offset1:3
    ds_read_b128 v[124:127], v160 offset:2560
    ds_read2_b32 v[80:81], v153 offset0:128 offset1:129
    ds_read2_b32 v[82:83], v153 offset0:130 offset1:131
    ds_read_b128 v[120:123], v160 offset:2048
    ds_read2_b32 v[84:85], v153 offset0:0 offset1:1
    ds_read2_b32 v[86:87], v153 offset0:2 offset1:3
    ds_read_b128 v[116:119], v160 offset:1536
    ds_read2_b32 v[88:89], v154 offset0:128 offset1:129
    ds_read2_b32 v[90:91], v154 offset0:130 offset1:131
    ds_read_b128 v[112:115], v160 offset:1024
    ds_read2_b32 v[92:93], v154 offset0:0 offset1:1
    ds_read2_b32 v[94:95], v154 offset0:2 offset1:3
    ds_read_b128 v[108:111], v160 offset:512
    ds_read2_b32 v[96:97], v155 offset0:128 offset1:129
    ds_read2_b32 v[98:99], v155 offset0:130 offset1:131
    ds_read_b128 v[104:107], v160 offset:0
    ds_read2_b32 v[100:101], v155 offset0:0 offset1:1
    ds_read2_b32 v[102:103], v155 offset0:2 offset1:3
    s_cmp_eq_u32 s62, 3
    s_cselect_b32 s79, 0, s79
    v_add_u32 v148, 16, v2
    v_lshlrev_b32 v149, 3, v3
    v_sub_u32 v148, v148, v149
    v_and_b32 v149, 1, v148
    v_lshlrev_b32 v149, 4, v149
    v_lshlrev_b32 v149, v149, s79
    v_lshrrev_b32 v148, 1, v148
    v_cmp_eq_u32 vcc, 0, v148
    s_nop 1
    v_cndmask_b32 v144, 0, v149, vcc
    v_cmp_eq_u32 vcc, 1, v148
    s_nop 1
    v_cndmask_b32 v145, 0, v149, vcc
    v_cmp_eq_u32 vcc, 2, v148
    s_nop 1
    v_cndmask_b32 v146, 0, v149, vcc
    v_cmp_eq_u32 vcc, 3, v148
    s_nop 1
    v_cndmask_b32 v147, 0, v149, vcc
    s_waitcnt lgkmcnt(15)
    s_nop 0
    v_mfma_f32_16x16x32_bf16 v[68:71], v[144:147], v[132:135], 0
    s_mul_i32 s12, s62, 8320
    s_mul_i32 s13, s62, 4608
    v_mfma_f32_16x16x32_bf16 v[68:71], v[72:75], v[132:135], v[68:71]
    s_add_u32 s12, s12, 128540
    s_add_u32 s13, s13, 150400
    v_mfma_f32_16x16x32_bf16 v[64:67], v[144:147], v[128:131], 0
    buffer_load_dwordx4 a[204:207], v1, s[52:55], s89 offen offset:2048 sc1
    s_cmp_eq_u32 s62, 3
    s_cselect_b32 s12, 128156, s12
    s_cselect_b32 s13, 150016, s13
    v_mfma_f32_16x16x32_bf16 v[64:67], v[72:75], v[128:131], v[64:67]
    v_add_u32 v156, s12, v136
    s_waitcnt lgkmcnt(14)
    v_mfma_f32_16x16x32_bf16 v[60:63], v[144:147], v[124:127], 0
    v_add_u32 v161, s13, v137
    v_subrev_u32 v157, 1024, v156
    v_mfma_f32_16x16x32_bf16 v[60:63], v[72:75], v[124:127], v[60:63]
    v_subrev_u32 v158, 2048, v156
    v_subrev_u32 v159, 3072, v156
    v_mfma_f32_16x16x32_bf16 v[56:59], v[144:147], v[120:123], 0
    buffer_load_dwordx4 a[208:211], v1, s[52:55], s89 offen offset:3072 sc1
    ds_read_b128 v[176:179], v161 offset:1536
    v_mfma_f32_16x16x32_bf16 v[56:59], v[72:75], v[120:123], v[56:59]
    s_waitcnt lgkmcnt(9)
    v_mfma_f32_16x16x32_bf16 v[52:55], v[144:147], v[116:119], 0
    ds_read_b128 v[172:175], v161 offset:1024
    v_mfma_f32_16x16x32_bf16 v[52:55], v[72:75], v[116:119], v[52:55]
    ds_read_b128 v[168:171], v161 offset:512
    v_mfma_f32_16x16x32_bf16 v[48:51], v[144:147], v[112:115], 0
    s_add_u32 s89, s89, 4096
    buffer_load_dwordx4 a[212:215], v1, s[52:55], s89 offen offset:0 sc1
    ds_read_b128 v[164:167], v161 offset:0
    v_mfma_f32_16x16x32_bf16 v[48:51], v[72:75], v[112:115], v[48:51]
    s_waitcnt lgkmcnt(6)
    v_mfma_f32_16x16x32_bf16 v[44:47], v[144:147], v[108:111], 0
    v_mfma_f32_16x16x32_bf16 v[44:47], v[72:75], v[108:111], v[44:47]
    v_mfma_f32_16x16x32_bf16 v[40:43], v[144:147], v[104:107], 0
    buffer_load_dwordx4 a[216:219], v1, s[52:55], s89 offen offset:1024 sc1
    v_mfma_f32_16x16x32_bf16 v[40:43], v[72:75], v[104:107], v[40:43]
    v_mfma_f32_16x16x32_bf16 v[68:71], v[76:79], v[128:131], v[68:71]
    ds_read_b128 v[132:135], v161 offset:3584
    v_mfma_f32_16x16x32_bf16 v[64:67], v[76:79], v[124:127], v[64:67]
    ds_read2_b32 v[72:73], v156 offset0:128 offset1:129
    v_mfma_f32_16x16x32_bf16 v[60:63], v[76:79], v[120:123], v[60:63]
    buffer_load_dwordx4 a[220:223], v1, s[52:55], s89 offen offset:2048 sc1
    ds_read2_b32 v[74:75], v156 offset0:130 offset1:131
    v_mfma_f32_16x16x32_bf16 v[56:59], v[76:79], v[116:119], v[56:59]
    v_mfma_f32_16x16x32_bf16 v[52:55], v[76:79], v[112:115], v[52:55]
    v_mfma_f32_16x16x32_bf16 v[48:51], v[76:79], v[108:111], v[48:51]
    v_mfma_f32_16x16x32_bf16 v[44:47], v[76:79], v[104:107], v[44:47]
    buffer_load_dwordx4 a[224:227], v1, s[52:55], s89 offen offset:3072 sc1
    ds_read_b128 v[128:131], v161 offset:3072
    v_mfma_f32_16x16x32_bf16 v[68:71], v[80:83], v[124:127], v[68:71]
    ds_read2_b32 v[76:77], v156 offset0:0 offset1:1
    v_mfma_f32_16x16x32_bf16 v[64:67], v[80:83], v[120:123], v[64:67]
    ds_read2_b32 v[78:79], v156 offset0:2 offset1:3
    v_mfma_f32_16x16x32_bf16 v[60:63], v[80:83], v[116:119], v[60:63]
    v_mfma_f32_16x16x32_bf16 v[56:59], v[80:83], v[112:115], v[56:59]
    s_add_u32 s89, s89, 4096
    buffer_load_dwordx4 a[228:231], v1, s[52:55], s89 offen offset:0 sc1
    v_mfma_f32_16x16x32_bf16 v[52:55], v[80:83], v[108:111], v[52:55]
    v_mfma_f32_16x16x32_bf16 v[48:51], v[80:83], v[104:107], v[48:51]
    v_mfma_f32_16x16x32_bf16 v[68:71], v[84:87], v[120:123], v[68:71]
    ds_read_b128 v[124:127], v161 offset:2560
    v_mfma_f32_16x16x32_bf16 v[64:67], v[84:87], v[116:119], v[64:67]
    s_waitcnt vmcnt(7)
    s_lshl_b32 s66, s61, 3
    s_add_u32 s66, s66, s60
    s_lshl_b32 s66, s66, 2
    s_add_u32 s66, s66, s62
    s_lshl_b32 s66, s66, 7
    s_add_u32 s66, s66, 282624
    s_mov_b64 exec, 65535
    buffer_store_dwordx2 v[38:39], v36, s[52:55], s66 offen sc1
    s_mov_b64 exec, -1
    buffer_load_dwordx4 a[232:235], v1, s[52:55], s89 offen offset:1024 sc1
    ds_read2_b32 v[80:81], v157 offset0:128 offset1:129
    v_mfma_f32_16x16x32_bf16 v[60:63], v[84:87], v[112:115], v[60:63]
    ds_read2_b32 v[82:83], v157 offset0:130 offset1:131
    v_mfma_f32_16x16x32_bf16 v[56:59], v[84:87], v[108:111], v[56:59]
    v_mfma_f32_16x16x32_bf16 v[52:55], v[84:87], v[104:107], v[52:55]
    buffer_load_dwordx4 a[236:239], v1, s[52:55], s89 offen offset:2048 sc1
    ds_read_b128 v[120:123], v161 offset:2048
    v_mfma_f32_16x16x32_bf16 v[68:71], v[88:91], v[116:119], v[68:71]
    ds_read2_b32 v[84:85], v157 offset0:0 offset1:1
    v_mfma_f32_16x16x32_bf16 v[64:67], v[88:91], v[112:115], v[64:67]
    ds_read2_b32 v[86:87], v157 offset0:2 offset1:3
    v_mfma_f32_16x16x32_bf16 v[60:63], v[88:91], v[108:111], v[60:63]
    v_mfma_f32_16x16x32_bf16 v[56:59], v[88:91], v[104:107], v[56:59]
    buffer_load_dwordx4 a[240:243], v1, s[52:55], s89 offen offset:3072 sc1
    v_mfma_f32_16x16x32_bf16 v[68:71], v[92:95], v[112:115], v[68:71]
    ds_read2_b32 v[88:89], v158 offset0:128 offset1:129
    v_mfma_f32_16x16x32_bf16 v[64:67], v[92:95], v[108:111], v[64:67]
    ds_read2_b32 v[90:91], v158 offset0:130 offset1:131
    v_mfma_f32_16x16x32_bf16 v[60:63], v[92:95], v[104:107], v[60:63]
    ds_read2_b32 v[92:93], v158 offset0:0 offset1:1
    v_mfma_f32_16x16x32_bf16 v[68:71], v[96:99], v[108:111], v[68:71]
    s_add_u32 s89, s89, 4096
    buffer_load_dwordx4 a[244:247], v1, s[52:55], s89 offen offset:0 sc1
    ds_read2_b32 v[94:95], v158 offset0:2 offset1:3
    v_mfma_f32_16x16x32_bf16 v[64:67], v[96:99], v[104:107], v[64:67]
    s_waitcnt lgkmcnt(15)
    v_mfma_f32_16x16x32_bf16 v[68:71], v[100:103], v[104:107], v[68:71]
    s_waitcnt lgkmcnt(12)
    v_mfma_f32_16x16x32_bf16 v[68:71], v[72:75], v[132:135], v[68:71]
    buffer_load_dwordx4 a[248:251], v1, s[52:55], s89 offen offset:1024 sc1
    s_mul_i32 s12, s62, 8320
    s_mul_i32 s13, s62, 4608
    v_mfma_f32_16x16x32_bf16 v[64:67], v[72:75], v[128:131], v[64:67]
    s_add_u32 s12, s12, 128476
    s_waitcnt lgkmcnt(6)
    v_mfma_f32_16x16x32_bf16 v[60:63], v[72:75], v[124:127], v[60:63]
    s_add_u32 s13, s13, 150336
    v_mfma_f32_16x16x32_bf16 v[56:59], v[72:75], v[120:123], v[56:59]
    v_mfma_f32_16x16x32_bf16 v[52:55], v[72:75], v[176:179], v[52:55]
    buffer_load_dwordx4 a[252:255], v1, s[52:55], s89 offen offset:2048 sc1
    s_cmp_eq_u32 s62, 3
    s_cselect_b32 s12, 136540, s12
    s_cselect_b32 s13, 154688, s13
    v_mfma_f32_16x16x32_bf16 v[48:51], v[72:75], v[172:175], v[48:51]
    v_add_u32 v152, s12, v136
    v_mfma_f32_16x16x32_bf16 v[44:47], v[72:75], v[168:171], v[44:47]
    v_add_u32 v160, s13, v137
    v_subrev_u32 v153, 1024, v152
    v_mfma_f32_16x16x32_bf16 v[40:43], v[72:75], v[164:167], v[40:43]
    v_subrev_u32 v154, 2048, v152
    v_mfma_f32_16x16x32_bf16 v[68:71], v[76:79], v[128:131], v[68:71]
    buffer_load_dwordx4 a[0:3], v1, s[52:55], s89 offen offset:3072 sc1
    v_subrev_u32 v155, 3072, v152
    v_mfma_f32_16x16x32_bf16 v[64:67], v[76:79], v[124:127], v[64:67]
    ds_read2_b32 v[96:97], v159 offset0:128 offset1:129
    v_mfma_f32_16x16x32_bf16 v[60:63], v[76:79], v[120:123], v[60:63]
    ds_read2_b32 v[98:99], v159 offset0:130 offset1:131
    v_mfma_f32_16x16x32_bf16 v[56:59], v[76:79], v[176:179], v[56:59]
    s_add_u32 s89, s89, 4096
    buffer_load_dwordx4 a[4:7], v1, s[52:55], s89 offen offset:0 sc1
    ds_read2_b32 v[100:101], v159 offset0:0 offset1:1
    v_mfma_f32_16x16x32_bf16 v[52:55], v[76:79], v[172:175], v[52:55]
    ds_read2_b32 v[102:103], v159 offset0:2 offset1:3
    v_mfma_f32_16x16x32_bf16 v[48:51], v[76:79], v[168:171], v[48:51]
    ds_read_b128 v[116:119], v160 offset:1536
    v_mfma_f32_16x16x32_bf16 v[44:47], v[76:79], v[164:167], v[44:47]
    ds_read_b128 v[112:115], v160 offset:1024
    v_mfma_f32_16x16x32_bf16 v[68:71], v[80:83], v[124:127], v[68:71]
    buffer_load_dwordx4 a[8:11], v1, s[52:55], s89 offen offset:1024 sc1
    ds_read_b128 v[108:111], v160 offset:512
    v_mfma_f32_16x16x32_bf16 v[64:67], v[80:83], v[120:123], v[64:67]
    ds_read_b128 v[104:107], v160 offset:0
    v_mfma_f32_16x16x32_bf16 v[60:63], v[80:83], v[176:179], v[60:63]
    ds_read_b128 v[132:135], v160 offset:3584
    v_mfma_f32_16x16x32_bf16 v[56:59], v[80:83], v[172:175], v[56:59]
    ds_read2_b32 v[72:73], v152 offset0:128 offset1:129
    v_mfma_f32_16x16x32_bf16 v[52:55], v[80:83], v[168:171], v[52:55]
    buffer_load_dwordx4 a[12:15], v1, s[52:55], s89 offen offset:2048 sc1
    ds_read2_b32 v[74:75], v152 offset0:130 offset1:131
    v_mfma_f32_16x16x32_bf16 v[48:51], v[80:83], v[164:167], v[48:51]
    s_waitcnt lgkmcnt(13)
    v_mfma_f32_16x16x32_bf16 v[68:71], v[84:87], v[120:123], v[68:71]
    ds_read_b128 v[128:131], v160 offset:3072
    v_mfma_f32_16x16x32_bf16 v[64:67], v[84:87], v[176:179], v[64:67]
    buffer_load_dwordx4 a[16:19], v1, s[52:55], s89 offen offset:3072 sc1
    ds_read2_b32 v[76:77], v152 offset0:0 offset1:1
    v_mfma_f32_16x16x32_bf16 v[60:63], v[84:87], v[172:175], v[60:63]
    ds_read2_b32 v[78:79], v152 offset0:2 offset1:3
    v_mfma_f32_16x16x32_bf16 v[56:59], v[84:87], v[168:171], v[56:59]
    ds_read_b128 v[124:127], v160 offset:2560
    v_mfma_f32_16x16x32_bf16 v[52:55], v[84:87], v[164:167], v[52:55]
    ds_read2_b32 v[80:81], v153 offset0:128 offset1:129
    v_mfma_f32_16x16x32_bf16 v[68:71], v[88:91], v[176:179], v[68:71]
    s_add_u32 s89, s89, 4096
    buffer_load_dwordx4 a[20:23], v1, s[52:55], s89 offen offset:0 sc1
    ds_read2_b32 v[82:83], v153 offset0:130 offset1:131
    v_mfma_f32_16x16x32_bf16 v[64:67], v[88:91], v[172:175], v[64:67]
    ds_read_b128 v[120:123], v160 offset:2048
    v_mfma_f32_16x16x32_bf16 v[60:63], v[88:91], v[168:171], v[60:63]
    ds_read2_b32 v[84:85], v153 offset0:0 offset1:1
    v_mfma_f32_16x16x32_bf16 v[56:59], v[88:91], v[164:167], v[56:59]
    s_waitcnt lgkmcnt(15)
    v_mfma_f32_16x16x32_bf16 v[68:71], v[92:95], v[172:175], v[68:71]
    buffer_load_dwordx4 a[24:27], v1, s[52:55], s89 offen offset:1024 sc1
    ds_read2_b32 v[86:87], v153 offset0:2 offset1:3
    v_mfma_f32_16x16x32_bf16 v[64:67], v[92:95], v[168:171], v[64:67]
    ds_read2_b32 v[88:89], v154 offset0:128 offset1:129
    v_mfma_f32_16x16x32_bf16 v[60:63], v[92:95], v[164:167], v[60:63]
    ds_read2_b32 v[90:91], v154 offset0:130 offset1:131
    v_mfma_f32_16x16x32_bf16 v[68:71], v[96:99], v[168:171], v[68:71]
    buffer_load_dwordx4 a[28:31], v1, s[52:55], s89 offen offset:2048 sc1
    ds_read2_b32 v[92:93], v154 offset0:0 offset1:1
    v_mfma_f32_16x16x32_bf16 v[64:67], v[96:99], v[164:167], v[64:67]
    v_mfma_f32_16x16x32_bf16 v[68:71], v[100:103], v[164:167], v[68:71]
    s_cmp_eq_u32 s62, 3
    s_cbranch_scc0 L_cfl_6
    v_add_u32 v148, 88064, v1
    ds_write_b128 v148, v[40:43] offset:0
    ds_write_b128 v148, v[44:47] offset:1024
    ds_write_b128 v148, v[48:51] offset:2048
    ds_write_b128 v148, v[52:55] offset:3072
    ds_write_b128 v148, v[56:59] offset:4096
    ds_write_b128 v148, v[60:63] offset:5120
    ds_write_b128 v148, v[64:67] offset:6144
    ds_write_b128 v148, v[68:71] offset:7168
    v_mov_b64 v[40:41], 0
    v_mov_b64 v[42:43], 0
    v_mov_b64 v[44:45], 0
    v_mov_b64 v[46:47], 0
    v_mov_b64 v[48:49], 0
    v_mov_b64 v[50:51], 0
    v_mov_b64 v[52:53], 0
    v_mov_b64 v[54:55], 0
    v_mov_b64 v[56:57], 0
    v_mov_b64 v[58:59], 0
    v_mov_b64 v[60:61], 0
    v_mov_b64 v[62:63], 0
    v_mov_b64 v[64:65], 0
    v_mov_b64 v[66:67], 0
    v_mov_b64 v[68:69], 0
    v_mov_b64 v[70:71], 0
L_cfl_6:
    s_waitcnt lgkmcnt(11)
    s_nop 0
    v_mfma_f32_16x16x32_bf16 v[68:71], v[72:75], v[132:135], v[68:71]
    ds_read2_b32 v[94:95], v154 offset0:2 offset1:3
    v_mfma_f32_16x16x32_bf16 v[64:67], v[72:75], v[128:131], v[64:67]
    buffer_load_dwordx4 a[32:35], v1, s[52:55], s89 offen offset:3072 sc1
    s_waitcnt lgkmcnt(6)
    v_mfma_f32_16x16x32_bf16 v[60:63], v[72:75], v[124:127], v[60:63]
    ds_read2_b32 v[96:97], v155 offset0:128 offset1:129
    v_mfma_f32_16x16x32_bf16 v[56:59], v[72:75], v[120:123], v[56:59]
    v_mfma_f32_16x16x32_bf16 v[52:55], v[72:75], v[116:119], v[52:55]
    ds_read2_b32 v[98:99], v155 offset0:130 offset1:131
    v_mfma_f32_16x16x32_bf16 v[48:51], v[72:75], v[112:115], v[48:51]
    s_max_u32 s74, s60, 1
    s_sub_u32 s74, s74, 1
    s_add_u32 s9, s60, 1
    s_min_u32 s9, s9, 7
    s_sub_u32 s9, s9, s74
    s_lshl_b32 s9, s9, 12
    s_lshl_b32 s74, s74, 12
    s_add_u32 s74, s74, 4096
    s_add_u32 s74, s74, s100
    v_lshrrev_b32 v205, 5, v0
    v_bfe_u32 v204, v0, 2, 3
    v_lshlrev_b32 v204, 7, v204
    v_mad_u32_u24 v204, v205, s9, v204
    buffer_load_dwordx2 v[206:207], v204, s[52:55], s74 offen sc1
    s_lshl_b32 s75, s61, 2
    s_add_u32 s75, s75, s62
    s_lshl_b32 s75, s75, 10
    s_add_u32 s75, s75, 282624
    v_lshrrev_b32 v200, 3, v0
    v_lshlrev_b32 v200, 7, v200
    buffer_load_dwordx2 v[202:203], v200, s[52:55], s75 offen sc1
    s_add_u32 s89, s89, 4096
    buffer_load_dwordx4 a[36:39], v1, s[52:55], s89 offen offset:0 sc1
    v_mfma_f32_16x16x32_bf16 v[44:47], v[72:75], v[108:111], v[44:47]
    ds_read2_b32 v[100:101], v155 offset0:0 offset1:1
    v_mfma_f32_16x16x32_bf16 v[40:43], v[72:75], v[104:107], v[40:43]
    v_mfma_f32_16x16x32_bf16 v[68:71], v[76:79], v[128:131], v[68:71]
    ds_read2_b32 v[102:103], v155 offset0:2 offset1:3
    v_mfma_f32_16x16x32_bf16 v[64:67], v[76:79], v[124:127], v[64:67]
    buffer_load_dwordx4 a[40:43], v1, s[52:55], s89 offen offset:1024 sc1
    v_mfma_f32_16x16x32_bf16 v[60:63], v[76:79], v[120:123], v[60:63]
    v_mfma_f32_16x16x32_bf16 v[56:59], v[76:79], v[116:119], v[56:59]
    v_mfma_f32_16x16x32_bf16 v[52:55], v[76:79], v[112:115], v[52:55]
    v_mfma_f32_16x16x32_bf16 v[48:51], v[76:79], v[108:111], v[48:51]
    v_mfma_f32_16x16x32_bf16 v[44:47], v[76:79], v[104:107], v[44:47]
    buffer_load_dwordx4 a[44:47], v1, s[52:55], s89 offen offset:2048 sc1
    v_mfma_f32_16x16x32_bf16 v[68:71], v[80:83], v[124:127], v[68:71]
    v_mfma_f32_16x16x32_bf16 v[64:67], v[80:83], v[120:123], v[64:67]
    v_mfma_f32_16x16x32_bf16 v[60:63], v[80:83], v[116:119], v[60:63]
    v_mfma_f32_16x16x32_bf16 v[56:59], v[80:83], v[112:115], v[56:59]
    v_mfma_f32_16x16x32_bf16 v[52:55], v[80:83], v[108:111], v[52:55]
    buffer_load_dwordx4 a[48:51], v1, s[52:55], s89 offen offset:3072 sc1
    v_mfma_f32_16x16x32_bf16 v[48:51], v[80:83], v[104:107], v[48:51]
    s_waitcnt lgkmcnt(6)
    v_mfma_f32_16x16x32_bf16 v[68:71], v[84:87], v[120:123], v[68:71]
    v_mfma_f32_16x16x32_bf16 v[64:67], v[84:87], v[116:119], v[64:67]
    v_mfma_f32_16x16x32_bf16 v[60:63], v[84:87], v[112:115], v[60:63]
    v_mfma_f32_16x16x32_bf16 v[56:59], v[84:87], v[108:111], v[56:59]
    s_add_u32 s89, s89, 4096
    buffer_load_dwordx4 a[52:55], v1, s[52:55], s89 offen offset:0 sc1
    v_mfma_f32_16x16x32_bf16 v[52:55], v[84:87], v[104:107], v[52:55]
    v_mfma_f32_16x16x32_bf16 v[68:71], v[88:91], v[116:119], v[68:71]
    v_mfma_f32_16x16x32_bf16 v[64:67], v[88:91], v[112:115], v[64:67]
    v_mfma_f32_16x16x32_bf16 v[60:63], v[88:91], v[108:111], v[60:63]
    v_mfma_f32_16x16x32_bf16 v[56:59], v[88:91], v[104:107], v[56:59]
    buffer_load_dwordx4 a[56:59], v1, s[52:55], s89 offen offset:1024 sc1
    s_waitcnt lgkmcnt(2)
    v_mfma_f32_16x16x32_bf16 v[68:71], v[92:95], v[112:115], v[68:71]
    v_mfma_f32_16x16x32_bf16 v[64:67], v[92:95], v[108:111], v[64:67]
    v_mfma_f32_16x16x32_bf16 v[60:63], v[92:95], v[104:107], v[60:63]
    v_mfma_f32_16x16x32_bf16 v[68:71], v[96:99], v[108:111], v[68:71]
    v_mfma_f32_16x16x32_bf16 v[64:67], v[96:99], v[104:107], v[64:67]
    s_waitcnt lgkmcnt(0)
    v_mfma_f32_16x16x32_bf16 v[68:71], v[100:103], v[104:107], v[68:71]
    s_lshl_b32 s66, s61, 2
    s_add_u32 s66, s66, s62
    s_lshl_b32 s66, s66, 10
    s_add_u32 s66, s66, 655360
    s_mul_i32 s67, s62, 5120
    s_mul_i32 s68, s61, 81920
    s_add_u32 s68, s68, s67
    s_add_u32 s68, s68, 7864320
    v_mov_b32 v160, 0x3f803f80
    v_mov_b32 v161, 0x3f803f80
    v_mov_b32 v162, 0x3f803f80
    v_mov_b32 v163, 0x3f803f80
    s_waitcnt vmcnt(6)
    v_cmp_ne_u64 vcc, s[64:65], v[202:203]
    s_cbranch_vccz L_chk_7_ok
    s_mov_b32 s82, 0
L_chk_7:
    s_sleep 1
    buffer_load_dwordx2 v[202:203], v200, s[52:55], s75 offen sc1
    s_add_u32 s82, s82, 1
    s_cmp_gt_u32 s82, 0x40000
    s_waitcnt vmcnt(0)
    s_cbranch_scc1 L_chk_7_ok
    v_cmp_ne_u64 vcc, s[64:65], v[202:203]
    s_cbranch_vccnz L_chk_7
L_chk_7_ok:
    v_cmp_ne_u64 vcc, s[64:65], v[206:207]
    s_cbranch_vccz L_chk_8_ok
    s_mov_b32 s82, 0
L_chk_8:
    s_sleep 1
    buffer_load_dwordx2 v[206:207], v204, s[52:55], s74 offen sc1
    s_add_u32 s82, s82, 1
    s_cmp_gt_u32 s82, 0x40000
    s_waitcnt vmcnt(0)
    s_cbranch_scc1 L_chk_8_ok
    v_cmp_ne_u64 vcc, s[64:65], v[206:207]
    s_cbranch_vccnz L_chk_8
L_chk_8_ok:
    s_add_u32 m0, s67, 0
    s_add_u32 s69, s68, 0
    buffer_load_dwordx4 v1, s[52:55], s69 offen offset:0 sc1 lds
    buffer_load_dwordx4 v1, s[52:55], s69 offen offset:1024 sc1 lds
    buffer_load_dwordx4 v1, s[52:55], s69 offen offset:2048 sc1 lds
    buffer_load_dwordx4 v1, s[52:55], s69 offen offset:3072 sc1 lds
    s_add_u32 m0, s67, 4096
    s_add_u32 s69, s69, 4096
    buffer_load_dwordx4 v1, s[52:55], s69 offen sc1 lds
    buffer_load_dwordx2 v[166:167], v36, s[52:55], s66 offen sc1
    buffer_load_dwordx2 v[168:169], v36, s[52:55], s66 offen offset:512 sc1
    s_waitcnt vmcnt(7)
    buffer_load_dwordx4 a[60:63], v1, s[52:55], s89 offen offset:2048 sc1
    v_mfma_f32_16x16x32_bf16 v[24:27], a[100:103], v[160:163], 0
    v_add_u32 v164, 0, v1
    v_mfma_f32_16x16x32_bf16 v[28:31], a[104:107], v[160:163], 0
    v_mfma_f32_16x16x32_bf16 v[32:35], a[108:111], v[160:163], 0
    v_add_u32 v165, 0, v36
    v_mfma_f32_16x16x32_bf16 v[24:27], a[112:115], v[160:163], v[24:27]
    buffer_load_dwordx4 a[64:67], v1, s[52:55], s89 offen offset:3072 sc1
    v_mfma_f32_16x16x32_bf16 v[28:31], a[116:119], v[160:163], v[28:31]
    v_add_u32 v180, 40960, v1
    v_mfma_f32_16x16x32_bf16 v[32:35], a[120:123], v[160:163], v[32:35]
    v_mfma_f32_16x16x32_bf16 v[24:27], a[124:127], v[160:163], v[24:27]
    v_add_u32 v181, 40960, v36
    v_mfma_f32_16x16x32_bf16 v[28:31], a[128:131], v[160:163], v[28:31]
    s_add_u32 s89, s89, 4096
    buffer_load_dwordx4 a[68:71], v1, s[52:55], s89 offen offset:0 sc1
    v_mfma_f32_16x16x32_bf16 v[32:35], a[132:135], v[160:163], v[32:35]
    s_lshl_b32 s70, s62, 9
    v_mfma_f32_16x16x32_bf16 v[24:27], a[136:139], v[160:163], v[24:27]
    v_mfma_f32_16x16x32_bf16 v[28:31], a[140:143], v[160:163], v[28:31]
    s_add_u32 s70, s70, 81920
    v_mfma_f32_16x16x32_bf16 v[32:35], a[144:147], v[160:163], v[32:35]
    buffer_load_dwordx4 a[72:75], v1, s[52:55], s89 offen offset:1024 sc1
    v_mfma_f32_16x16x32_bf16 v[24:27], a[148:151], v[160:163], v[24:27]
    v_add_u32 v170, s70, v36
    v_mfma_f32_16x16x32_bf16 v[28:31], a[152:155], v[160:163], v[28:31]
    v_mfma_f32_16x16x32_bf16 v[32:35], a[156:159], v[160:163], v[32:35]
    buffer_load_dwordx4 a[76:79], v1, s[52:55], s89 offen offset:2048 sc1
    v_add_u32 v174, 81920, v36
    v_mfma_f32_16x16x32_bf16 v[24:27], a[160:163], v[160:163], v[24:27]
    v_mfma_f32_16x16x32_bf16 v[28:31], a[164:167], v[160:163], v[28:31]
    s_mul_i32 s70, s61, 32
    v_mfma_f32_16x16x32_bf16 v[32:35], a[168:171], v[160:163], v[32:35]
    v_mfma_f32_16x16x32_bf16 v[24:27], a[172:175], v[160:163], v[24:27]
    buffer_load_dwordx4 a[80:83], v1, s[52:55], s89 offen offset:3072 sc1
    s_add_u32 s70, s70, s60
    v_mfma_f32_16x16x32_bf16 v[28:31], a[176:179], v[160:163], v[28:31]
    v_mfma_f32_16x16x32_bf16 v[32:35], a[180:183], v[160:163], v[32:35]
    s_mul_i32 s70, s70, 6144
    v_mfma_f32_16x16x32_bf16 v[24:27], a[184:187], v[160:163], v[24:27]
    v_mfma_f32_16x16x32_bf16 v[28:31], a[188:191], v[160:163], v[28:31]
    s_add_u32 m0, s67, 20480
    s_add_u32 s69, s68, 20480
    buffer_load_dwordx4 v1, s[52:55], s69 offen offset:0 sc1 lds
    s_add_u32 s70, s70, 10485760
    v_mfma_f32_16x16x32_bf16 v[32:35], a[192:195], v[160:163], v[32:35]
    v_mfma_f32_16x16x32_bf16 v[24:27], a[196:199], v[160:163], v[24:27]
    s_lshl_b32 s71, s62, 9
    v_mfma_f32_16x16x32_bf16 v[28:31], a[200:203], v[160:163], v[28:31]
    v_mfma_f32_16x16x32_bf16 v[32:35], a[204:207], v[160:163], v[32:35]
    buffer_load_dwordx4 v1, s[52:55], s69 offen offset:1024 sc1 lds
    s_add_u32 s70, s70, s71
    v_mfma_f32_16x16x32_bf16 v[24:27], a[208:211], v[160:163], v[24:27]
    v_mfma_f32_16x16x32_bf16 v[28:31], a[212:215], v[160:163], v[28:31]
    s_add_u32 s70, s70, s71
    v_mfma_f32_16x16x32_bf16 v[32:35], a[216:219], v[160:163], v[32:35]
    buffer_load_dwordx4 v1, s[52:55], s69 offen offset:2048 sc1 lds
    v_mfma_f32_16x16x32_bf16 v[24:27], a[220:223], v[160:163], v[24:27]
    s_sub_u32 s71, s70, s71
    v_mfma_f32_16x16x32_bf16 v[28:31], a[224:227], v[160:163], v[28:31]
    v_mfma_f32_16x16x32_bf16 v[32:35], a[228:231], v[160:163], v[32:35]
    s_add_u32 s71, s71, 4096
    v_mfma_f32_16x16x32_bf16 v[24:27], a[232:235], v[160:163], v[24:27]
    buffer_load_dwordx4 v1, s[52:55], s69 offen offset:3072 sc1 lds
    v_mfma_f32_16x16x32_bf16 v[28:31], a[236:239], v[160:163], v[28:31]
    s_lshl_b32 s94, s60, 2
    v_mfma_f32_16x16x32_bf16 v[32:35], a[240:243], v[160:163], v[32:35]
    v_mfma_f32_16x16x32_bf16 v[24:27], a[244:247], v[160:163], v[24:27]
    s_add_u32 s94, s94, s62
    v_mfma_f32_16x16x32_bf16 v[28:31], a[248:251], v[160:163], v[28:31]
    s_add_u32 m0, s67, 24576
    s_add_u32 s69, s69, 4096
    buffer_load_dwordx4 v1, s[52:55], s69 offen sc1 lds
    v_mfma_f32_16x16x32_bf16 v[32:35], a[252:255], v[160:163], v[32:35]
    s_mul_i32 s94, s94, 61440
    v_mfma_f32_16x16x32_bf16 v[24:27], a[0:3], v[160:163], v[24:27]
    v_mfma_f32_16x16x32_bf16 v[28:31], a[4:7], v[160:163], v[28:31]
    s_add_u32 s94, s94, 3276800
    v_mfma_f32_16x16x32_bf16 v[32:35], a[8:11], v[160:163], v[32:35]
    s_waitcnt vmcnt(11)
    v_add_f32 v166, v166, v168
    v_add_f32 v167, v167, v169
    ds_write_b64 v170, v[166:167]
    v_mfma_f32_16x16x32_bf16 v[24:27], a[12:15], v[160:163], v[24:27]
    v_mfma_f32_16x16x32_bf16 v[28:31], a[16:19], v[160:163], v[28:31]
    v_mfma_f32_16x16x32_bf16 v[32:35], a[20:23], v[160:163], v[32:35]
    v_mfma_f32_16x16x32_bf16 v[24:27], a[24:27], v[160:163], v[24:27]
    v_mfma_f32_16x16x32_bf16 v[28:31], a[28:31], v[160:163], v[28:31]
    v_mfma_f32_16x16x32_bf16 v[32:35], a[32:35], v[160:163], v[32:35]
    v_mfma_f32_16x16x32_bf16 v[24:27], a[36:39], v[160:163], v[24:27]
    v_mfma_f32_16x16x32_bf16 v[28:31], a[40:43], v[160:163], v[28:31]
    v_mfma_f32_16x16x32_bf16 v[32:35], a[44:47], v[160:163], v[32:35]
    v_mfma_f32_16x16x32_bf16 v[24:27], a[48:51], v[160:163], v[24:27]
    v_mfma_f32_16x16x32_bf16 v[28:31], a[52:55], v[160:163], v[28:31]
    v_mfma_f32_16x16x32_bf16 v[32:35], a[56:59], v[160:163], v[32:35]
    s_waitcnt lgkmcnt(0)
    s_barrier
    ds_read_b128 v[96:99], v164 offset:0
    ds_read_b128 v[100:103], v164 offset:1024
    ds_read_b128 v[104:107], v164 offset:2048
    ds_read_b128 v[108:111], v164 offset:3072
    s_waitcnt lgkmcnt(3)
    s_add_u32 m0, s67, 40960
    s_add_u32 s69, s68, 40960
    buffer_load_dwordx4 v1, s[52:55], s69 offen offset:0 sc1 lds
    v_mfma_f32_16x16x32_bf16 v[72:75], a[100:103], v[96:99], 0
    ds_read_b64 v[166:167], v174 offset:0
    v_mfma_f32_16x16x32_bf16 v[76:79], a[104:107], v[96:99], 0
    ds_read_b64 v[168:169], v174 offset:512
    ds_read_b64 v[112:113], v165 offset:4096
    ds_read_b64 v[114:115], v165 offset:4608
    v_mfma_f32_16x16x32_bf16 v[80:83], a[108:111], v[96:99], 0
    ds_read_b64 v[170:171], v174 offset:1024
    s_waitcnt lgkmcnt(6)
    v_mfma_f32_16x16x32_bf16 v[72:75], a[112:115], v[100:103], v[72:75]
    buffer_load_dwordx4 v1, s[52:55], s69 offen offset:1024 sc1 lds
    v_mfma_f32_16x16x32_bf16 v[76:79], a[116:119], v[100:103], v[76:79]
    ds_read_b64 v[172:173], v174 offset:1536
    ds_read_b128 v[116:119], v164 offset:5120
    v_mfma_f32_16x16x32_bf16 v[80:83], a[120:123], v[100:103], v[80:83]
    s_lshl_b32 s66, s62, 10
    v_mfma_f32_16x16x32_bf16 v[72:75], a[124:127], v[104:107], v[72:75]
    s_add_u32 s66, s66, 83968
    v_mfma_f32_16x16x32_bf16 v[76:79], a[128:131], v[104:107], v[76:79]
    buffer_load_dwordx4 v1, s[52:55], s69 offen offset:2048 sc1 lds
    v_lshl_add_u32 v175, v2, 4, s66
    ds_read_b128 v[96:99], v164 offset:6144
    v_mfma_f32_16x16x32_bf16 v[80:83], a[132:135], v[104:107], v[80:83]
    v_add_u32 v176, s66, v1
    s_waitcnt lgkmcnt(4)
    v_mfma_f32_16x16x32_bf16 v[72:75], a[136:139], v[108:111], v[72:75]
    v_mfma_f32_16x16x32_bf16 v[76:79], a[140:143], v[108:111], v[76:79]
    s_waitcnt lgkmcnt(2)
    ds_read_b128 v[100:103], v164 offset:7168
    v_mfma_f32_16x16x32_bf16 v[80:83], a[144:147], v[108:111], v[80:83]
    buffer_load_dwordx4 v1, s[52:55], s69 offen offset:3072 sc1 lds
    v_add_f32 v166, v166, v168
    v_mfma_f32_16x16x32_bf16 v[72:75], a[148:151], v[112:115], v[72:75]
    v_add_f32 v170, v170, v172
    v_mfma_f32_16x16x32_bf16 v[76:79], a[152:155], v[112:115], v[76:79]
    v_add_f32 v167, v167, v169
    ds_read_b128 v[104:107], v164 offset:8192
    v_mfma_f32_16x16x32_bf16 v[80:83], a[156:159], v[112:115], v[80:83]
    s_add_u32 m0, s67, 45056
    s_add_u32 s69, s69, 4096
    buffer_load_dwordx4 v1, s[52:55], s69 offen sc1 lds
    v_add_f32 v171, v171, v173
    s_waitcnt lgkmcnt(2)
    v_mfma_f32_16x16x32_bf16 v[72:75], a[160:163], v[116:119], v[72:75]
    v_add_f32 v166, v166, v170
    v_mfma_f32_16x16x32_bf16 v[76:79], a[164:167], v[116:119], v[76:79]
    ds_read_b64 v[108:109], v165 offset:9216
    ds_read_b64 v[110:111], v165 offset:9728
    v_mfma_f32_16x16x32_bf16 v[80:83], a[168:171], v[116:119], v[80:83]
    v_add_f32 v167, v167, v171
    v_mfma_f32_16x16x32_bf16 v[72:75], a[172:175], v[96:99], v[72:75]
    s_add_u32 m0, s67, 61440
    s_add_u32 s69, s68, 61440
    buffer_load_dwordx4 v1, s[52:55], s69 offen offset:0 sc1 lds
    v_mul_f32 v170, 0x3acccccd, v166
    v_mfma_f32_16x16x32_bf16 v[76:79], a[176:179], v[96:99], v[76:79]
    v_mul_f32 v168, 0x3acccccd, v167
    ds_read_b128 v[112:115], v164 offset:10240
    v_mfma_f32_16x16x32_bf16 v[80:83], a[180:183], v[96:99], v[80:83]
    v_fma_f32 v168, -v170, v170, v168
    s_waitcnt lgkmcnt(3)
    v_mfma_f32_16x16x32_bf16 v[72:75], a[184:187], v[100:103], v[72:75]
    v_max_f32 v168, 0, v168
    v_mfma_f32_16x16x32_bf16 v[76:79], a[188:191], v[100:103], v[76:79]
    buffer_load_dwordx4 v1, s[52:55], s69 offen offset:1024 sc1 lds
    v_cvt_pk_bf16_f32 v169, v168, v168
    ds_read_b128 v[116:119], v164 offset:11264
    v_mfma_f32_16x16x32_bf16 v[80:83], a[192:195], v[100:103], v[80:83]
    v_mfma_f32_16x16x32_bf16 v[72:75], a[196:199], v[104:107], v[72:75]
    v_and_b32 v169, 0xffff0000, v169
    v_mfma_f32_16x16x32_bf16 v[76:79], a[200:203], v[104:107], v[76:79]
    v_add_f32 v169, 0x3727c5ac, v169
    ds_read_b128 v[96:99], v164 offset:12288
    v_mfma_f32_16x16x32_bf16 v[80:83], a[204:207], v[104:107], v[80:83]
    buffer_load_dwordx4 v1, s[52:55], s69 offen offset:2048 sc1 lds
    v_cvt_pk_bf16_f32 v169, v169, v169
    s_waitcnt lgkmcnt(2)
    v_mfma_f32_16x16x32_bf16 v[72:75], a[208:211], v[108:111], v[72:75]
    v_and_b32 v169, 0xffff0000, v169
    v_mfma_f32_16x16x32_bf16 v[76:79], a[212:215], v[108:111], v[76:79]
    ds_read_b128 v[100:103], v164 offset:13312
    v_mfma_f32_16x16x32_bf16 v[80:83], a[216:219], v[108:111], v[80:83]
    buffer_load_dwordx4 v1, s[52:55], s69 offen offset:3072 sc1 lds
    v_sqrt_f32 v169, v169
    v_mfma_f32_16x16x32_bf16 v[72:75], a[220:223], v[112:115], v[72:75]
    v_mfma_f32_16x16x32_bf16 v[76:79], a[224:227], v[112:115], v[76:79]
    v_cvt_pk_bf16_f32 v171, v169, v169
    ds_read_b64 v[104:105], v165 offset:14336
    ds_read_b64 v[106:107], v165 offset:14848
    v_mfma_f32_16x16x32_bf16 v[80:83], a[228:231], v[112:115], v[80:83]
    v_and_b32 v171, 0xffff0000, v171
    s_waitcnt lgkmcnt(3)
    v_mfma_f32_16x16x32_bf16 v[72:75], a[232:235], v[116:119], v[72:75]
    s_add_u32 m0, s67, 65536
    s_add_u32 s69, s69, 4096
    buffer_load_dwordx4 v1, s[52:55], s69 offen sc1 lds
    v_mfma_f32_16x16x32_bf16 v[76:79], a[236:239], v[116:119], v[76:79]
    v_rcp_f32 v168, v171
    ds_read_b128 v[108:111], v164 offset:15360
    v_mfma_f32_16x16x32_bf16 v[80:83], a[240:243], v[116:119], v[80:83]
    v_mul_f32 v169, v168, v168
    v_mfma_f32_16x16x32_bf16 v[72:75], a[244:247], v[96:99], v[72:75]
    v_mfma_f32_16x16x32_bf16 v[76:79], a[248:251], v[96:99], v[76:79]
    v_mul_f32 v173, 0xc0135761, v168
    ds_read_b128 v[112:115], v164 offset:16384
    v_mfma_f32_16x16x32_bf16 v[80:83], a[252:255], v[96:99], v[80:83]
    v_mul_f32 v169, 0x3d372713, v169
    s_waitcnt lgkmcnt(2)
    v_mfma_f32_16x16x32_bf16 v[72:75], a[0:3], v[100:103], v[72:75]
    v_mul_f32 v172, v169, v173
    v_mfma_f32_16x16x32_bf16 v[76:79], a[4:7], v[100:103], v[76:79]
    ds_write_b128 v176, v[170:173]
    ds_read_b128 v[116:119], v164 offset:17408
    v_mfma_f32_16x16x32_bf16 v[80:83], a[8:11], v[100:103], v[80:83]
    ds_read_b128 v[120:123], v175 offset:0
    v_mfma_f32_16x16x32_bf16 v[72:75], a[12:15], v[104:107], v[72:75]
    v_mfma_f32_16x16x32_bf16 v[76:79], a[16:19], v[104:107], v[76:79]
    ds_read_b128 v[124:127], v175 offset:256
    ds_read_b128 v[96:99], v164 offset:18432
    v_mfma_f32_16x16x32_bf16 v[80:83], a[20:23], v[104:107], v[80:83]
    ds_read_b128 v[128:131], v175 offset:512
    s_waitcnt lgkmcnt(6)
    v_mfma_f32_16x16x32_bf16 v[72:75], a[24:27], v[108:111], v[72:75]
    ds_read_b128 v[132:135], v175 offset:768
    v_mfma_f32_16x16x32_bf16 v[76:79], a[28:31], v[108:111], v[76:79]
    ds_read_b64 v[100:101], v165 offset:19456
    ds_read_b64 v[102:103], v165 offset:19968
    v_mfma_f32_16x16x32_bf16 v[80:83], a[32:35], v[108:111], v[80:83]
    s_waitcnt vmcnt(10)
    s_barrier
    v_mfma_f32_16x16x32_bf16 v[72:75], a[36:39], v[112:115], v[72:75]
    v_mfma_f32_16x16x32_bf16 v[76:79], a[40:43], v[112:115], v[76:79]
    ds_read_b128 v[104:107], v164 offset:20480
    v_mfma_f32_16x16x32_bf16 v[80:83], a[44:47], v[112:115], v[80:83]
    s_waitcnt lgkmcnt(5)
    v_mfma_f32_16x16x32_bf16 v[72:75], a[48:51], v[116:119], v[72:75]
    v_mfma_f32_16x16x32_bf16 v[76:79], a[52:55], v[116:119], v[76:79]
    ds_read_b128 v[108:111], v164 offset:21504
    v_mfma_f32_16x16x32_bf16 v[80:83], a[56:59], v[116:119], v[80:83]
    v_mfma_f32_16x16x32_bf16 v[72:75], a[60:63], v[96:99], v[72:75]
    v_mfma_f32_16x16x32_bf16 v[76:79], a[64:67], v[96:99], v[76:79]
    ds_read_b128 v[112:115], v164 offset:22528
    v_mfma_f32_16x16x32_bf16 v[80:83], a[68:71], v[96:99], v[80:83]
    v_mfma_f32_16x16x32_bf16 v[24:27], a[60:63], v[160:163], v[24:27]
    v_mfma_f32_16x16x32_bf16 v[28:31], a[64:67], v[160:163], v[28:31]
    v_mfma_f32_16x16x32_bf16 v[32:35], a[68:71], v[160:163], v[32:35]
    s_waitcnt lgkmcnt(2)
    v_mfma_f32_16x16x32_bf16 v[72:75], a[72:75], v[100:103], v[72:75]
    v_mfma_f32_16x16x32_bf16 v[76:79], a[76:79], v[100:103], v[76:79]
    ds_read_b128 v[116:119], v164 offset:23552
    v_mfma_f32_16x16x32_bf16 v[80:83], a[80:83], v[100:103], v[80:83]
    v_mfma_f32_16x16x32_bf16 v[24:27], a[72:75], v[160:163], v[24:27]
    v_mfma_f32_16x16x32_bf16 v[28:31], a[76:79], v[160:163], v[28:31]
    v_mfma_f32_16x16x32_bf16 v[32:35], a[80:83], v[160:163], v[32:35]
    v_mfma_f32_16x16x32_bf16 v[84:87], a[100:103], v[104:107], 0
    buffer_load_dwordx4 v[186:189], v1, s[52:55], s94 offen offset:0 sc1
    v_mfma_f32_16x16x32_bf16 v[88:91], a[104:107], v[104:107], 0
    ds_read_b64 v[96:97], v165 offset:24576
    ds_read_b64 v[98:99], v165 offset:25088
    v_mfma_f32_16x16x32_bf16 v[92:95], a[108:111], v[104:107], 0
    v_fma_f32 v72, -v24, v120, v72
    s_waitcnt lgkmcnt(3)
    v_mfma_f32_16x16x32_bf16 v[84:87], a[112:115], v[108:111], v[84:87]
    v_fma_f32 v73, -v25, v120, v73
    v_fma_f32 v74, -v26, v120, v74
    v_fma_f32 v75, -v27, v120, v75
    v_mfma_f32_16x16x32_bf16 v[88:91], a[116:119], v[108:111], v[88:91]
    v_fma_f32 v76, -v28, v120, v76
    v_fma_f32 v77, -v29, v120, v77
    ds_read_b128 v[100:103], v164 offset:25600
    v_mfma_f32_16x16x32_bf16 v[92:95], a[120:123], v[108:111], v[92:95]
    buffer_load_dwordx4 v[190:193], v1, s[52:55], s94 offen offset:1024 sc1
    v_fma_f32 v78, -v30, v120, v78
    v_fma_f32 v79, -v31, v120, v79
    v_mfma_f32_16x16x32_bf16 v[84:87], a[124:127], v[112:115], v[84:87]
    v_fma_f32 v80, -v32, v120, v80
    v_fma_f32 v81, -v33, v120, v81
    v_fma_f32 v82, -v34, v120, v82
    v_mfma_f32_16x16x32_bf16 v[88:91], a[128:131], v[112:115], v[88:91]
    v_fma_f32 v83, -v35, v120, v83
    v_mul_f32 v140, v72, v72
    ds_read_b128 v[104:107], v164 offset:26624
    v_mfma_f32_16x16x32_bf16 v[92:95], a[132:135], v[112:115], v[92:95]
    v_mul_f32 v141, v73, v73
    v_mul_f32 v142, v74, v74
    s_waitcnt lgkmcnt(2)
    v_mfma_f32_16x16x32_bf16 v[84:87], a[136:139], v[116:119], v[84:87]
    v_mul_f32 v143, v75, v75
    v_mul_f32 v144, v76, v76
    v_mul_f32 v145, v77, v77
    v_mfma_f32_16x16x32_bf16 v[88:91], a[140:143], v[116:119], v[88:91]
    buffer_load_dwordx4 v[194:197], v1, s[52:55], s94 offen offset:2048 sc1
    v_mul_f32 v146, v78, v78
    v_mul_f32 v147, v79, v79
    ds_read_b128 v[108:111], v164 offset:27648
    v_mfma_f32_16x16x32_bf16 v[92:95], a[144:147], v[116:119], v[92:95]
    v_mul_f32 v148, v80, v80
    v_mul_f32 v149, v81, v81
    v_mfma_f32_16x16x32_bf16 v[84:87], a[148:151], v[96:99], v[84:87]
    v_mul_f32 v150, v82, v82
    v_mul_f32 v151, v83, v83
    v_fma_f32 v140, v140, v122, v123
    v_mfma_f32_16x16x32_bf16 v[88:91], a[152:155], v[96:99], v[88:91]
    v_fma_f32 v141, v141, v122, v123
    v_fma_f32 v142, v142, v122, v123
    ds_read_b128 v[112:115], v164 offset:28672
    v_mfma_f32_16x16x32_bf16 v[92:95], a[156:159], v[96:99], v[92:95]
    v_fma_f32 v143, v143, v122, v123
    v_fma_f32 v144, v144, v122, v123
    s_waitcnt lgkmcnt(2)
    v_mfma_f32_16x16x32_bf16 v[84:87], a[160:163], v[100:103], v[84:87]
    v_fma_f32 v145, v145, v122, v123
    v_fma_f32 v146, v146, v122, v123
    v_fma_f32 v147, v147, v122, v123
    v_mfma_f32_16x16x32_bf16 v[88:91], a[164:167], v[100:103], v[88:91]
    buffer_load_dwordx4 v[198:201], v1, s[52:55], s94 offen offset:3072 sc1
    v_fma_f32 v148, v148, v122, v123
    v_fma_f32 v149, v149, v122, v123
    ds_read_b64 v[116:117], v165 offset:29696
    ds_read_b64 v[118:119], v165 offset:30208
    v_mfma_f32_16x16x32_bf16 v[92:95], a[168:171], v[100:103], v[92:95]
    v_fma_f32 v150, v150, v122, v123
    v_fma_f32 v151, v151, v122, v123
    v_mfma_f32_16x16x32_bf16 v[84:87], a[172:175], v[104:107], v[84:87]
    v_mul_f32 v140, v140, v72
    v_mul_f32 v141, v141, v73
    v_mul_f32 v142, v142, v74
    v_mfma_f32_16x16x32_bf16 v[88:91], a[176:179], v[104:107], v[88:91]
    v_mul_f32 v143, v143, v75
    v_mul_f32 v144, v144, v76
    ds_read_b128 v[96:99], v164 offset:30720
    v_mfma_f32_16x16x32_bf16 v[92:95], a[180:183], v[104:107], v[92:95]
    v_mul_f32 v145, v145, v77
    v_mul_f32 v146, v146, v78
    s_waitcnt lgkmcnt(3)
    v_mfma_f32_16x16x32_bf16 v[84:87], a[184:187], v[108:111], v[84:87]
    s_add_u32 s94, s94, 4096
    buffer_load_dwordx4 v[202:205], v1, s[52:55], s94 offen offset:0 sc1
    v_mul_f32 v147, v147, v79
    v_mul_f32 v148, v148, v80
    v_mul_f32 v149, v149, v81
    v_mfma_f32_16x16x32_bf16 v[88:91], a[188:191], v[108:111], v[88:91]
    v_mul_f32 v150, v150, v82
    v_mul_f32 v151, v151, v83
    ds_read_b128 v[100:103], v164 offset:31744
    v_mfma_f32_16x16x32_bf16 v[92:95], a[192:195], v[108:111], v[92:95]
    v_exp_f32 v140, v140
    v_mfma_f32_16x16x32_bf16 v[84:87], a[196:199], v[112:115], v[84:87]
    v_exp_f32 v141, v141
    v_mfma_f32_16x16x32_bf16 v[88:91], a[200:203], v[112:115], v[88:91]
    v_exp_f32 v142, v142
    v_exp_f32 v143, v143
    ds_read_b128 v[104:107], v164 offset:32768
    v_mfma_f32_16x16x32_bf16 v[92:95], a[204:207], v[112:115], v[92:95]
    v_exp_f32 v144, v144
    s_waitcnt lgkmcnt(2)
    v_mfma_f32_16x16x32_bf16 v[84:87], a[208:211], v[116:119], v[84:87]
    buffer_load_dwordx4 v[206:209], v1, s[52:55], s94 offen offset:1024 sc1
    v_exp_f32 v145, v145
    v_mfma_f32_16x16x32_bf16 v[88:91], a[212:215], v[116:119], v[88:91]
    v_exp_f32 v146, v146
    ds_read_b128 v[108:111], v164 offset:33792
    v_mfma_f32_16x16x32_bf16 v[92:95], a[216:219], v[116:119], v[92:95]
    v_exp_f32 v147, v147
    v_mfma_f32_16x16x32_bf16 v[84:87], a[220:223], v[96:99], v[84:87]
    v_exp_f32 v148, v148
    v_mfma_f32_16x16x32_bf16 v[88:91], a[224:227], v[96:99], v[88:91]
    v_exp_f32 v149, v149
    v_exp_f32 v150, v150
    ds_read_b64 v[112:113], v165 offset:34816
    ds_read_b64 v[114:115], v165 offset:35328
    v_mfma_f32_16x16x32_bf16 v[92:95], a[228:231], v[96:99], v[92:95]
    buffer_load_dwordx4 v[210:213], v1, s[52:55], s94 offen offset:2048 sc1
    v_exp_f32 v151, v151
    s_waitcnt lgkmcnt(3)
    v_mfma_f32_16x16x32_bf16 v[84:87], a[232:235], v[100:103], v[84:87]
    v_fma_f32 v140, v140, v121, v121
    v_fma_f32 v141, v141, v121, v121
    v_mfma_f32_16x16x32_bf16 v[88:91], a[236:239], v[100:103], v[88:91]
    v_fma_f32 v142, v142, v121, v121
    v_fma_f32 v143, v143, v121, v121
    ds_read_b128 v[116:119], v164 offset:35840
    v_mfma_f32_16x16x32_bf16 v[92:95], a[240:243], v[100:103], v[92:95]
    v_fma_f32 v144, v144, v121, v121
    v_fma_f32 v145, v145, v121, v121
    v_fma_f32 v146, v146, v121, v121
    v_mfma_f32_16x16x32_bf16 v[84:87], a[244:247], v[104:107], v[84:87]
    v_fma_f32 v147, v147, v121, v121
    v_fma_f32 v148, v148, v121, v121
    v_mfma_f32_16x16x32_bf16 v[88:91], a[248:251], v[104:107], v[88:91]
    v_fma_f32 v149, v149, v121, v121
    v_fma_f32 v150, v150, v121, v121
    ds_read_b128 v[96:99], v164 offset:36864
    v_mfma_f32_16x16x32_bf16 v[92:95], a[252:255], v[104:107], v[92:95]
    buffer_load_dwordx4 v[214:217], v1, s[52:55], s94 offen offset:3072 sc1
    v_fma_f32 v151, v151, v121, v121
    v_rcp_f32 v140, v140
    s_waitcnt lgkmcnt(2)
    v_mfma_f32_16x16x32_bf16 v[84:87], a[0:3], v[108:111], v[84:87]
    v_rcp_f32 v141, v141
    v_mfma_f32_16x16x32_bf16 v[88:91], a[4:7], v[108:111], v[88:91]
    v_rcp_f32 v142, v142
    ds_read_b128 v[100:103], v164 offset:37888
    v_mfma_f32_16x16x32_bf16 v[92:95], a[8:11], v[108:111], v[92:95]
    v_rcp_f32 v143, v143
    v_mfma_f32_16x16x32_bf16 v[84:87], a[12:15], v[112:115], v[84:87]
    v_rcp_f32 v144, v144
    v_mfma_f32_16x16x32_bf16 v[88:91], a[16:19], v[112:115], v[88:91]
    s_add_u32 s94, s94, 4096
    buffer_load_dwordx4 v[218:221], v1, s[52:55], s94 offen offset:0 sc1
    v_rcp_f32 v145, v145
    v_rcp_f32 v146, v146
    ds_read_b128 v[104:107], v164 offset:38912
    v_mfma_f32_16x16x32_bf16 v[92:95], a[20:23], v[112:115], v[92:95]
    v_rcp_f32 v147, v147
    s_waitcnt lgkmcnt(2)
    v_mfma_f32_16x16x32_bf16 v[84:87], a[24:27], v[116:119], v[84:87]
    v_rcp_f32 v148, v148
    v_mfma_f32_16x16x32_bf16 v[88:91], a[28:31], v[116:119], v[88:91]
    v_rcp_f32 v149, v149
    ds_read_b64 v[108:109], v165 offset:39936
    ds_read_b64 v[110:111], v165 offset:40448
    v_mfma_f32_16x16x32_bf16 v[92:95], a[32:35], v[116:119], v[92:95]
    v_rcp_f32 v150, v150
    s_waitcnt vmcnt(9)
    s_barrier
    v_mfma_f32_16x16x32_bf16 v[84:87], a[36:39], v[96:99], v[84:87]
    v_rcp_f32 v151, v151
    v_mul_f32 v140, v140, v72
    v_mfma_f32_16x16x32_bf16 v[88:91], a[40:43], v[96:99], v[88:91]
    buffer_load_dwordx4 v[222:225], v1, s[52:55], s94 offen offset:1024 sc1
    v_mul_f32 v141, v141, v73
    v_mul_f32 v142, v142, v74
    ds_read_b128 v[112:115], v164 offset:40960
    v_mfma_f32_16x16x32_bf16 v[92:95], a[44:47], v[96:99], v[92:95]
    v_mul_f32 v143, v143, v75
    v_mul_f32 v144, v144, v76
    v_mul_f32 v145, v145, v77
    s_waitcnt lgkmcnt(3)
    v_mfma_f32_16x16x32_bf16 v[84:87], a[48:51], v[100:103], v[84:87]
    v_mul_f32 v146, v146, v78
    v_mul_f32 v147, v147, v79
    v_mfma_f32_16x16x32_bf16 v[88:91], a[52:55], v[100:103], v[88:91]
    v_mul_f32 v148, v148, v80
    v_mul_f32 v149, v149, v81
    ds_read_b128 v[116:119], v164 offset:41984
    v_mfma_f32_16x16x32_bf16 v[92:95], a[56:59], v[100:103], v[92:95]
    v_mul_f32 v150, v150, v82
    v_mul_f32 v151, v151, v83
    v_cvt_pk_bf16_f32 v152, v140, v141
    v_mfma_f32_16x16x32_bf16 v[84:87], a[60:63], v[104:107], v[84:87]
    buffer_load_dwordx4 v[226:229], v1, s[52:55], s94 offen offset:2048 sc1
    v_cvt_pk_bf16_f32 v153, v142, v143
    v_cvt_pk_bf16_f32 v154, v144, v145
    v_mfma_f32_16x16x32_bf16 v[88:91], a[64:67], v[104:107], v[88:91]
    v_cvt_pk_bf16_f32 v155, v146, v147
    v_cvt_pk_bf16_f32 v156, v148, v149
    ds_read_b128 v[96:99], v164 offset:43008
    v_mfma_f32_16x16x32_bf16 v[92:95], a[68:71], v[104:107], v[92:95]
    v_cvt_pk_bf16_f32 v157, v150, v151
    buffer_store_dwordx4 v[152:155], v1, s[52:55], s70 offen sc1
    buffer_store_dwordx2 v[156:157], v36, s[52:55], s71 offen sc1
    s_waitcnt lgkmcnt(2)
    v_mfma_f32_16x16x32_bf16 v[84:87], a[72:75], v[108:111], v[84:87]
    s_add_u32 s70, s70, 49152
    s_add_u32 s71, s71, 49152
    v_mfma_f32_16x16x32_bf16 v[88:91], a[76:79], v[108:111], v[88:91]
    ds_read_b128 v[100:103], v164 offset:44032
    v_mfma_f32_16x16x32_bf16 v[92:95], a[80:83], v[108:111], v[92:95]
    v_mfma_f32_16x16x32_bf16 v[72:75], a[100:103], v[112:115], 0
    buffer_load_dwordx4 v[230:233], v1, s[52:55], s94 offen offset:3072 sc1
    v_mfma_f32_16x16x32_bf16 v[76:79], a[104:107], v[112:115], 0
    ds_read_b64 v[104:105], v165 offset:45056
    ds_read_b64 v[106:107], v165 offset:45568
    v_mfma_f32_16x16x32_bf16 v[80:83], a[108:111], v[112:115], 0
    v_fma_f32 v84, -v24, v124, v84
    v_fma_f32 v85, -v25, v124, v85
    s_waitcnt lgkmcnt(3)
    v_mfma_f32_16x16x32_bf16 v[72:75], a[112:115], v[116:119], v[72:75]
    v_fma_f32 v86, -v26, v124, v86
    v_fma_f32 v87, -v27, v124, v87
    v_fma_f32 v88, -v28, v124, v88
    v_mfma_f32_16x16x32_bf16 v[76:79], a[116:119], v[116:119], v[76:79]
    v_fma_f32 v89, -v29, v124, v89
    v_fma_f32 v90, -v30, v124, v90
    ds_read_b128 v[108:111], v164 offset:46080
    v_mfma_f32_16x16x32_bf16 v[80:83], a[120:123], v[116:119], v[80:83]
    s_add_u32 s94, s94, 4096
    buffer_load_dwordx4 v[234:237], v1, s[52:55], s94 offen offset:0 sc1
    v_fma_f32 v91, -v31, v124, v91
    v_fma_f32 v92, -v32, v124, v92
    v_mfma_f32_16x16x32_bf16 v[72:75], a[124:127], v[96:99], v[72:75]
    v_fma_f32 v93, -v33, v124, v93
    v_fma_f32 v94, -v34, v124, v94
    v_fma_f32 v95, -v35, v124, v95
    v_mfma_f32_16x16x32_bf16 v[76:79], a[128:131], v[96:99], v[76:79]
    v_mul_f32 v140, v84, v84
    v_mul_f32 v141, v85, v85
    ds_read_b128 v[112:115], v164 offset:47104
    v_mfma_f32_16x16x32_bf16 v[80:83], a[132:135], v[96:99], v[80:83]
    v_mul_f32 v142, v86, v86
    v_mul_f32 v143, v87, v87
    s_waitcnt lgkmcnt(2)
    v_mfma_f32_16x16x32_bf16 v[72:75], a[136:139], v[100:103], v[72:75]
    v_mul_f32 v144, v88, v88
    v_mul_f32 v145, v89, v89
    v_mul_f32 v146, v90, v90
    v_mfma_f32_16x16x32_bf16 v[76:79], a[140:143], v[100:103], v[76:79]
    buffer_load_dwordx4 v[238:241], v1, s[52:55], s94 offen offset:1024 sc1
    v_mul_f32 v147, v91, v91
    v_mul_f32 v148, v92, v92
    ds_read_b128 v[116:119], v164 offset:48128
    v_mfma_f32_16x16x32_bf16 v[80:83], a[144:147], v[100:103], v[80:83]
    v_mul_f32 v149, v93, v93
    v_mul_f32 v150, v94, v94
    v_mfma_f32_16x16x32_bf16 v[72:75], a[148:151], v[104:107], v[72:75]
    v_mul_f32 v151, v95, v95
    v_fma_f32 v140, v140, v126, v127
    v_fma_f32 v141, v141, v126, v127
    v_mfma_f32_16x16x32_bf16 v[76:79], a[152:155], v[104:107], v[76:79]
    v_fma_f32 v142, v142, v126, v127
    v_fma_f32 v143, v143, v126, v127
    ds_read_b128 v[96:99], v164 offset:49152
    v_mfma_f32_16x16x32_bf16 v[80:83], a[156:159], v[104:107], v[80:83]
    v_fma_f32 v144, v144, v126, v127
    v_fma_f32 v145, v145, v126, v127
    s_waitcnt lgkmcnt(2)
    v_mfma_f32_16x16x32_bf16 v[72:75], a[160:163], v[108:111], v[72:75]
    v_fma_f32 v146, v146, v126, v127
    v_fma_f32 v147, v147, v126, v127
    v_fma_f32 v148, v148, v126, v127
    v_mfma_f32_16x16x32_bf16 v[76:79], a[164:167], v[108:111], v[76:79]
    buffer_load_dwordx4 v[242:245], v1, s[52:55], s94 offen offset:2048 sc1
    v_fma_f32 v149, v149, v126, v127
    v_fma_f32 v150, v150, v126, v127
    ds_read_b64 v[100:101], v165 offset:50176
    ds_read_b64 v[102:103], v165 offset:50688
    v_mfma_f32_16x16x32_bf16 v[80:83], a[168:171], v[108:111], v[80:83]
    v_fma_f32 v151, v151, v126, v127
    v_mul_f32 v140, v140, v84
    v_mfma_f32_16x16x32_bf16 v[72:75], a[172:175], v[112:115], v[72:75]
    v_mul_f32 v141, v141, v85
    v_mul_f32 v142, v142, v86
    v_mfma_f32_16x16x32_bf16 v[76:79], a[176:179], v[112:115], v[76:79]
    v_mul_f32 v143, v143, v87
    v_mul_f32 v144, v144, v88
    v_mul_f32 v145, v145, v89
    ds_read_b128 v[104:107], v164 offset:51200
    v_mfma_f32_16x16x32_bf16 v[80:83], a[180:183], v[112:115], v[80:83]
    v_mul_f32 v146, v146, v90
    v_mul_f32 v147, v147, v91
    s_waitcnt lgkmcnt(3)
    v_mfma_f32_16x16x32_bf16 v[72:75], a[184:187], v[116:119], v[72:75]
    buffer_load_dwordx4 v[246:249], v1, s[52:55], s94 offen offset:3072 sc1
    v_mul_f32 v148, v148, v92
    v_mul_f32 v149, v149, v93
    v_mfma_f32_16x16x32_bf16 v[76:79], a[188:191], v[116:119], v[76:79]
    v_mul_f32 v150, v150, v94
    v_mul_f32 v151, v151, v95
    ds_read_b128 v[108:111], v164 offset:52224
    v_mfma_f32_16x16x32_bf16 v[80:83], a[192:195], v[116:119], v[80:83]
    v_exp_f32 v140, v140
    v_exp_f32 v141, v141
    v_mfma_f32_16x16x32_bf16 v[72:75], a[196:199], v[96:99], v[72:75]
    v_exp_f32 v142, v142
    v_mfma_f32_16x16x32_bf16 v[76:79], a[200:203], v[96:99], v[76:79]
    v_exp_f32 v143, v143
    ds_read_b128 v[112:115], v164 offset:53248
    v_mfma_f32_16x16x32_bf16 v[80:83], a[204:207], v[96:99], v[80:83]
    v_exp_f32 v144, v144
    s_waitcnt lgkmcnt(2)
    v_mfma_f32_16x16x32_bf16 v[72:75], a[208:211], v[100:103], v[72:75]
    s_add_u32 s94, s94, 4096
    buffer_load_dwordx4 v[250:253], v1, s[52:55], s94 offen offset:0 sc1
    v_exp_f32 v145, v145
    v_mfma_f32_16x16x32_bf16 v[76:79], a[212:215], v[100:103], v[76:79]
    v_exp_f32 v146, v146
    ds_read_b128 v[116:119], v164 offset:54272
    v_mfma_f32_16x16x32_bf16 v[80:83], a[216:219], v[100:103], v[80:83]
    v_exp_f32 v147, v147
    v_exp_f32 v148, v148
    v_mfma_f32_16x16x32_bf16 v[72:75], a[220:223], v[104:107], v[72:75]
    v_exp_f32 v149, v149
    v_mfma_f32_16x16x32_bf16 v[76:79], a[224:227], v[104:107], v[76:79]
    v_exp_f32 v150, v150
    ds_read_b64 v[96:97], v165 offset:55296
    ds_read_b64 v[98:99], v165 offset:55808
    v_mfma_f32_16x16x32_bf16 v[80:83], a[228:231], v[104:107], v[80:83]
    buffer_load_dwordx4 a[84:87], v1, s[52:55], s94 offen offset:1024 sc1
    v_exp_f32 v151, v151
    s_waitcnt lgkmcnt(3)
    v_mfma_f32_16x16x32_bf16 v[72:75], a[232:235], v[108:111], v[72:75]
    v_fma_f32 v140, v140, v125, v125
    v_fma_f32 v141, v141, v125, v125
    v_mfma_f32_16x16x32_bf16 v[76:79], a[236:239], v[108:111], v[76:79]
    v_fma_f32 v142, v142, v125, v125
    v_fma_f32 v143, v143, v125, v125
    v_fma_f32 v144, v144, v125, v125
    ds_read_b128 v[100:103], v164 offset:56320
    v_mfma_f32_16x16x32_bf16 v[80:83], a[240:243], v[108:111], v[80:83]
    v_fma_f32 v145, v145, v125, v125
    v_fma_f32 v146, v146, v125, v125
    v_mfma_f32_16x16x32_bf16 v[72:75], a[244:247], v[112:115], v[72:75]
    v_fma_f32 v147, v147, v125, v125
    v_fma_f32 v148, v148, v125, v125
    v_mfma_f32_16x16x32_bf16 v[76:79], a[248:251], v[112:115], v[76:79]
    v_fma_f32 v149, v149, v125, v125
    v_fma_f32 v150, v150, v125, v125
    v_fma_f32 v151, v151, v125, v125
    ds_read_b128 v[104:107], v164 offset:57344
    v_mfma_f32_16x16x32_bf16 v[80:83], a[252:255], v[112:115], v[80:83]
    buffer_load_dwordx4 a[88:91], v1, s[52:55], s94 offen offset:2048 sc1
    v_rcp_f32 v140, v140
    s_waitcnt lgkmcnt(2)
    v_mfma_f32_16x16x32_bf16 v[72:75], a[0:3], v[116:119], v[72:75]
    v_rcp_f32 v141, v141
    v_mfma_f32_16x16x32_bf16 v[76:79], a[4:7], v[116:119], v[76:79]
    v_rcp_f32 v142, v142
    ds_read_b128 v[108:111], v164 offset:58368
    v_mfma_f32_16x16x32_bf16 v[80:83], a[8:11], v[116:119], v[80:83]
    v_rcp_f32 v143, v143
    v_mfma_f32_16x16x32_bf16 v[72:75], a[12:15], v[96:99], v[72:75]
    v_rcp_f32 v144, v144
    v_rcp_f32 v145, v145
    v_mfma_f32_16x16x32_bf16 v[76:79], a[16:19], v[96:99], v[76:79]
    buffer_load_dwordx4 a[92:95], v1, s[52:55], s94 offen offset:3072 sc1
    v_rcp_f32 v146, v146
    ds_read_b128 v[112:115], v164 offset:59392
    v_mfma_f32_16x16x32_bf16 v[80:83], a[20:23], v[96:99], v[80:83]
    v_rcp_f32 v147, v147
    s_waitcnt lgkmcnt(2)
    v_mfma_f32_16x16x32_bf16 v[72:75], a[24:27], v[100:103], v[72:75]
    v_rcp_f32 v148, v148
    v_mfma_f32_16x16x32_bf16 v[76:79], a[28:31], v[100:103], v[76:79]
    v_rcp_f32 v149, v149
    ds_read_b64 v[116:117], v165 offset:60416
    ds_read_b64 v[118:119], v165 offset:60928
    v_mfma_f32_16x16x32_bf16 v[80:83], a[32:35], v[100:103], v[80:83]
    v_rcp_f32 v150, v150
    v_mfma_f32_16x16x32_bf16 v[72:75], a[36:39], v[104:107], v[72:75]
    v_rcp_f32 v151, v151
    v_mul_f32 v140, v140, v84
    v_mfma_f32_16x16x32_bf16 v[76:79], a[40:43], v[104:107], v[76:79]
    s_add_u32 s94, s94, 4096
    buffer_load_dwordx4 a[96:99], v1, s[52:55], s94 offen offset:0 sc1
    v_mul_f32 v141, v141, v85
    v_mul_f32 v142, v142, v86
    ds_read_b128 v[96:99], v164 offset:61440
    v_mfma_f32_16x16x32_bf16 v[80:83], a[44:47], v[104:107], v[80:83]
    v_mul_f32 v143, v143, v87
    v_mul_f32 v144, v144, v88
    v_mul_f32 v145, v145, v89
    s_waitcnt lgkmcnt(3)
    v_mfma_f32_16x16x32_bf16 v[72:75], a[48:51], v[108:111], v[72:75]
    v_mul_f32 v146, v146, v90
    v_mul_f32 v147, v147, v91
    v_mfma_f32_16x16x32_bf16 v[76:79], a[52:55], v[108:111], v[76:79]
    v_mul_f32 v148, v148, v92
    v_mul_f32 v149, v149, v93
    ds_read_b128 v[100:103], v164 offset:62464
    v_mfma_f32_16x16x32_bf16 v[80:83], a[56:59], v[108:111], v[80:83]
    v_mul_f32 v150, v150, v94
    v_mul_f32 v151, v151, v95
    v_cvt_pk_bf16_f32 v152, v140, v141
    v_mfma_f32_16x16x32_bf16 v[72:75], a[60:63], v[112:115], v[72:75]
    v_cvt_pk_bf16_f32 v153, v142, v143
    v_cvt_pk_bf16_f32 v154, v144, v145
    v_mfma_f32_16x16x32_bf16 v[76:79], a[64:67], v[112:115], v[76:79]
    v_cvt_pk_bf16_f32 v155, v146, v147
    v_cvt_pk_bf16_f32 v156, v148, v149
    ds_read_b128 v[104:107], v164 offset:63488
    v_mfma_f32_16x16x32_bf16 v[80:83], a[68:71], v[112:115], v[80:83]
    v_cvt_pk_bf16_f32 v157, v150, v151
    buffer_store_dwordx4 v[152:155], v1, s[52:55], s70 offen sc1
    buffer_store_dwordx2 v[156:157], v36, s[52:55], s71 offen sc1
    s_waitcnt lgkmcnt(2)
    v_mfma_f32_16x16x32_bf16 v[72:75], a[72:75], v[116:119], v[72:75]
    s_add_u32 s70, s70, 49152
    s_add_u32 s71, s71, 49152
    v_mfma_f32_16x16x32_bf16 v[76:79], a[76:79], v[116:119], v[76:79]
    ds_read_b128 v[108:111], v180 offset:23552
    v_mfma_f32_16x16x32_bf16 v[80:83], a[80:83], v[116:119], v[80:83]
    v_mfma_f32_16x16x32_bf16 v[84:87], a[100:103], v[96:99], 0
    v_mfma_f32_16x16x32_bf16 v[88:91], a[104:107], v[96:99], 0
    ds_read_b64 v[112:113], v181 offset:24576
    ds_read_b64 v[114:115], v181 offset:25088
    v_mfma_f32_16x16x32_bf16 v[92:95], a[108:111], v[96:99], 0
    v_fma_f32 v72, -v24, v128, v72
    v_fma_f32 v73, -v25, v128, v73
    s_waitcnt lgkmcnt(3)
    v_mfma_f32_16x16x32_bf16 v[84:87], a[112:115], v[100:103], v[84:87]
    buffer_load_dwordx4 a[100:103], v1, s[52:55], s94 offen offset:1024 sc1
    v_fma_f32 v74, -v26, v128, v74
    v_fma_f32 v75, -v27, v128, v75
    v_fma_f32 v76, -v28, v128, v76
    v_mfma_f32_16x16x32_bf16 v[88:91], a[116:119], v[100:103], v[88:91]
    v_fma_f32 v77, -v29, v128, v77
    v_fma_f32 v78, -v30, v128, v78
    ds_read_b128 v[116:119], v180 offset:25600
    v_mfma_f32_16x16x32_bf16 v[92:95], a[120:123], v[100:103], v[92:95]
    v_fma_f32 v79, -v31, v128, v79
    v_fma_f32 v80, -v32, v128, v80
    v_mfma_f32_16x16x32_bf16 v[84:87], a[124:127], v[104:107], v[84:87]
    v_fma_f32 v81, -v33, v128, v81
    v_fma_f32 v82, -v34, v128, v82
    v_fma_f32 v83, -v35, v128, v83
    v_mfma_f32_16x16x32_bf16 v[88:91], a[128:131], v[104:107], v[88:91]
    v_mul_f32 v140, v72, v72
    v_mul_f32 v141, v73, v73
    ds_read_b128 v[96:99], v180 offset:26624
    v_mfma_f32_16x16x32_bf16 v[92:95], a[132:135], v[104:107], v[92:95]
    buffer_load_dwordx4 a[104:107], v1, s[52:55], s94 offen offset:2048 sc1
    v_mul_f32 v142, v74, v74
    v_mul_f32 v143, v75, v75
    s_waitcnt lgkmcnt(2)
    v_mfma_f32_16x16x32_bf16 v[84:87], a[136:139], v[108:111], v[84:87]
    v_mul_f32 v144, v76, v76
    v_mul_f32 v145, v77, v77
    v_mul_f32 v146, v78, v78
    v_mfma_f32_16x16x32_bf16 v[88:91], a[140:143], v[108:111], v[88:91]
    v_mul_f32 v147, v79, v79
    v_mul_f32 v148, v80, v80
    ds_read_b128 v[100:103], v180 offset:27648
    v_mfma_f32_16x16x32_bf16 v[92:95], a[144:147], v[108:111], v[92:95]
    v_mul_f32 v149, v81, v81
    v_mul_f32 v150, v82, v82
    v_mfma_f32_16x16x32_bf16 v[84:87], a[148:151], v[112:115], v[84:87]
    v_mul_f32 v151, v83, v83
    v_fma_f32 v140, v140, v130, v131
    v_fma_f32 v141, v141, v130, v131
    v_mfma_f32_16x16x32_bf16 v[88:91], a[152:155], v[112:115], v[88:91]
    buffer_load_dwordx4 a[108:111], v1, s[52:55], s94 offen offset:3072 sc1
    v_fma_f32 v142, v142, v130, v131
    v_fma_f32 v143, v143, v130, v131
    ds_read_b128 v[104:107], v180 offset:28672
    v_mfma_f32_16x16x32_bf16 v[92:95], a[156:159], v[112:115], v[92:95]
    v_fma_f32 v144, v144, v130, v131
    v_fma_f32 v145, v145, v130, v131
    s_waitcnt lgkmcnt(2)
    v_mfma_f32_16x16x32_bf16 v[84:87], a[160:163], v[116:119], v[84:87]
    v_fma_f32 v146, v146, v130, v131
    v_fma_f32 v147, v147, v130, v131
    v_fma_f32 v148, v148, v130, v131
    v_mfma_f32_16x16x32_bf16 v[88:91], a[164:167], v[116:119], v[88:91]
    v_fma_f32 v149, v149, v130, v131
    v_fma_f32 v150, v150, v130, v131
    ds_read_b64 v[108:109], v181 offset:29696
    ds_read_b64 v[110:111], v181 offset:30208
    v_mfma_f32_16x16x32_bf16 v[92:95], a[168:171], v[116:119], v[92:95]
    v_fma_f32 v151, v151, v130, v131
    v_mul_f32 v140, v140, v72
    v_mfma_f32_16x16x32_bf16 v[84:87], a[172:175], v[96:99], v[84:87]
    s_add_u32 s94, s94, 4096
    buffer_load_dwordx4 a[112:115], v1, s[52:55], s94 offen offset:0 sc1
    v_mul_f32 v141, v141, v73
    v_mul_f32 v142, v142, v74
    v_mfma_f32_16x16x32_bf16 v[88:91], a[176:179], v[96:99], v[88:91]
    v_mul_f32 v143, v143, v75
    v_mul_f32 v144, v144, v76
    v_mul_f32 v145, v145, v77
    ds_read_b128 v[112:115], v180 offset:30720
    v_mfma_f32_16x16x32_bf16 v[92:95], a[180:183], v[96:99], v[92:95]
    v_mul_f32 v146, v146, v78
    v_mul_f32 v147, v147, v79
    s_waitcnt lgkmcnt(3)
    v_mfma_f32_16x16x32_bf16 v[84:87], a[184:187], v[100:103], v[84:87]
    v_mul_f32 v148, v148, v80
    v_mul_f32 v149, v149, v81
    v_mfma_f32_16x16x32_bf16 v[88:91], a[188:191], v[100:103], v[88:91]
    v_mul_f32 v150, v150, v82
    v_mul_f32 v151, v151, v83
    ds_read_b128 v[116:119], v180 offset:31744
    v_mfma_f32_16x16x32_bf16 v[92:95], a[192:195], v[100:103], v[92:95]
    buffer_load_dwordx4 a[116:119], v1, s[52:55], s94 offen offset:1024 sc1
    v_exp_f32 v140, v140
    v_exp_f32 v141, v141
    v_mfma_f32_16x16x32_bf16 v[84:87], a[196:199], v[104:107], v[84:87]
    v_exp_f32 v142, v142
    v_mfma_f32_16x16x32_bf16 v[88:91], a[200:203], v[104:107], v[88:91]
    v_exp_f32 v143, v143
    ds_read_b128 v[96:99], v180 offset:32768
    v_mfma_f32_16x16x32_bf16 v[92:95], a[204:207], v[104:107], v[92:95]
    v_exp_f32 v144, v144
    s_waitcnt lgkmcnt(2)
    v_mfma_f32_16x16x32_bf16 v[84:87], a[208:211], v[108:111], v[84:87]
    v_exp_f32 v145, v145
    v_mfma_f32_16x16x32_bf16 v[88:91], a[212:215], v[108:111], v[88:91]
    buffer_load_dwordx4 a[120:123], v1, s[52:55], s94 offen offset:2048 sc1
    v_exp_f32 v146, v146
    ds_read_b128 v[100:103], v180 offset:33792
    v_mfma_f32_16x16x32_bf16 v[92:95], a[216:219], v[108:111], v[92:95]
    v_exp_f32 v147, v147
    v_exp_f32 v148, v148
    v_mfma_f32_16x16x32_bf16 v[84:87], a[220:223], v[112:115], v[84:87]
    v_exp_f32 v149, v149
    v_mfma_f32_16x16x32_bf16 v[88:91], a[224:227], v[112:115], v[88:91]
    v_exp_f32 v150, v150
    ds_read_b64 v[104:105], v181 offset:34816
    ds_read_b64 v[106:107], v181 offset:35328
    v_mfma_f32_16x16x32_bf16 v[92:95], a[228:231], v[112:115], v[92:95]
    v_exp_f32 v151, v151
    s_waitcnt lgkmcnt(3)
    v_mfma_f32_16x16x32_bf16 v[84:87], a[232:235], v[116:119], v[84:87]
    buffer_load_dwordx4 a[124:127], v1, s[52:55], s94 offen offset:3072 sc1
    v_fma_f32 v140, v140, v129, v129
    v_fma_f32 v141, v141, v129, v129
    v_mfma_f32_16x16x32_bf16 v[88:91], a[236:239], v[116:119], v[88:91]
    v_fma_f32 v142, v142, v129, v129
    v_fma_f32 v143, v143, v129, v129
    v_fma_f32 v144, v144, v129, v129
    ds_read_b128 v[108:111], v180 offset:35840
    v_mfma_f32_16x16x32_bf16 v[92:95], a[240:243], v[116:119], v[92:95]
    v_fma_f32 v145, v145, v129, v129
    v_fma_f32 v146, v146, v129, v129
    v_mfma_f32_16x16x32_bf16 v[84:87], a[244:247], v[96:99], v[84:87]
    v_fma_f32 v147, v147, v129, v129
    v_fma_f32 v148, v148, v129, v129
    v_mfma_f32_16x16x32_bf16 v[88:91], a[248:251], v[96:99], v[88:91]
    v_fma_f32 v149, v149, v129, v129
    v_fma_f32 v150, v150, v129, v129
    v_fma_f32 v151, v151, v129, v129
    ds_read_b128 v[112:115], v180 offset:36864
    v_mfma_f32_16x16x32_bf16 v[92:95], a[252:255], v[96:99], v[92:95]
    s_add_u32 s94, s94, 4096
    buffer_load_dwordx4 a[128:131], v1, s[52:55], s94 offen offset:0 sc1
    v_rcp_f32 v140, v140
    s_waitcnt lgkmcnt(2)
    v_mfma_f32_16x16x32_bf16 v[84:87], a[0:3], v[100:103], v[84:87]
    v_rcp_f32 v141, v141
    v_mfma_f32_16x16x32_bf16 v[88:91], a[4:7], v[100:103], v[88:91]
    v_rcp_f32 v142, v142
    ds_read_b128 v[116:119], v180 offset:37888
    v_mfma_f32_16x16x32_bf16 v[92:95], a[8:11], v[100:103], v[92:95]
    v_rcp_f32 v143, v143
    v_mfma_f32_16x16x32_bf16 v[84:87], a[12:15], v[104:107], v[84:87]
    v_rcp_f32 v144, v144
    v_rcp_f32 v145, v145
    v_mfma_f32_16x16x32_bf16 v[88:91], a[16:19], v[104:107], v[88:91]
    buffer_load_dwordx4 a[132:135], v1, s[52:55], s94 offen offset:1024 sc1
    v_rcp_f32 v146, v146
    ds_read_b128 v[96:99], v180 offset:38912
    v_mfma_f32_16x16x32_bf16 v[92:95], a[20:23], v[104:107], v[92:95]
    v_rcp_f32 v147, v147
    s_waitcnt lgkmcnt(2)
    v_mfma_f32_16x16x32_bf16 v[84:87], a[24:27], v[108:111], v[84:87]
    v_rcp_f32 v148, v148
    v_mfma_f32_16x16x32_bf16 v[88:91], a[28:31], v[108:111], v[88:91]
    v_rcp_f32 v149, v149
    ds_read_b64 v[100:101], v181 offset:39936
    ds_read_b64 v[102:103], v181 offset:40448
    v_mfma_f32_16x16x32_bf16 v[92:95], a[32:35], v[108:111], v[92:95]
    v_rcp_f32 v150, v150
    v_mfma_f32_16x16x32_bf16 v[84:87], a[36:39], v[112:115], v[84:87]
    buffer_load_dwordx4 a[136:139], v1, s[52:55], s94 offen offset:2048 sc1
    v_rcp_f32 v151, v151
    v_mul_f32 v140, v140, v72
    v_mfma_f32_16x16x32_bf16 v[88:91], a[40:43], v[112:115], v[88:91]
    v_mul_f32 v141, v141, v73
    v_mul_f32 v142, v142, v74
    v_mfma_f32_16x16x32_bf16 v[92:95], a[44:47], v[112:115], v[92:95]
    v_mul_f32 v143, v143, v75
    v_mul_f32 v144, v144, v76
    v_mul_f32 v145, v145, v77
    s_waitcnt lgkmcnt(2)
    v_mfma_f32_16x16x32_bf16 v[84:87], a[48:51], v[116:119], v[84:87]
    v_mul_f32 v146, v146, v78
    v_mul_f32 v147, v147, v79
    v_mfma_f32_16x16x32_bf16 v[88:91], a[52:55], v[116:119], v[88:91]
    v_mul_f32 v148, v148, v80
    v_mul_f32 v149, v149, v81
    v_mfma_f32_16x16x32_bf16 v[92:95], a[56:59], v[116:119], v[92:95]
    v_mul_f32 v150, v150, v82
    v_mul_f32 v151, v151, v83
    v_cvt_pk_bf16_f32 v152, v140, v141
    v_mfma_f32_16x16x32_bf16 v[84:87], a[60:63], v[96:99], v[84:87]
    v_cvt_pk_bf16_f32 v153, v142, v143
    v_cvt_pk_bf16_f32 v154, v144, v145
    v_mfma_f32_16x16x32_bf16 v[88:91], a[64:67], v[96:99], v[88:91]
    v_cvt_pk_bf16_f32 v155, v146, v147
    v_cvt_pk_bf16_f32 v156, v148, v149
    v_mfma_f32_16x16x32_bf16 v[92:95], a[68:71], v[96:99], v[92:95]
    v_cvt_pk_bf16_f32 v157, v150, v151
    buffer_store_dwordx4 v[152:155], v1, s[52:55], s70 offen sc1
    buffer_store_dwordx2 v[156:157], v36, s[52:55], s71 offen sc1
    s_waitcnt lgkmcnt(0)
    v_mfma_f32_16x16x32_bf16 v[84:87], a[72:75], v[100:103], v[84:87]
    s_add_u32 s70, s70, 49152
    s_add_u32 s71, s71, 49152
    v_mfma_f32_16x16x32_bf16 v[88:91], a[76:79], v[100:103], v[88:91]
    v_mfma_f32_16x16x32_bf16 v[92:95], a[80:83], v[100:103], v[92:95]
    s_waitcnt lgkmcnt(0)
    s_barrier
    v_mov_b32 v166, v133
    s_nop 0
    v_pk_fma_f32 v[84:85], v[24:25], v[132:133], v[84:85] op_sel_hi:[1,0,1] neg_lo:[0,1,0] neg_hi:[0,1,0]
    v_pk_fma_f32 v[86:87], v[26:27], v[132:133], v[86:87] op_sel_hi:[1,0,1] neg_lo:[0,1,0] neg_hi:[0,1,0]
    s_nop 0
    v_pk_fma_f32 v[88:89], v[28:29], v[132:133], v[88:89] op_sel_hi:[1,0,1] neg_lo:[0,1,0] neg_hi:[0,1,0]
    v_pk_fma_f32 v[90:91], v[30:31], v[132:133], v[90:91] op_sel_hi:[1,0,1] neg_lo:[0,1,0] neg_hi:[0,1,0]
    v_pk_fma_f32 v[92:93], v[32:33], v[132:133], v[92:93] op_sel_hi:[1,0,1] neg_lo:[0,1,0] neg_hi:[0,1,0]
    v_pk_fma_f32 v[94:95], v[34:35], v[132:133], v[94:95] op_sel_hi:[1,0,1] neg_lo:[0,1,0] neg_hi:[0,1,0]
    v_pk_mul_f32 v[140:141], v[84:85], v[84:85]
    v_pk_mul_f32 v[142:143], v[86:87], v[86:87]
    v_pk_mul_f32 v[144:145], v[88:89], v[88:89]
    v_pk_mul_f32 v[146:147], v[90:91], v[90:91]
    v_pk_mul_f32 v[148:149], v[92:93], v[92:93]
    v_pk_mul_f32 v[150:151], v[94:95], v[94:95]
    v_pk_fma_f32 v[140:141], v[140:141], v[134:135], v[134:135] op_sel:[0,0,1] op_sel_hi:[1,0,1]
    v_pk_fma_f32 v[142:143], v[142:143], v[134:135], v[134:135] op_sel:[0,0,1] op_sel_hi:[1,0,1]
    v_pk_fma_f32 v[144:145], v[144:145], v[134:135], v[134:135] op_sel:[0,0,1] op_sel_hi:[1,0,1]
    v_pk_fma_f32 v[146:147], v[146:147], v[134:135], v[134:135] op_sel:[0,0,1] op_sel_hi:[1,0,1]
    v_pk_fma_f32 v[148:149], v[148:149], v[134:135], v[134:135] op_sel:[0,0,1] op_sel_hi:[1,0,1]
    v_pk_fma_f32 v[150:151], v[150:151], v[134:135], v[134:135] op_sel:[0,0,1] op_sel_hi:[1,0,1]
    v_pk_mul_f32 v[140:141], v[140:141], v[84:85]
    v_pk_mul_f32 v[142:143], v[142:143], v[86:87]
    v_pk_mul_f32 v[144:145], v[144:145], v[88:89]
    v_pk_mul_f32 v[146:147], v[146:147], v[90:91]
    v_pk_mul_f32 v[148:149], v[148:149], v[92:93]
    v_pk_mul_f32 v[150:151], v[150:151], v[94:95]
    v_exp_f32 v140, v140
    v_exp_f32 v141, v141
    v_exp_f32 v142, v142
    v_exp_f32 v143, v143
    v_exp_f32 v144, v144
    v_exp_f32 v145, v145
    v_exp_f32 v146, v146
    v_exp_f32 v147, v147
    v_exp_f32 v148, v148
    v_exp_f32 v149, v149
    v_exp_f32 v150, v150
    v_exp_f32 v151, v151
    v_pk_fma_f32 v[140:141], v[140:141], v[166:167], v[166:167] op_sel_hi:[1,0,0]
    v_pk_fma_f32 v[142:143], v[142:143], v[166:167], v[166:167] op_sel_hi:[1,0,0]
    v_pk_fma_f32 v[144:145], v[144:145], v[166:167], v[166:167] op_sel_hi:[1,0,0]
    v_pk_fma_f32 v[146:147], v[146:147], v[166:167], v[166:167] op_sel_hi:[1,0,0]
    v_pk_fma_f32 v[148:149], v[148:149], v[166:167], v[166:167] op_sel_hi:[1,0,0]
    v_pk_fma_f32 v[150:151], v[150:151], v[166:167], v[166:167] op_sel_hi:[1,0,0]
    v_rcp_f32 v140, v140
    v_rcp_f32 v141, v141
    v_rcp_f32 v142, v142
    v_rcp_f32 v143, v143
    v_rcp_f32 v144, v144
    v_rcp_f32 v145, v145
    v_rcp_f32 v146, v146
    v_rcp_f32 v147, v147
    v_rcp_f32 v148, v148
    v_rcp_f32 v149, v149
    v_rcp_f32 v150, v150
    v_rcp_f32 v151, v151
    v_pk_mul_f32 v[140:141], v[84:85], v[140:141]
    v_pk_mul_f32 v[142:143], v[86:87], v[142:143]
    v_pk_mul_f32 v[144:145], v[88:89], v[144:145]
    v_pk_mul_f32 v[146:147], v[90:91], v[146:147]
    v_pk_mul_f32 v[148:149], v[92:93], v[148:149]
    v_pk_mul_f32 v[150:151], v[94:95], v[150:151]
    v_cvt_pk_bf16_f32 v152, v140, v141
    v_cvt_pk_bf16_f32 v153, v142, v143
    v_cvt_pk_bf16_f32 v154, v144, v145
    v_cvt_pk_bf16_f32 v155, v146, v147
    v_cvt_pk_bf16_f32 v156, v148, v149
    v_cvt_pk_bf16_f32 v157, v150, v151
    buffer_store_dwordx4 v[152:155], v1, s[52:55], s70 offen sc1
    buffer_store_dwordx2 v[156:157], v36, s[52:55], s71 offen sc1
    s_add_u32 s70, s70, 49152
    s_add_u32 s71, s71, 49152
    v_and_b32 v148, 1, v0
    v_xor_b32 v148, 1, v148
    v_mul_u32_u24 v148, 4160, v148
    v_and_b32 v149, 14, v0
    v_lshlrev_b32 v149, 1, v149
    v_sub_u32 v148, v148, v149
    v_lshl_add_u32 v136, v3, 4, v148
    v_lshlrev_b32 v148, 5, v2
    v_lshl_add_u32 v137, v3, 4, v148
    s_mul_i32 s12, s62, 8320
    s_mul_i32 s13, s62, 4608
    s_add_u32 s12, s12, 128412
    s_add_u32 s13, s13, 150272
    s_cmp_eq_u32 s62, 3
    s_cselect_b32 s12, 136476, s12
    s_cselect_b32 s13, 154624, s13
    v_add_u32 v156, s12, v136
    v_add_u32 v161, s13, v137
    v_subrev_u32 v157, 1024, v156
    v_subrev_u32 v158, 2048, v156
    v_subrev_u32 v159, 3072, v156
    ds_read_b128 v[132:135], v161 offset:3584
    ds_read2_b32 v[72:73], v156 offset0:128 offset1:129
    ds_read2_b32 v[74:75], v156 offset0:130 offset1:131
    ds_read_b128 v[128:131], v161 offset:3072
    ds_read2_b32 v[76:77], v156 offset0:0 offset1:1
    ds_read2_b32 v[78:79], v156 offset0:2 offset1:3
    ds_read_b128 v[124:127], v161 offset:2560
    ds_read2_b32 v[80:81], v157 offset0:128 offset1:129
    ds_read2_b32 v[82:83], v157 offset0:130 offset1:131
    ds_read_b128 v[120:123], v161 offset:2048
    ds_read2_b32 v[84:85], v157 offset0:0 offset1:1
    ds_read2_b32 v[86:87], v157 offset0:2 offset1:3
    ds_read_b128 v[176:179], v161 offset:1536
    ds_read2_b32 v[88:89], v158 offset0:128 offset1:129
    ds_read2_b32 v[90:91], v158 offset0:130 offset1:131
    ds_read_b128 v[172:175], v161 offset:1024
    ds_read2_b32 v[92:93], v158 offset0:0 offset1:1
    ds_read2_b32 v[94:95], v158 offset0:2 offset1:3
    ds_read_b128 v[168:171], v161 offset:512
    ds_read2_b32 v[96:97], v159 offset0:128 offset1:129
    ds_read2_b32 v[98:99], v159 offset0:130 offset1:131
    ds_read_b128 v[164:167], v161 offset:0
    ds_read2_b32 v[100:101], v159 offset0:0 offset1:1
    ds_read2_b32 v[102:103], v159 offset0:2 offset1:3
    s_add_u32 s4, s62, 1
    s_and_b32 s4, s4, 3
    s_lshl_b32 s66, s61, 2
    s_add_u32 s4, s4, s66
    s_lshl_b32 s4, s4, 2
    s_add_u32 s4, s4, s62
    s_mul_i32 s4, s4, 12288
    s_add_u32 s4, s4, 10485760
    s_add_u32 s5, s62, 2
    s_and_b32 s5, s5, 3
    s_lshl_b32 s66, s61, 2
    s_add_u32 s5, s5, s66
    s_lshl_b32 s5, s5, 2
    s_add_u32 s5, s5, s62
    s_mul_i32 s5, s5, 12288
    s_add_u32 s5, s5, 10485760
    s_add_u32 s6, s62, 3
    s_and_b32 s6, s6, 3
    s_lshl_b32 s66, s61, 2
    s_add_u32 s6, s6, s66
    s_lshl_b32 s6, s6, 2
    s_add_u32 s6, s6, s62
    s_mul_i32 s6, s6, 12288
    s_add_u32 s6, s6, 10485760
    s_add_u32 s7, s62, 4
    s_and_b32 s7, s7, 3
    s_lshl_b32 s66, s61, 2
    s_add_u32 s7, s7, s66
    s_lshl_b32 s7, s7, 2
    s_add_u32 s7, s7, s62
    s_mul_i32 s7, s7, 12288
    s_add_u32 s7, s7, 10485760
    s_waitcnt lgkmcnt(15)
    v_mfma_f32_16x16x32_bf16 v[68:71], v[72:75], v[132:135], v[68:71]
    s_mul_i32 s12, s62, 8320
    s_mul_i32 s13, s62, 4608
    v_mfma_f32_16x16x32_bf16 v[64:67], v[72:75], v[128:131], v[64:67]
    s_add_u32 s12, s12, 128348
    s_waitcnt lgkmcnt(14)
    v_mfma_f32_16x16x32_bf16 v[60:63], v[72:75], v[124:127], v[60:63]
    buffer_load_dwordx4 a[140:143], v1, s[52:55], s94 offen offset:3072 sc1
    s_add_u32 s13, s13, 150208
    v_mfma_f32_16x16x32_bf16 v[56:59], v[72:75], v[120:123], v[56:59]
    s_waitcnt lgkmcnt(8)
    v_mfma_f32_16x16x32_bf16 v[52:55], v[72:75], v[176:179], v[52:55]
    s_cmp_eq_u32 s62, 3
    s_cselect_b32 s12, 144860, s12
    s_cselect_b32 s13, 159296, s13
    v_mfma_f32_16x16x32_bf16 v[48:51], v[72:75], v[172:175], v[48:51]
    s_add_u32 s94, s94, 4096
    buffer_load_dwordx4 a[144:147], v1, s[52:55], s94 offen offset:0 sc1
    v_add_u32 v152, s12, v136
    s_waitcnt lgkmcnt(2)
    v_mfma_f32_16x16x32_bf16 v[44:47], v[72:75], v[168:171], v[44:47]
    v_add_u32 v160, s13, v137
    v_subrev_u32 v153, 1024, v152
    v_mfma_f32_16x16x32_bf16 v[40:43], v[72:75], v[164:167], v[40:43]
    v_subrev_u32 v154, 2048, v152
    v_mfma_f32_16x16x32_bf16 v[68:71], v[76:79], v[128:131], v[68:71]
    v_subrev_u32 v155, 3072, v152
    v_mfma_f32_16x16x32_bf16 v[64:67], v[76:79], v[124:127], v[64:67]
    buffer_load_dwordx4 a[148:151], v1, s[52:55], s94 offen offset:1024 sc1
    ds_read_b128 v[116:119], v160 offset:1536
    v_mfma_f32_16x16x32_bf16 v[60:63], v[76:79], v[120:123], v[60:63]
    ds_read_b128 v[112:115], v160 offset:1024
    v_mfma_f32_16x16x32_bf16 v[56:59], v[76:79], v[176:179], v[56:59]
    ds_read_b128 v[108:111], v160 offset:512
    v_mfma_f32_16x16x32_bf16 v[52:55], v[76:79], v[172:175], v[52:55]
    ds_read_b128 v[104:107], v160 offset:0
    v_mfma_f32_16x16x32_bf16 v[48:51], v[76:79], v[168:171], v[48:51]
    buffer_load_dwordx4 a[152:155], v1, s[52:55], s94 offen offset:2048 sc1
    ds_read_b128 v[132:135], v160 offset:3584
    v_mfma_f32_16x16x32_bf16 v[44:47], v[76:79], v[164:167], v[44:47]
    ds_read2_b32 v[72:73], v152 offset0:128 offset1:129
    v_mfma_f32_16x16x32_bf16 v[68:71], v[80:83], v[124:127], v[68:71]
    ds_read2_b32 v[74:75], v152 offset0:130 offset1:131
    v_mfma_f32_16x16x32_bf16 v[64:67], v[80:83], v[120:123], v[64:67]
    buffer_load_dwordx4 a[156:159], v1, s[52:55], s94 offen offset:3072 sc1
    ds_read_b128 v[128:131], v160 offset:3072
    v_mfma_f32_16x16x32_bf16 v[60:63], v[80:83], v[176:179], v[60:63]
    ds_read2_b32 v[76:77], v152 offset0:0 offset1:1
    v_mfma_f32_16x16x32_bf16 v[56:59], v[80:83], v[172:175], v[56:59]
    ds_read2_b32 v[78:79], v152 offset0:2 offset1:3
    v_mfma_f32_16x16x32_bf16 v[52:55], v[80:83], v[168:171], v[52:55]
    v_mfma_f32_16x16x32_bf16 v[48:51], v[80:83], v[164:167], v[48:51]
    s_add_u32 s94, s94, 4096
    buffer_load_dwordx4 a[160:163], v1, s[52:55], s94 offen offset:0 sc1
    v_mfma_f32_16x16x32_bf16 v[68:71], v[84:87], v[120:123], v[68:71]
    ds_read_b128 v[124:127], v160 offset:2560
    v_mfma_f32_16x16x32_bf16 v[64:67], v[84:87], v[176:179], v[64:67]
    ds_read2_b32 v[80:81], v153 offset0:128 offset1:129
    v_mfma_f32_16x16x32_bf16 v[60:63], v[84:87], v[172:175], v[60:63]
    ds_read2_b32 v[82:83], v153 offset0:130 offset1:131
    v_mfma_f32_16x16x32_bf16 v[56:59], v[84:87], v[168:171], v[56:59]
    s_waitcnt vmcnt(6)
    s_lshl_b32 s66, s61, 3
    s_add_u32 s66, s66, s60
    s_lshl_b32 s66, s66, 2
    s_add_u32 s66, s66, s62
    s_lshl_b32 s66, s66, 7
    s_add_u32 s66, s66, 413696
    s_mov_b64 exec, 65535
    buffer_store_dwordx2 v[38:39], v36, s[52:55], s66 offen sc1
    s_mov_b64 exec, -1
    buffer_load_dwordx4 a[164:167], v1, s[52:55], s94 offen offset:1024 sc1
    v_mfma_f32_16x16x32_bf16 v[52:55], v[84:87], v[164:167], v[52:55]
    ds_read_b128 v[120:123], v160 offset:2048
    v_mfma_f32_16x16x32_bf16 v[68:71], v[88:91], v[176:179], v[68:71]
    ds_read2_b32 v[84:85], v153 offset0:0 offset1:1
    v_mfma_f32_16x16x32_bf16 v[64:67], v[88:91], v[172:175], v[64:67]
    buffer_load_dwordx4 a[168:171], v1, s[52:55], s94 offen offset:2048 sc1
    ds_read2_b32 v[86:87], v153 offset0:2 offset1:3
    v_mfma_f32_16x16x32_bf16 v[60:63], v[88:91], v[168:171], v[60:63]
    v_mfma_f32_16x16x32_bf16 v[56:59], v[88:91], v[164:167], v[56:59]
    v_mfma_f32_16x16x32_bf16 v[68:71], v[92:95], v[172:175], v[68:71]
    buffer_load_dwordx4 a[172:175], v1, s[52:55], s94 offen offset:3072 sc1
    ds_read2_b32 v[88:89], v154 offset0:128 offset1:129
    v_mfma_f32_16x16x32_bf16 v[64:67], v[92:95], v[168:171], v[64:67]
    ds_read2_b32 v[90:91], v154 offset0:130 offset1:131
    v_mfma_f32_16x16x32_bf16 v[60:63], v[92:95], v[164:167], v[60:63]
    ds_read2_b32 v[92:93], v154 offset0:0 offset1:1
    v_mfma_f32_16x16x32_bf16 v[68:71], v[96:99], v[168:171], v[68:71]
    s_add_u32 s94, s94, 4096
    buffer_load_dwordx4 a[176:179], v1, s[52:55], s94 offen offset:0 sc1
    ds_read2_b32 v[94:95], v154 offset0:2 offset1:3
    v_mfma_f32_16x16x32_bf16 v[64:67], v[96:99], v[164:167], v[64:67]
    s_waitcnt lgkmcnt(15)
    v_mfma_f32_16x16x32_bf16 v[68:71], v[100:103], v[164:167], v[68:71]
    s_cmp_eq_u32 s62, 3
    s_cbranch_scc0 L_cfl_9
    v_add_u32 v148, 96256, v1
    ds_write_b128 v148, v[40:43] offset:0
    ds_write_b128 v148, v[44:47] offset:1024
    ds_write_b128 v148, v[48:51] offset:2048
    ds_write_b128 v148, v[52:55] offset:3072
    ds_write_b128 v148, v[56:59] offset:4096
    ds_write_b128 v148, v[60:63] offset:5120
    ds_write_b128 v148, v[64:67] offset:6144
    ds_write_b128 v148, v[68:71] offset:7168
    v_mov_b64 v[40:41], 0
    v_mov_b64 v[42:43], 0
    v_mov_b64 v[44:45], 0
    v_mov_b64 v[46:47], 0
    v_mov_b64 v[48:49], 0
    v_mov_b64 v[50:51], 0
    v_mov_b64 v[52:53], 0
    v_mov_b64 v[54:55], 0
    v_mov_b64 v[56:57], 0
    v_mov_b64 v[58:59], 0
    v_mov_b64 v[60:61], 0
    v_mov_b64 v[62:63], 0
    v_mov_b64 v[64:65], 0
    v_mov_b64 v[66:67], 0
    v_mov_b64 v[68:69], 0
    v_mov_b64 v[70:71], 0
L_cfl_9:
    s_waitcnt lgkmcnt(12)
    s_nop 0
    v_mfma_f32_16x16x32_bf16 v[68:71], v[72:75], v[132:135], v[68:71]
    s_mul_i32 s12, s62, 8320
    s_mul_i32 s13, s62, 4608
    v_mfma_f32_16x16x32_bf16 v[64:67], v[72:75], v[128:131], v[64:67]
    buffer_load_dwordx4 a[180:183], v1, s[52:55], s94 offen offset:1024 sc1
    s_add_u32 s12, s12, 128284
    s_waitcnt lgkmcnt(6)
    v_mfma_f32_16x16x32_bf16 v[60:63], v[72:75], v[124:127], v[60:63]
    s_add_u32 s13, s13, 150144
    v_mfma_f32_16x16x32_bf16 v[56:59], v[72:75], v[120:123], v[56:59]
    v_mfma_f32_16x16x32_bf16 v[52:55], v[72:75], v[116:119], v[52:55]
    buffer_load_dwordx4 a[184:187], v1, s[52:55], s94 offen offset:2048 sc1
    s_cmp_eq_u32 s62, 3
    s_cselect_b32 s12, 144796, s12
    s_cselect_b32 s13, 159232, s13
    v_mfma_f32_16x16x32_bf16 v[48:51], v[72:75], v[112:115], v[48:51]
    v_add_u32 v156, s12, v136
    v_mfma_f32_16x16x32_bf16 v[44:47], v[72:75], v[108:111], v[44:47]
    v_add_u32 v161, s13, v137
    v_subrev_u32 v157, 1024, v156
    v_mfma_f32_16x16x32_bf16 v[40:43], v[72:75], v[104:107], v[40:43]
    buffer_load_dwordx4 a[188:191], v1, s[52:55], s94 offen offset:3072 sc1
    v_subrev_u32 v158, 2048, v156
    v_mfma_f32_16x16x32_bf16 v[68:71], v[76:79], v[128:131], v[68:71]
    v_subrev_u32 v159, 3072, v156
    v_mfma_f32_16x16x32_bf16 v[64:67], v[76:79], v[124:127], v[64:67]
    ds_read2_b32 v[96:97], v155 offset0:128 offset1:129
    v_mfma_f32_16x16x32_bf16 v[60:63], v[76:79], v[120:123], v[60:63]
    ds_read2_b32 v[98:99], v155 offset0:130 offset1:131
    v_mfma_f32_16x16x32_bf16 v[56:59], v[76:79], v[116:119], v[56:59]
    s_add_u32 s94, s94, 4096
    buffer_load_dwordx4 a[192:195], v1, s[52:55], s94 offen offset:0 sc1
    ds_read2_b32 v[100:101], v155 offset0:0 offset1:1
    v_mfma_f32_16x16x32_bf16 v[52:55], v[76:79], v[112:115], v[52:55]
    ds_read2_b32 v[102:103], v155 offset0:2 offset1:3
    v_mfma_f32_16x16x32_bf16 v[48:51], v[76:79], v[108:111], v[48:51]
    ds_read_b128 v[176:179], v161 offset:1536
    v_mfma_f32_16x16x32_bf16 v[44:47], v[76:79], v[104:107], v[44:47]
    buffer_load_dwordx4 a[196:199], v1, s[52:55], s94 offen offset:1024 sc1
    ds_read_b128 v[172:175], v161 offset:1024
    v_mfma_f32_16x16x32_bf16 v[68:71], v[80:83], v[124:127], v[68:71]
    ds_read_b128 v[168:171], v161 offset:512
    v_mfma_f32_16x16x32_bf16 v[64:67], v[80:83], v[120:123], v[64:67]
    ds_read_b128 v[164:167], v161 offset:0
    v_mfma_f32_16x16x32_bf16 v[60:63], v[80:83], v[116:119], v[60:63]
    buffer_load_dwordx4 a[200:203], v1, s[52:55], s94 offen offset:2048 sc1
    ds_read_b128 v[132:135], v161 offset:3584
    v_mfma_f32_16x16x32_bf16 v[56:59], v[80:83], v[112:115], v[56:59]
    ds_read2_b32 v[72:73], v156 offset0:128 offset1:129
    v_mfma_f32_16x16x32_bf16 v[52:55], v[80:83], v[108:111], v[52:55]
    ds_read2_b32 v[74:75], v156 offset0:130 offset1:131
    v_mfma_f32_16x16x32_bf16 v[48:51], v[80:83], v[104:107], v[48:51]
    buffer_load_dwordx4 a[204:207], v1, s[52:55], s94 offen offset:3072 sc1
    s_waitcnt lgkmcnt(13)
    v_mfma_f32_16x16x32_bf16 v[68:71], v[84:87], v[120:123], v[68:71]
    ds_read_b128 v[128:131], v161 offset:3072
    v_mfma_f32_16x16x32_bf16 v[64:67], v[84:87], v[116:119], v[64:67]
    ds_read2_b32 v[76:77], v156 offset0:0 offset1:1
    v_mfma_f32_16x16x32_bf16 v[60:63], v[84:87], v[112:115], v[60:63]
    ds_read2_b32 v[78:79], v156 offset0:2 offset1:3
    v_mfma_f32_16x16x32_bf16 v[56:59], v[84:87], v[108:111], v[56:59]
    s_add_u32 s94, s94, 4096
    buffer_load_dwordx4 a[208:211], v1, s[52:55], s94 offen offset:0 sc1
    ds_read_b128 v[124:127], v161 offset:2560
    v_mfma_f32_16x16x32_bf16 v[52:55], v[84:87], v[104:107], v[52:55]
    ds_read2_b32 v[80:81], v157 offset0:128 offset1:129
    v_mfma_f32_16x16x32_bf16 v[68:71], v[88:91], v[116:119], v[68:71]
    ds_read2_b32 v[82:83], v157 offset0:130 offset1:131
    v_mfma_f32_16x16x32_bf16 v[64:67], v[88:91], v[112:115], v[64:67]
    buffer_load_dwordx4 a[212:215], v1, s[52:55], s94 offen offset:1024 sc1
    ds_read_b128 v[120:123], v161 offset:2048
    v_mfma_f32_16x16x32_bf16 v[60:63], v[88:91], v[108:111], v[60:63]
    ds_read2_b32 v[84:85], v157 offset0:0 offset1:1
    v_mfma_f32_16x16x32_bf16 v[56:59], v[88:91], v[104:107], v[56:59]
    s_waitcnt lgkmcnt(15)
    v_mfma_f32_16x16x32_bf16 v[68:71], v[92:95], v[112:115], v[68:71]
    buffer_load_dwordx4 a[216:219], v1, s[52:55], s94 offen offset:2048 sc1
    ds_read2_b32 v[86:87], v157 offset0:2 offset1:3
    v_mfma_f32_16x16x32_bf16 v[64:67], v[92:95], v[108:111], v[64:67]
    ds_read2_b32 v[88:89], v158 offset0:128 offset1:129
    v_mfma_f32_16x16x32_bf16 v[60:63], v[92:95], v[104:107], v[60:63]
    ds_read2_b32 v[90:91], v158 offset0:130 offset1:131
    v_mfma_f32_16x16x32_bf16 v[68:71], v[96:99], v[108:111], v[68:71]
    ds_read2_b32 v[92:93], v158 offset0:0 offset1:1
    v_mfma_f32_16x16x32_bf16 v[64:67], v[96:99], v[104:107], v[64:67]
    buffer_load_dwordx4 a[220:223], v1, s[52:55], s94 offen offset:3072 sc1
    v_mfma_f32_16x16x32_bf16 v[68:71], v[100:103], v[104:107], v[68:71]
    s_waitcnt lgkmcnt(11)
    v_mfma_f32_16x16x32_bf16 v[68:71], v[72:75], v[132:135], v[68:71]
    ds_read2_b32 v[94:95], v158 offset0:2 offset1:3
    v_mfma_f32_16x16x32_bf16 v[64:67], v[72:75], v[128:131], v[64:67]
    s_add_u32 s94, s94, 4096
    buffer_load_dwordx4 a[224:227], v1, s[52:55], s94 offen offset:0 sc1
    s_waitcnt lgkmcnt(6)
    v_mfma_f32_16x16x32_bf16 v[60:63], v[72:75], v[124:127], v[60:63]
    ds_read2_b32 v[96:97], v159 offset0:128 offset1:129
    v_mfma_f32_16x16x32_bf16 v[56:59], v[72:75], v[120:123], v[56:59]
    v_mfma_f32_16x16x32_bf16 v[52:55], v[72:75], v[176:179], v[52:55]
    buffer_load_dwordx4 a[228:231], v1, s[52:55], s94 offen offset:1024 sc1
    ds_read2_b32 v[98:99], v159 offset0:130 offset1:131
    v_mfma_f32_16x16x32_bf16 v[48:51], v[72:75], v[172:175], v[48:51]
    v_mfma_f32_16x16x32_bf16 v[44:47], v[72:75], v[168:171], v[44:47]
    ds_read2_b32 v[100:101], v159 offset0:0 offset1:1
    v_mfma_f32_16x16x32_bf16 v[40:43], v[72:75], v[164:167], v[40:43]
    v_mfma_f32_16x16x32_bf16 v[68:71], v[76:79], v[128:131], v[68:71]
    s_lshl_b32 s75, s61, 2
    s_add_u32 s75, s75, s62
    s_lshl_b32 s75, s75, 10
    s_add_u32 s75, s75, 413696
    v_lshrrev_b32 v182, 3, v0
    v_lshlrev_b32 v182, 7, v182
    buffer_load_dwordx2 v[184:185], v182, s[52:55], s75 offen sc1
    buffer_load_dwordx4 a[232:235], v1, s[52:55], s94 offen offset:2048 sc1
    ds_read2_b32 v[102:103], v159 offset0:2 offset1:3
    v_mfma_f32_16x16x32_bf16 v[64:67], v[76:79], v[124:127], v[64:67]
    v_mfma_f32_16x16x32_bf16 v[60:63], v[76:79], v[120:123], v[60:63]
    v_mfma_f32_16x16x32_bf16 v[56:59], v[76:79], v[176:179], v[56:59]
    v_mfma_f32_16x16x32_bf16 v[52:55], v[76:79], v[172:175], v[52:55]
    buffer_load_dwordx4 a[236:239], v1, s[52:55], s94 offen offset:3072 sc1
    v_mfma_f32_16x16x32_bf16 v[48:51], v[76:79], v[168:171], v[48:51]
    v_mfma_f32_16x16x32_bf16 v[44:47], v[76:79], v[164:167], v[44:47]
    v_mfma_f32_16x16x32_bf16 v[68:71], v[80:83], v[124:127], v[68:71]
    v_mfma_f32_16x16x32_bf16 v[64:67], v[80:83], v[120:123], v[64:67]
    s_add_u32 s94, s94, 4096
    buffer_load_dwordx4 a[240:243], v1, s[52:55], s94 offen offset:0 sc1
    v_mfma_f32_16x16x32_bf16 v[60:63], v[80:83], v[176:179], v[60:63]
    v_mfma_f32_16x16x32_bf16 v[56:59], v[80:83], v[172:175], v[56:59]
    v_mfma_f32_16x16x32_bf16 v[52:55], v[80:83], v[168:171], v[52:55]
    v_mfma_f32_16x16x32_bf16 v[48:51], v[80:83], v[164:167], v[48:51]
    s_waitcnt lgkmcnt(6)
    v_mfma_f32_16x16x32_bf16 v[68:71], v[84:87], v[120:123], v[68:71]
    buffer_load_dwordx4 a[244:247], v1, s[52:55], s94 offen offset:1024 sc1
    v_mfma_f32_16x16x32_bf16 v[64:67], v[84:87], v[176:179], v[64:67]
    v_mfma_f32_16x16x32_bf16 v[60:63], v[84:87], v[172:175], v[60:63]
    v_mfma_f32_16x16x32_bf16 v[56:59], v[84:87], v[168:171], v[56:59]
    v_mfma_f32_16x16x32_bf16 v[52:55], v[84:87], v[164:167], v[52:55]
    buffer_load_dwordx4 a[248:251], v1, s[52:55], s94 offen offset:2048 sc1
    v_mfma_f32_16x16x32_bf16 v[68:71], v[88:91], v[176:179], v[68:71]
    v_mfma_f32_16x16x32_bf16 v[64:67], v[88:91], v[172:175], v[64:67]
    v_mfma_f32_16x16x32_bf16 v[60:63], v[88:91], v[168:171], v[60:63]
    v_mfma_f32_16x16x32_bf16 v[56:59], v[88:91], v[164:167], v[56:59]
    buffer_load_dwordx4 a[252:255], v1, s[52:55], s94 offen offset:3072 sc1
    s_waitcnt lgkmcnt(2)
    v_mfma_f32_16x16x32_bf16 v[68:71], v[92:95], v[172:175], v[68:71]
    v_mfma_f32_16x16x32_bf16 v[64:67], v[92:95], v[168:171], v[64:67]
    v_mfma_f32_16x16x32_bf16 v[60:63], v[92:95], v[164:167], v[60:63]
    v_mfma_f32_16x16x32_bf16 v[68:71], v[96:99], v[168:171], v[68:71]
    v_mfma_f32_16x16x32_bf16 v[64:67], v[96:99], v[164:167], v[64:67]
    s_waitcnt lgkmcnt(0)
    v_mfma_f32_16x16x32_bf16 v[68:71], v[100:103], v[164:167], v[68:71]
    s_cmp_eq_u32 s62, 3
    s_cbranch_scc0 L_cfl_10
    v_add_u32 v148, 104448, v1
    ds_write_b128 v148, v[40:43] offset:0
    ds_write_b128 v148, v[44:47] offset:1024
    ds_write_b128 v148, v[48:51] offset:2048
    ds_write_b128 v148, v[52:55] offset:3072
    ds_write_b128 v148, v[56:59] offset:4096
    ds_write_b128 v148, v[60:63] offset:5120
    ds_write_b128 v148, v[64:67] offset:6144
    ds_write_b128 v148, v[68:71] offset:7168
L_cfl_10:
    s_waitcnt lgkmcnt(0)
    s_barrier
    s_waitcnt vmcnt(6)
    v_cmp_ne_u64 vcc, s[64:65], v[184:185]
    s_cbranch_vccz L_chk_11_ok
    s_mov_b32 s82, 0
L_chk_11:
    s_sleep 1
    buffer_load_dwordx2 v[184:185], v182, s[52:55], s75 offen sc1
    s_add_u32 s82, s82, 1
    s_cmp_gt_u32 s82, 0x40000
    s_waitcnt vmcnt(0)
    s_cbranch_scc1 L_chk_11_ok
    v_cmp_ne_u64 vcc, s[64:65], v[184:185]
    s_cbranch_vccnz L_chk_11
L_chk_11_ok:
    s_add_u32 s71, s4, 0
    buffer_load_dwordx4 v[104:107], v1, s[52:55], s71 offen offset:0 sc1
    buffer_load_dwordx4 v[108:111], v1, s[52:55], s71 offen offset:1024 sc1
    buffer_load_dwordx4 v[112:115], v1, s[52:55], s71 offen offset:2048 sc1
    buffer_load_dwordx4 v[116:119], v1, s[52:55], s71 offen offset:3072 sc1
    s_add_u32 s71, s4, 4096
    buffer_load_dwordx2 v[120:121], v36, s[52:55], s71 offen offset:0 sc1
    s_lshl_b32 s66, s62, 13
    buffer_load_dwordx2 v[122:123], v36, s[52:55], s71 offen offset:512 sc1
    s_add_u32 s66, s66, 88064
    v_add_u32 v102, s66, v1
    ds_read_b128 v[72:75], v102 offset:0
    ds_read_b128 v[76:79], v102 offset:1024
    ds_read_b128 v[80:83], v102 offset:2048
    ds_read_b128 v[84:87], v102 offset:3072
    ds_read_b128 v[88:91], v102 offset:4096
    buffer_load_dwordx2 v[124:125], v36, s[52:55], s71 offen offset:1024 sc1
    ds_read_b128 v[92:95], v102 offset:5120
    ds_read_b128 v[96:99], v102 offset:6144
    s_mul_i32 s67, s62, 4608
    s_add_u32 s67, s67, 150016
    s_cmp_eq_u32 s62, 3
    s_cselect_b32 s67, 125056, s67
    v_lshlrev_b32 v100, 5, v2
    buffer_load_dwordx2 v[126:127], v36, s[52:55], s71 offen offset:1536 sc1
    v_lshl_add_u32 v100, v3, 3, v100
    v_add_u32 v100, s67, v100
    v_add_u32 v101, s67, v1
    s_lshl_b32 s66, s76, 12
    s_add_u32 s66, s66, 19398656
    s_cmp_eq_u32 s77, 1
    s_cselect_b32 s66, s66, 0x7ffff000
    s_waitcnt lgkmcnt(6)
    buffer_load_dwordx4 v[128:131], v1, s[52:55], s71 offen offset:2048 sc1
    v_pk_add_f32 v[40:41], v[40:41], v[72:73]
    v_pk_add_f32 v[42:43], v[42:43], v[74:75]
    ds_read_b128 v[72:75], v102 offset:7168
    v_cvt_pk_bf16_f32 v40, v40, v41
    v_cvt_pk_bf16_f32 v41, v42, v43
    ds_write_b64 v100, v[40:41] offset:0
    s_waitcnt lgkmcnt(7)
    buffer_load_dwordx4 v[132:135], v1, s[52:55], s71 offen offset:3072 sc1
    v_pk_add_f32 v[44:45], v[44:45], v[76:77]
    v_pk_add_f32 v[46:47], v[46:47], v[78:79]
    v_cvt_pk_bf16_f32 v44, v44, v45
    v_cvt_pk_bf16_f32 v45, v46, v47
    ds_write_b64 v100, v[44:45] offset:512
    s_waitcnt lgkmcnt(7)
    v_pk_add_f32 v[48:49], v[48:49], v[80:81]
    v_pk_add_f32 v[50:51], v[50:51], v[82:83]
    s_add_u32 s71, s4, 8192
    buffer_load_dwordx4 v[136:139], v1, s[52:55], s71 offen offset:0 sc1
    v_cvt_pk_bf16_f32 v48, v48, v49
    v_cvt_pk_bf16_f32 v49, v50, v51
    ds_write_b64 v100, v[48:49] offset:1024
    s_waitcnt lgkmcnt(7)
    v_pk_add_f32 v[52:53], v[52:53], v[84:85]
    v_pk_add_f32 v[54:55], v[54:55], v[86:87]
    v_cvt_pk_bf16_f32 v52, v52, v53
    buffer_load_dwordx4 v[140:143], v1, s[52:55], s71 offen offset:1024 sc1
    v_cvt_pk_bf16_f32 v53, v54, v55
    ds_write_b64 v100, v[52:53] offset:1536
    s_waitcnt lgkmcnt(7)
    v_pk_add_f32 v[56:57], v[56:57], v[88:89]
    v_pk_add_f32 v[58:59], v[58:59], v[90:91]
    v_cvt_pk_bf16_f32 v56, v56, v57
    v_cvt_pk_bf16_f32 v57, v58, v59
    ds_write_b64 v100, v[56:57] offset:2048
    buffer_load_dwordx2 v[144:145], v36, s[52:55], s71 offen offset:2048 sc1
    s_waitcnt lgkmcnt(7)
    v_pk_add_f32 v[60:61], v[60:61], v[92:93]
    v_pk_add_f32 v[62:63], v[62:63], v[94:95]
    v_cvt_pk_bf16_f32 v60, v60, v61
    v_cvt_pk_bf16_f32 v61, v62, v63
    ds_write_b64 v100, v[60:61] offset:2560
    s_waitcnt lgkmcnt(7)
    buffer_load_dwordx2 v[146:147], v36, s[52:55], s71 offen offset:2560 sc1
    v_pk_add_f32 v[64:65], v[64:65], v[96:97]
    v_pk_add_f32 v[66:67], v[66:67], v[98:99]
    v_cvt_pk_bf16_f32 v64, v64, v65
    v_cvt_pk_bf16_f32 v65, v66, v67
    ds_write_b64 v100, v[64:65] offset:3072
    s_waitcnt lgkmcnt(7)
    v_pk_add_f32 v[68:69], v[68:69], v[72:73]
    v_pk_add_f32 v[70:71], v[70:71], v[74:75]
    buffer_load_dwordx2 v[148:149], v36, s[52:55], s71 offen offset:3072 sc1
    v_cvt_pk_bf16_f32 v68, v68, v69
    v_cvt_pk_bf16_f32 v69, v70, v71
    ds_write_b64 v100, v[68:69] offset:3584
    ds_read_b128 v[76:79], v101 offset:0
    ds_read_b128 v[80:83], v101 offset:1024
    ds_read_b128 v[84:87], v101 offset:2048
    ds_read_b128 v[88:91], v101 offset:3072
    buffer_load_dwordx2 v[150:151], v36, s[52:55], s71 offen offset:3584 sc1
    s_waitcnt lgkmcnt(3)
    buffer_store_dwordx4 v[76:79], v1, s[52:55], s66 offen offset:0 sc1
    s_waitcnt lgkmcnt(2)
    buffer_store_dwordx4 v[80:83], v1, s[52:55], s66 offen offset:1024 sc1
    s_waitcnt lgkmcnt(1)
    buffer_store_dwordx4 v[84:87], v1, s[52:55], s66 offen offset:2048 sc1
    s_waitcnt lgkmcnt(0)
    buffer_store_dwordx4 v[88:91], v1, s[52:55], s66 offen offset:3072 sc1
    s_add_u32 s71, s5, 0
    buffer_load_dwordx4 v[152:155], v1, s[52:55], s71 offen offset:0 sc1
    buffer_load_dwordx4 v[156:159], v1, s[52:55], s71 offen offset:1024 sc1
    buffer_load_dwordx4 v[160:163], v1, s[52:55], s71 offen offset:2048 sc1
    buffer_load_dwordx4 v[164:167], v1, s[52:55], s71 offen offset:3072 sc1
    s_mul_i32 s66, s62, 15360
    s_add_u32 s66, s66, 0
    v_add_u32 v169, s66, v1
    s_waitcnt vmcnt(23)
    v_mfma_f32_16x16x32_bf16 v[40:43], v[186:189], v[104:107], 0
    v_mfma_f32_16x16x32_bf16 v[44:47], v[190:193], v[104:107], 0
    v_mfma_f32_16x16x32_bf16 v[48:51], v[194:197], v[104:107], 0
    v_mfma_f32_16x16x32_bf16 v[52:55], v[198:201], v[104:107], 0
    v_mfma_f32_16x16x32_bf16 v[56:59], v[202:205], v[104:107], 0
    s_waitcnt vmcnt(22)
    v_mfma_f32_16x16x32_bf16 v[40:43], v[206:209], v[108:111], v[40:43]
    s_add_u32 s71, s5, 4096
    buffer_load_dwordx2 v[104:105], v36, s[52:55], s71 offen offset:0 sc1
    buffer_load_dwordx2 v[106:107], v36, s[52:55], s71 offen offset:512 sc1
    v_mfma_f32_16x16x32_bf16 v[44:47], v[210:213], v[108:111], v[44:47]
    v_mfma_f32_16x16x32_bf16 v[48:51], v[214:217], v[108:111], v[48:51]
    v_mfma_f32_16x16x32_bf16 v[52:55], v[218:221], v[108:111], v[52:55]
    v_mfma_f32_16x16x32_bf16 v[56:59], v[222:225], v[108:111], v[56:59]
    s_waitcnt vmcnt(23)
    v_mfma_f32_16x16x32_bf16 v[40:43], v[226:229], v[112:115], v[40:43]
    buffer_load_dwordx2 v[108:109], v36, s[52:55], s71 offen offset:1024 sc1
    buffer_load_dwordx2 v[110:111], v36, s[52:55], s71 offen offset:1536 sc1
    v_mfma_f32_16x16x32_bf16 v[44:47], v[230:233], v[112:115], v[44:47]
    v_mfma_f32_16x16x32_bf16 v[48:51], v[234:237], v[112:115], v[48:51]
    v_mfma_f32_16x16x32_bf16 v[52:55], v[238:241], v[112:115], v[52:55]
    v_mfma_f32_16x16x32_bf16 v[56:59], v[242:245], v[112:115], v[56:59]
    s_waitcnt vmcnt(24)
    v_mfma_f32_16x16x32_bf16 v[40:43], v[246:249], v[116:119], v[40:43]
    buffer_load_dwordx4 v[112:115], v1, s[52:55], s71 offen offset:2048 sc1
    v_mfma_f32_16x16x32_bf16 v[44:47], v[250:253], v[116:119], v[44:47]
    v_mfma_f32_16x16x32_bf16 v[48:51], a[84:87], v[116:119], v[48:51]
    v_mfma_f32_16x16x32_bf16 v[52:55], a[88:91], v[116:119], v[52:55]
    v_mfma_f32_16x16x32_bf16 v[56:59], a[92:95], v[116:119], v[56:59]
    s_waitcnt vmcnt(23)
    v_mfma_f32_16x16x32_bf16 v[40:43], a[96:99], v[120:123], v[40:43]
    buffer_load_dwordx4 v[116:119], v1, s[52:55], s71 offen offset:3072 sc1
    v_mfma_f32_16x16x32_bf16 v[44:47], a[100:103], v[120:123], v[44:47]
    v_mfma_f32_16x16x32_bf16 v[48:51], a[104:107], v[120:123], v[48:51]
    v_mfma_f32_16x16x32_bf16 v[52:55], a[108:111], v[120:123], v[52:55]
    v_mfma_f32_16x16x32_bf16 v[56:59], a[112:115], v[120:123], v[56:59]
    s_waitcnt vmcnt(22)
    v_mfma_f32_16x16x32_bf16 v[40:43], a[116:119], v[124:127], v[40:43]
    s_add_u32 s71, s5, 8192
    buffer_load_dwordx4 v[120:123], v1, s[52:55], s71 offen offset:0 sc1
    v_mfma_f32_16x16x32_bf16 v[44:47], a[120:123], v[124:127], v[44:47]
    v_mfma_f32_16x16x32_bf16 v[48:51], a[124:127], v[124:127], v[48:51]
    v_mfma_f32_16x16x32_bf16 v[52:55], a[128:131], v[124:127], v[52:55]
    v_mfma_f32_16x16x32_bf16 v[56:59], a[132:135], v[124:127], v[56:59]
    s_waitcnt vmcnt(22)
    v_mfma_f32_16x16x32_bf16 v[40:43], a[136:139], v[128:131], v[40:43]
    buffer_load_dwordx4 v[124:127], v1, s[52:55], s71 offen offset:1024 sc1
    v_mfma_f32_16x16x32_bf16 v[44:47], a[140:143], v[128:131], v[44:47]
    v_mfma_f32_16x16x32_bf16 v[48:51], a[144:147], v[128:131], v[48:51]
    v_mfma_f32_16x16x32_bf16 v[52:55], a[148:151], v[128:131], v[52:55]
    v_mfma_f32_16x16x32_bf16 v[56:59], a[152:155], v[128:131], v[56:59]
    s_waitcnt vmcnt(22)
    v_mfma_f32_16x16x32_bf16 v[40:43], a[156:159], v[132:135], v[40:43]
    buffer_load_dwordx2 v[128:129], v36, s[52:55], s71 offen offset:2048 sc1
    buffer_load_dwordx2 v[130:131], v36, s[52:55], s71 offen offset:2560 sc1
    v_mfma_f32_16x16x32_bf16 v[44:47], a[160:163], v[132:135], v[44:47]
    v_mfma_f32_16x16x32_bf16 v[48:51], a[164:167], v[132:135], v[48:51]
    v_mfma_f32_16x16x32_bf16 v[52:55], a[168:171], v[132:135], v[52:55]
    v_mfma_f32_16x16x32_bf16 v[56:59], a[172:175], v[132:135], v[56:59]
    s_waitcnt vmcnt(23)
    v_mfma_f32_16x16x32_bf16 v[40:43], a[176:179], v[136:139], v[40:43]
    buffer_load_dwordx2 v[132:133], v36, s[52:55], s71 offen offset:3072 sc1
    buffer_load_dwordx2 v[134:135], v36, s[52:55], s71 offen offset:3584 sc1
    v_mfma_f32_16x16x32_bf16 v[44:47], a[180:183], v[136:139], v[44:47]
    v_mfma_f32_16x16x32_bf16 v[48:51], a[184:187], v[136:139], v[48:51]
    v_mfma_f32_16x16x32_bf16 v[52:55], a[188:191], v[136:139], v[52:55]
    v_mfma_f32_16x16x32_bf16 v[56:59], a[192:195], v[136:139], v[56:59]
    s_waitcnt vmcnt(24)
    v_mfma_f32_16x16x32_bf16 v[40:43], a[196:199], v[140:143], v[40:43]
    s_add_u32 s71, s6, 0
    buffer_load_dwordx4 v[136:139], v1, s[52:55], s71 offen offset:0 sc1
    v_mfma_f32_16x16x32_bf16 v[44:47], a[200:203], v[140:143], v[44:47]
    v_mfma_f32_16x16x32_bf16 v[48:51], a[204:207], v[140:143], v[48:51]
    v_mfma_f32_16x16x32_bf16 v[52:55], a[208:211], v[140:143], v[52:55]
    v_mfma_f32_16x16x32_bf16 v[56:59], a[212:215], v[140:143], v[56:59]
    s_waitcnt vmcnt(16)
    s_cmp_eq_u32 s77, 0
    s_cbranch_scc1 L_g3_skip
    s_lshl_b32 s66, s76, 7
    s_add_u32 s66, s66, 69632
    s_mov_b64 exec, 65535
    buffer_store_dwordx2 v[38:39], v36, s[52:55], s66 offen sc1
    s_mov_b64 exec, -1
L_g3_skip:
    v_mfma_f32_16x16x32_bf16 v[40:43], a[216:219], v[144:147], v[40:43]
    buffer_load_dwordx4 v[140:143], v1, s[52:55], s71 offen offset:1024 sc1
    v_mfma_f32_16x16x32_bf16 v[44:47], a[220:223], v[144:147], v[44:47]
    v_mfma_f32_16x16x32_bf16 v[48:51], a[224:227], v[144:147], v[48:51]
    v_mfma_f32_16x16x32_bf16 v[52:55], a[228:231], v[144:147], v[52:55]
    v_mfma_f32_16x16x32_bf16 v[56:59], a[232:235], v[144:147], v[56:59]
    v_mfma_f32_16x16x32_bf16 v[40:43], a[236:239], v[148:151], v[40:43]
    buffer_load_dwordx4 v[144:147], v1, s[52:55], s71 offen offset:2048 sc1
    v_mfma_f32_16x16x32_bf16 v[44:47], a[240:243], v[148:151], v[44:47]
    v_mfma_f32_16x16x32_bf16 v[48:51], a[244:247], v[148:151], v[48:51]
    v_mfma_f32_16x16x32_bf16 v[52:55], a[248:251], v[148:151], v[52:55]
    v_mfma_f32_16x16x32_bf16 v[56:59], a[252:255], v[148:151], v[56:59]
    v_mfma_f32_16x16x32_bf16 v[60:63], v[186:189], v[152:155], 0
    buffer_load_dwordx4 v[148:151], v1, s[52:55], s71 offen offset:3072 sc1
    v_mfma_f32_16x16x32_bf16 v[64:67], v[190:193], v[152:155], 0
    v_mfma_f32_16x16x32_bf16 v[68:71], v[194:197], v[152:155], 0
    s_add_u32 s66, s62, 1
    v_mfma_f32_16x16x32_bf16 v[72:75], v[198:201], v[152:155], 0
    s_and_b32 s66, s66, 3
    v_mfma_f32_16x16x32_bf16 v[76:79], v[202:205], v[152:155], 0
    s_mul_i32 s66, s66, 15360
    s_waitcnt vmcnt(18)
    v_mfma_f32_16x16x32_bf16 v[60:63], v[206:209], v[156:159], v[60:63]
    s_add_u32 s66, s66, 0
    s_add_u32 s71, s6, 4096
    buffer_load_dwordx2 v[152:153], v36, s[52:55], s71 offen offset:0 sc1
    buffer_load_dwordx2 v[154:155], v36, s[52:55], s71 offen offset:512 sc1
    v_mfma_f32_16x16x32_bf16 v[64:67], v[210:213], v[156:159], v[64:67]
    v_add_u32 v168, s66, v1
    v_mfma_f32_16x16x32_bf16 v[68:71], v[214:217], v[156:159], v[68:71]
    ds_write_b128 v168, v[40:43] offset:0
    v_mfma_f32_16x16x32_bf16 v[72:75], v[218:221], v[156:159], v[72:75]
    ds_write_b128 v168, v[44:47] offset:1024
    ds_write_b128 v168, v[48:51] offset:2048
    v_mfma_f32_16x16x32_bf16 v[76:79], v[222:225], v[156:159], v[76:79]
    ds_write_b128 v168, v[52:55] offset:3072
    s_waitcnt vmcnt(19)
    v_mfma_f32_16x16x32_bf16 v[60:63], v[226:229], v[160:163], v[60:63]
    ds_write_b128 v168, v[56:59] offset:4096
    buffer_load_dwordx2 v[156:157], v36, s[52:55], s71 offen offset:1024 sc1
    buffer_load_dwordx2 v[158:159], v36, s[52:55], s71 offen offset:1536 sc1
    v_mfma_f32_16x16x32_bf16 v[64:67], v[230:233], v[160:163], v[64:67]
    v_lshrrev_b32 v24, 2, v0
    v_mfma_f32_16x16x32_bf16 v[68:71], v[234:237], v[160:163], v[68:71]
    v_lshlrev_b32 v24, 7, v24
    v_mfma_f32_16x16x32_bf16 v[72:75], v[238:241], v[160:163], v[72:75]
    v_and_b32 v25, 3, v0
    v_mfma_f32_16x16x32_bf16 v[76:79], v[242:245], v[160:163], v[76:79]
    v_lshl_add_u32 v24, v25, 3, v24
    s_waitcnt vmcnt(20)
    v_mfma_f32_16x16x32_bf16 v[60:63], v[246:249], v[164:167], v[60:63]
    s_lshl_b32 s66, s62, 5
    buffer_load_dwordx4 v[160:163], v1, s[52:55], s71 offen offset:2048 sc1
    v_mfma_f32_16x16x32_bf16 v[64:67], v[250:253], v[164:167], v[64:67]
    s_add_u32 s66, s66, 61440
    v_mfma_f32_16x16x32_bf16 v[68:71], a[84:87], v[164:167], v[68:71]
    v_add_u32 v24, s66, v24
    v_mfma_f32_16x16x32_bf16 v[72:75], a[88:91], v[164:167], v[72:75]
    s_mul_i32 s66, s62, 2816
    v_mfma_f32_16x16x32_bf16 v[76:79], a[92:95], v[164:167], v[76:79]
    s_add_u32 s66, s66, 73728
    s_waitcnt vmcnt(19)
    v_mfma_f32_16x16x32_bf16 v[60:63], a[96:99], v[104:107], v[60:63]
    v_mul_u32_u24 v25, 176, v2
    buffer_load_dwordx4 v[164:167], v1, s[52:55], s71 offen offset:3072 sc1
    v_mfma_f32_16x16x32_bf16 v[64:67], a[100:103], v[104:107], v[64:67]
    v_lshl_add_u32 v25, v3, 3, v25
    v_mfma_f32_16x16x32_bf16 v[68:71], a[104:107], v[104:107], v[68:71]
    v_add_u32 v25, s66, v25
    v_add_u32 v26, 0, v0
    v_mfma_f32_16x16x32_bf16 v[72:75], a[108:111], v[104:107], v[72:75]
    v_mul_u32_u24 v29, 6554, v26
    v_mfma_f32_16x16x32_bf16 v[76:79], a[112:115], v[104:107], v[76:79]
    v_lshrrev_b32 v29, 16, v29
    s_waitcnt vmcnt(18)
    v_mfma_f32_16x16x32_bf16 v[60:63], a[116:119], v[108:111], v[60:63]
    v_mul_u32_u24 v32, 10, v29
    s_add_u32 s71, s6, 8192
    buffer_load_dwordx4 v[104:107], v1, s[52:55], s71 offen offset:0 sc1
    v_mfma_f32_16x16x32_bf16 v[64:67], a[120:123], v[108:111], v[64:67]
    v_sub_u32 v32, v26, v32
    v_mfma_f32_16x16x32_bf16 v[68:71], a[124:127], v[108:111], v[68:71]
    v_lshlrev_b32 v32, 4, v32
    v_mfma_f32_16x16x32_bf16 v[72:75], a[128:131], v[108:111], v[72:75]
    v_mul_u32_u24 v26, 176, v29
    v_mfma_f32_16x16x32_bf16 v[76:79], a[132:135], v[108:111], v[76:79]
    v_add3_u32 v26, v26, v32, s66
    s_waitcnt vmcnt(18)
    v_mfma_f32_16x16x32_bf16 v[60:63], a[136:139], v[112:115], v[60:63]
    v_mul_u32_u24 v29, 1280, v29
    buffer_load_dwordx4 v[108:111], v1, s[52:55], s71 offen offset:1024 sc1
    v_mfma_f32_16x16x32_bf16 v[64:67], a[140:143], v[112:115], v[64:67]
    v_add_u32 v29, v29, v32
    v_mfma_f32_16x16x32_bf16 v[68:71], a[144:147], v[112:115], v[68:71]
    v_add_u32 v27, 64, v0
    v_mfma_f32_16x16x32_bf16 v[72:75], a[148:151], v[112:115], v[72:75]
    v_mul_u32_u24 v30, 6554, v27
    v_mfma_f32_16x16x32_bf16 v[76:79], a[152:155], v[112:115], v[76:79]
    v_lshrrev_b32 v30, 16, v30
    s_waitcnt vmcnt(18)
    v_mfma_f32_16x16x32_bf16 v[60:63], a[156:159], v[116:119], v[60:63]
    v_mul_u32_u24 v32, 10, v30
    v_sub_u32 v32, v27, v32
    buffer_load_dwordx2 v[112:113], v36, s[52:55], s71 offen offset:2048 sc1
    buffer_load_dwordx2 v[114:115], v36, s[52:55], s71 offen offset:2560 sc1
    v_mfma_f32_16x16x32_bf16 v[64:67], a[160:163], v[116:119], v[64:67]
    v_lshlrev_b32 v32, 4, v32
    v_mfma_f32_16x16x32_bf16 v[68:71], a[164:167], v[116:119], v[68:71]
    v_mul_u32_u24 v27, 176, v30
    v_mfma_f32_16x16x32_bf16 v[72:75], a[168:171], v[116:119], v[72:75]
    v_add3_u32 v27, v27, v32, s66
    v_mfma_f32_16x16x32_bf16 v[76:79], a[172:175], v[116:119], v[76:79]
    v_mul_u32_u24 v30, 1280, v30
    s_waitcnt vmcnt(19)
    v_mfma_f32_16x16x32_bf16 v[60:63], a[176:179], v[120:123], v[60:63]
    v_add_u32 v30, v30, v32
    buffer_load_dwordx2 v[116:117], v36, s[52:55], s71 offen offset:3072 sc1
    buffer_load_dwordx2 v[118:119], v36, s[52:55], s71 offen offset:3584 sc1
    v_mfma_f32_16x16x32_bf16 v[64:67], a[180:183], v[120:123], v[64:67]
    v_add_u32 v28, 128, v0
    v_mfma_f32_16x16x32_bf16 v[68:71], a[184:187], v[120:123], v[68:71]
    v_mul_u32_u24 v31, 6554, v28
    v_mfma_f32_16x16x32_bf16 v[72:75], a[188:191], v[120:123], v[72:75]
    v_lshrrev_b32 v31, 16, v31
    v_mfma_f32_16x16x32_bf16 v[76:79], a[192:195], v[120:123], v[76:79]
    v_mul_u32_u24 v32, 10, v31
    s_waitcnt vmcnt(20)
    v_mfma_f32_16x16x32_bf16 v[60:63], a[196:199], v[124:127], v[60:63]
    v_sub_u32 v32, v28, v32
    s_add_u32 s71, s7, 0
    buffer_load_dwordx4 v[120:123], v1, s[52:55], s71 offen offset:0 sc1
    v_mfma_f32_16x16x32_bf16 v[64:67], a[200:203], v[124:127], v[64:67]
    v_lshlrev_b32 v32, 4, v32
    v_mfma_f32_16x16x32_bf16 v[68:71], a[204:207], v[124:127], v[68:71]
    v_mul_u32_u24 v28, 176, v31
    v_mfma_f32_16x16x32_bf16 v[72:75], a[208:211], v[124:127], v[72:75]
    v_add3_u32 v28, v28, v32, s66
    v_mfma_f32_16x16x32_bf16 v[76:79], a[212:215], v[124:127], v[76:79]
    v_mul_u32_u24 v31, 1280, v31
    v_add_u32 v31, v31, v32
    s_waitcnt vmcnt(19)
    v_mfma_f32_16x16x32_bf16 v[60:63], a[216:219], v[128:131], v[60:63]
    s_lshl_b32 s14, s61, 2
    buffer_load_dwordx4 v[124:127], v1, s[52:55], s71 offen offset:1024 sc1
    v_mfma_f32_16x16x32_bf16 v[64:67], a[220:223], v[128:131], v[64:67]
    s_add_u32 s14, s14, s62
    v_mfma_f32_16x16x32_bf16 v[68:71], a[224:227], v[128:131], v[68:71]
    s_mul_i32 s14, s14, 20480
    v_mfma_f32_16x16x32_bf16 v[72:75], a[228:231], v[128:131], v[72:75]
    s_mul_i32 s68, s60, 160
    v_mfma_f32_16x16x32_bf16 v[76:79], a[232:235], v[128:131], v[76:79]
    s_add_u32 s14, s14, s68
    s_waitcnt vmcnt(18)
    v_mfma_f32_16x16x32_bf16 v[60:63], a[236:239], v[132:135], v[60:63]
    s_mov_b32 s68, 0xbfb8aa3b
    buffer_load_dwordx4 v[128:131], v1, s[52:55], s71 offen offset:2048 sc1
    v_mfma_f32_16x16x32_bf16 v[64:67], a[240:243], v[132:135], v[64:67]
    v_mfma_f32_16x16x32_bf16 v[68:71], a[244:247], v[132:135], v[68:71]
    v_mfma_f32_16x16x32_bf16 v[72:75], a[248:251], v[132:135], v[72:75]
    v_mfma_f32_16x16x32_bf16 v[76:79], a[252:255], v[132:135], v[76:79]
    s_waitcnt vmcnt(18)
    v_mfma_f32_16x16x32_bf16 v[40:43], v[186:189], v[136:139], 0
    buffer_load_dwordx4 v[132:135], v1, s[52:55], s71 offen offset:3072 sc1
    v_mfma_f32_16x16x32_bf16 v[44:47], v[190:193], v[136:139], 0
    v_mfma_f32_16x16x32_bf16 v[48:51], v[194:197], v[136:139], 0
    v_mfma_f32_16x16x32_bf16 v[52:55], v[198:201], v[136:139], 0
    s_add_u32 s66, s62, 2
    v_mfma_f32_16x16x32_bf16 v[56:59], v[202:205], v[136:139], 0
    s_waitcnt vmcnt(18)
    v_mfma_f32_16x16x32_bf16 v[40:43], v[206:209], v[140:143], v[40:43]
    s_add_u32 s71, s7, 4096
    buffer_load_dwordx2 v[136:137], v36, s[52:55], s71 offen offset:0 sc1
    buffer_load_dwordx2 v[138:139], v36, s[52:55], s71 offen offset:512 sc1
    v_mfma_f32_16x16x32_bf16 v[44:47], v[210:213], v[140:143], v[44:47]
    v_mfma_f32_16x16x32_bf16 v[48:51], v[214:217], v[140:143], v[48:51]
    s_and_b32 s66, s66, 3
    v_mfma_f32_16x16x32_bf16 v[52:55], v[218:221], v[140:143], v[52:55]
    v_mfma_f32_16x16x32_bf16 v[56:59], v[222:225], v[140:143], v[56:59]
    s_waitcnt vmcnt(19)
    v_mfma_f32_16x16x32_bf16 v[40:43], v[226:229], v[144:147], v[40:43]
    buffer_load_dwordx2 v[140:141], v36, s[52:55], s71 offen offset:1024 sc1
    buffer_load_dwordx2 v[142:143], v36, s[52:55], s71 offen offset:1536 sc1
    v_mfma_f32_16x16x32_bf16 v[44:47], v[230:233], v[144:147], v[44:47]
    s_mul_i32 s66, s66, 15360
    v_mfma_f32_16x16x32_bf16 v[48:51], v[234:237], v[144:147], v[48:51]
    v_mfma_f32_16x16x32_bf16 v[52:55], v[238:241], v[144:147], v[52:55]
    v_mfma_f32_16x16x32_bf16 v[56:59], v[242:245], v[144:147], v[56:59]
    s_waitcnt vmcnt(20)
    v_mfma_f32_16x16x32_bf16 v[40:43], v[246:249], v[148:151], v[40:43]
    s_add_u32 s66, s66, 5120
    buffer_load_dwordx4 v[144:147], v1, s[52:55], s71 offen offset:2048 sc1
    v_mfma_f32_16x16x32_bf16 v[44:47], v[250:253], v[148:151], v[44:47]
    v_mfma_f32_16x16x32_bf16 v[48:51], a[84:87], v[148:151], v[48:51]
    v_mfma_f32_16x16x32_bf16 v[52:55], a[88:91], v[148:151], v[52:55]
    v_mfma_f32_16x16x32_bf16 v[56:59], a[92:95], v[148:151], v[56:59]
    v_add_u32 v168, s66, v1
    s_waitcnt vmcnt(19)
    v_mfma_f32_16x16x32_bf16 v[40:43], a[96:99], v[152:155], v[40:43]
    buffer_load_dwordx4 v[148:151], v1, s[52:55], s71 offen offset:3072 sc1
    v_mfma_f32_16x16x32_bf16 v[44:47], a[100:103], v[152:155], v[44:47]
    v_mfma_f32_16x16x32_bf16 v[48:51], a[104:107], v[152:155], v[48:51]
    ds_write_b128 v168, v[60:63] offset:0
    v_mfma_f32_16x16x32_bf16 v[52:55], a[108:111], v[152:155], v[52:55]
    v_mfma_f32_16x16x32_bf16 v[56:59], a[112:115], v[152:155], v[56:59]
    s_waitcnt vmcnt(18)
    v_mfma_f32_16x16x32_bf16 v[40:43], a[116:119], v[156:159], v[40:43]
    s_add_u32 s71, s7, 8192
    buffer_load_dwordx4 v[152:155], v1, s[52:55], s71 offen offset:0 sc1
    v_mfma_f32_16x16x32_bf16 v[44:47], a[120:123], v[156:159], v[44:47]
    ds_write_b128 v168, v[64:67] offset:1024
    v_mfma_f32_16x16x32_bf16 v[48:51], a[124:127], v[156:159], v[48:51]
    v_mfma_f32_16x16x32_bf16 v[52:55], a[128:131], v[156:159], v[52:55]
    v_mfma_f32_16x16x32_bf16 v[56:59], a[132:135], v[156:159], v[56:59]
    s_waitcnt vmcnt(18)
    v_mfma_f32_16x16x32_bf16 v[40:43], a[136:139], v[160:163], v[40:43]
    ds_write_b128 v168, v[68:71] offset:2048
    buffer_load_dwordx4 v[156:159], v1, s[52:55], s71 offen offset:1024 sc1
    v_mfma_f32_16x16x32_bf16 v[44:47], a[140:143], v[160:163], v[44:47]
    v_mfma_f32_16x16x32_bf16 v[48:51], a[144:147], v[160:163], v[48:51]
    v_mfma_f32_16x16x32_bf16 v[52:55], a[148:151], v[160:163], v[52:55]
    v_mfma_f32_16x16x32_bf16 v[56:59], a[152:155], v[160:163], v[56:59]
    ds_write_b128 v168, v[72:75] offset:3072
    s_waitcnt vmcnt(18)
    v_mfma_f32_16x16x32_bf16 v[40:43], a[156:159], v[164:167], v[40:43]
    buffer_load_dwordx2 v[160:161], v36, s[52:55], s71 offen offset:2048 sc1
    buffer_load_dwordx2 v[162:163], v36, s[52:55], s71 offen offset:2560 sc1
    v_mfma_f32_16x16x32_bf16 v[44:47], a[160:163], v[164:167], v[44:47]
    v_mfma_f32_16x16x32_bf16 v[48:51], a[164:167], v[164:167], v[48:51]
    v_mfma_f32_16x16x32_bf16 v[52:55], a[168:171], v[164:167], v[52:55]
    ds_write_b128 v168, v[76:79] offset:4096
    v_mfma_f32_16x16x32_bf16 v[56:59], a[172:175], v[164:167], v[56:59]
    s_mul_i32 s75, s60, 10240
    s_add_u32 s75, s75, 69632
    s_add_u32 s75, s75, s100
    s_cmp_lt_u32 s62, 2
    s_cselect_b32 s15, 2, 1
    v_min_u32 v171, s15, v3
    v_bfe_u32 v170, v0, 1, 3
    v_lshlrev_b32 v170, 7, v170
    v_lshl_add_u32 v170, v171, 12, v170
    buffer_load_dwordx2 v[172:173], v170, s[52:55], s75 offen sc1
    s_waitcnt vmcnt(20)
    v_mfma_f32_16x16x32_bf16 v[40:43], a[176:179], v[104:107], v[40:43]
    v_lshlrev_b32 v60, 16, v14
    buffer_load_dwordx2 v[164:165], v36, s[52:55], s71 offen offset:3072 sc1
    buffer_load_dwordx2 v[166:167], v36, s[52:55], s71 offen offset:3584 sc1
    v_mfma_f32_16x16x32_bf16 v[44:47], a[180:183], v[104:107], v[44:47]
    v_and_b32 v61, 0xffff0000, v14
    v_mfma_f32_16x16x32_bf16 v[48:51], a[184:187], v[104:107], v[48:51]
    v_lshlrev_b32 v62, 16, v15
    v_mfma_f32_16x16x32_bf16 v[52:55], a[188:191], v[104:107], v[52:55]
    v_and_b32 v63, 0xffff0000, v15
    v_mfma_f32_16x16x32_bf16 v[56:59], a[192:195], v[104:107], v[56:59]
    v_lshlrev_b32 v64, 16, v16
    s_waitcnt vmcnt(21)
    v_mfma_f32_16x16x32_bf16 v[40:43], a[196:199], v[108:111], v[40:43]
    v_and_b32 v65, 0xffff0000, v16
    v_mfma_f32_16x16x32_bf16 v[44:47], a[200:203], v[108:111], v[44:47]
    v_lshlrev_b32 v66, 16, v17
    v_mfma_f32_16x16x32_bf16 v[48:51], a[204:207], v[108:111], v[48:51]
    v_and_b32 v67, 0xffff0000, v17
    v_mfma_f32_16x16x32_bf16 v[52:55], a[208:211], v[108:111], v[52:55]
    v_lshlrev_b32 v68, 16, v18
    v_mfma_f32_16x16x32_bf16 v[56:59], a[212:215], v[108:111], v[56:59]
    v_and_b32 v69, 0xffff0000, v18
    s_waitcnt vmcnt(19)
    v_mfma_f32_16x16x32_bf16 v[40:43], a[216:219], v[112:115], v[40:43]
    v_lshlrev_b32 v70, 16, v19
    v_mfma_f32_16x16x32_bf16 v[44:47], a[220:223], v[112:115], v[44:47]
    v_and_b32 v71, 0xffff0000, v19
    v_mfma_f32_16x16x32_bf16 v[48:51], a[224:227], v[112:115], v[48:51]
    v_lshlrev_b32 v72, 16, v20
    v_mfma_f32_16x16x32_bf16 v[52:55], a[228:231], v[112:115], v[52:55]
    v_and_b32 v73, 0xffff0000, v20
    v_mfma_f32_16x16x32_bf16 v[56:59], a[232:235], v[112:115], v[56:59]
    v_lshlrev_b32 v74, 16, v21
    s_waitcnt vmcnt(17)
    v_mfma_f32_16x16x32_bf16 v[40:43], a[236:239], v[116:119], v[40:43]
    v_and_b32 v75, 0xffff0000, v21
    v_mfma_f32_16x16x32_bf16 v[44:47], a[240:243], v[116:119], v[44:47]
    v_lshlrev_b32 v76, 16, v22
    v_mfma_f32_16x16x32_bf16 v[48:51], a[244:247], v[116:119], v[48:51]
    v_and_b32 v77, 0xffff0000, v22
    v_mfma_f32_16x16x32_bf16 v[52:55], a[248:251], v[116:119], v[52:55]
    v_lshlrev_b32 v78, 16, v23
    v_mfma_f32_16x16x32_bf16 v[56:59], a[252:255], v[116:119], v[56:59]
    v_and_b32 v79, 0xffff0000, v23
    s_waitcnt vmcnt(16)
    v_mfma_f32_16x16x32_bf16 v[60:63], v[186:189], v[120:123], v[60:63]
    v_mfma_f32_16x16x32_bf16 v[64:67], v[190:193], v[120:123], v[64:67]
    v_mfma_f32_16x16x32_bf16 v[68:71], v[194:197], v[120:123], v[68:71]
    s_add_u32 s66, s62, 3
    v_mfma_f32_16x16x32_bf16 v[72:75], v[198:201], v[120:123], v[72:75]
    v_mfma_f32_16x16x32_bf16 v[76:79], v[202:205], v[120:123], v[76:79]
    s_and_b32 s66, s66, 3
    s_waitcnt vmcnt(15)
    v_mfma_f32_16x16x32_bf16 v[60:63], v[206:209], v[124:127], v[60:63]
    s_mul_i32 s66, s66, 15360
    v_mfma_f32_16x16x32_bf16 v[64:67], v[210:213], v[124:127], v[64:67]
    v_mfma_f32_16x16x32_bf16 v[68:71], v[214:217], v[124:127], v[68:71]
    s_add_u32 s66, s66, 10240
    v_mfma_f32_16x16x32_bf16 v[72:75], v[218:221], v[124:127], v[72:75]
    v_mfma_f32_16x16x32_bf16 v[76:79], v[222:225], v[124:127], v[76:79]
    v_add_u32 v168, s66, v1
    s_waitcnt vmcnt(2)
    v_cmp_ne_u64 vcc, s[64:65], v[172:173]
    s_cbranch_vccz L_chk_12_ok
    s_mov_b32 s82, 0
L_chk_12:
    s_sleep 1
    buffer_load_dwordx2 v[172:173], v170, s[52:55], s75 offen sc1
    s_add_u32 s82, s82, 1
    s_cmp_gt_u32 s82, 0x40000
    s_waitcnt vmcnt(0)
    s_cbranch_scc1 L_chk_12_ok
    v_cmp_ne_u64 vcc, s[64:65], v[172:173]
    s_cbranch_vccnz L_chk_12
L_chk_12_ok:
    v_lshrrev_b32 v170, 3, v0
    v_and_b32 v171, 7, v0
    v_lshlrev_b32 v170, 12, v170
    v_lshl_add_u32 v170, v171, 4, v170
    s_mul_i32 s66, s60, 10
    s_add_u32 s66, s66, s62
    s_lshl_b32 s66, s66, 15
    s_lshl_b32 s15, s61, 7
    s_add_u32 s66, s66, s15
    s_add_u32 s66, s66, 19398656
    s_lshl_b32 s15, s62, 10
    s_add_u32 m0, s15, 61440
    s_nop 0
    buffer_load_dwordx4 v170, s[52:55], s66 offen sc1 lds
    s_add_u32 s66, s66, 131072
    s_add_u32 m0, s15, 65536
    s_nop 0
    buffer_load_dwordx4 v170, s[52:55], s66 offen sc1 lds
    s_add_u32 s66, s66, 131072
    s_add_u32 m0, s15, 69632
    s_cmp_lt_u32 s62, 2
    s_cselect_b32 s66, s66, 0x7ffff000
    buffer_load_dwordx4 v170, s[52:55], s66 offen sc1 lds
    v_mfma_f32_16x16x32_bf16 v[60:63], v[226:229], v[128:131], v[60:63]
    v_mfma_f32_16x16x32_bf16 v[64:67], v[230:233], v[128:131], v[64:67]
    ds_write_b128 v168, v[40:43] offset:0
    v_mfma_f32_16x16x32_bf16 v[68:71], v[234:237], v[128:131], v[68:71]
    v_mfma_f32_16x16x32_bf16 v[72:75], v[238:241], v[128:131], v[72:75]
    ds_write_b128 v168, v[44:47] offset:1024
    v_mfma_f32_16x16x32_bf16 v[76:79], v[242:245], v[128:131], v[76:79]
    v_mfma_f32_16x16x32_bf16 v[60:63], v[246:249], v[132:135], v[60:63]
    ds_write_b128 v168, v[48:51] offset:2048
    v_mfma_f32_16x16x32_bf16 v[64:67], v[250:253], v[132:135], v[64:67]
    v_mfma_f32_16x16x32_bf16 v[68:71], a[84:87], v[132:135], v[68:71]
    v_mfma_f32_16x16x32_bf16 v[72:75], a[88:91], v[132:135], v[72:75]
    ds_write_b128 v168, v[52:55] offset:3072
    v_mfma_f32_16x16x32_bf16 v[76:79], a[92:95], v[132:135], v[76:79]
    v_mfma_f32_16x16x32_bf16 v[60:63], a[96:99], v[136:139], v[60:63]
    ds_write_b128 v168, v[56:59] offset:4096
    v_mfma_f32_16x16x32_bf16 v[64:67], a[100:103], v[136:139], v[64:67]
    v_mfma_f32_16x16x32_bf16 v[68:71], a[104:107], v[136:139], v[68:71]
    v_mfma_f32_16x16x32_bf16 v[72:75], a[108:111], v[136:139], v[72:75]
    v_mfma_f32_16x16x32_bf16 v[76:79], a[112:115], v[136:139], v[76:79]
    s_waitcnt lgkmcnt(0)
    s_barrier
    v_mfma_f32_16x16x32_bf16 v[60:63], a[116:119], v[140:143], v[60:63]
    ds_read_b128 v[80:83], v169 offset:0
    v_mfma_f32_16x16x32_bf16 v[64:67], a[120:123], v[140:143], v[64:67]
    ds_read_b128 v[84:87], v169 offset:1024
    v_mfma_f32_16x16x32_bf16 v[68:71], a[124:127], v[140:143], v[68:71]
    ds_read_b128 v[88:91], v169 offset:2048
    v_mfma_f32_16x16x32_bf16 v[72:75], a[128:131], v[140:143], v[72:75]
    ds_read_b128 v[92:95], v169 offset:3072
    v_mfma_f32_16x16x32_bf16 v[76:79], a[132:135], v[140:143], v[76:79]
    ds_read_b128 v[96:99], v169 offset:4096
    v_mfma_f32_16x16x32_bf16 v[60:63], a[136:139], v[144:147], v[60:63]
    ds_read_b128 v[40:43], v169 offset:5120
    v_mfma_f32_16x16x32_bf16 v[64:67], a[140:143], v[144:147], v[64:67]
    ds_read_b128 v[44:47], v169 offset:6144
    v_mfma_f32_16x16x32_bf16 v[68:71], a[144:147], v[144:147], v[68:71]
    ds_read_b128 v[48:51], v169 offset:7168
    v_mfma_f32_16x16x32_bf16 v[72:75], a[148:151], v[144:147], v[72:75]
    ds_read_b128 v[52:55], v169 offset:8192
    v_mfma_f32_16x16x32_bf16 v[76:79], a[152:155], v[144:147], v[76:79]
    ds_read_b128 v[56:59], v169 offset:9216
    v_mfma_f32_16x16x32_bf16 v[60:63], a[156:159], v[148:151], v[60:63]
    s_waitcnt lgkmcnt(0)
    v_mfma_f32_16x16x32_bf16 v[64:67], a[160:163], v[148:151], v[64:67]
    v_add_f32 v80, v80, v40
    v_mfma_f32_16x16x32_bf16 v[68:71], a[164:167], v[148:151], v[68:71]
    v_add_f32 v81, v81, v41
    v_mfma_f32_16x16x32_bf16 v[72:75], a[168:171], v[148:151], v[72:75]
    v_add_f32 v82, v82, v42
    v_mfma_f32_16x16x32_bf16 v[76:79], a[172:175], v[148:151], v[76:79]
    v_add_f32 v83, v83, v43
    v_mfma_f32_16x16x32_bf16 v[60:63], a[176:179], v[152:155], v[60:63]
    v_add_f32 v84, v84, v44
    v_mfma_f32_16x16x32_bf16 v[64:67], a[180:183], v[152:155], v[64:67]
    v_add_f32 v85, v85, v45
    v_mfma_f32_16x16x32_bf16 v[68:71], a[184:187], v[152:155], v[68:71]
    v_add_f32 v86, v86, v46
    v_add_f32 v87, v87, v47
    v_mfma_f32_16x16x32_bf16 v[72:75], a[188:191], v[152:155], v[72:75]
    v_add_f32 v88, v88, v48
    v_mfma_f32_16x16x32_bf16 v[76:79], a[192:195], v[152:155], v[76:79]
    v_add_f32 v89, v89, v49
    v_mfma_f32_16x16x32_bf16 v[60:63], a[196:199], v[156:159], v[60:63]
    v_add_f32 v90, v90, v50
    v_mfma_f32_16x16x32_bf16 v[64:67], a[200:203], v[156:159], v[64:67]
    v_add_f32 v91, v91, v51
    v_mfma_f32_16x16x32_bf16 v[68:71], a[204:207], v[156:159], v[68:71]
    v_add_f32 v92, v92, v52
    v_mfma_f32_16x16x32_bf16 v[72:75], a[208:211], v[156:159], v[72:75]
    v_add_f32 v93, v93, v53
    v_mfma_f32_16x16x32_bf16 v[76:79], a[212:215], v[156:159], v[76:79]
    v_add_f32 v94, v94, v54
    v_mfma_f32_16x16x32_bf16 v[60:63], a[216:219], v[160:163], v[60:63]
    v_add_f32 v95, v95, v55
    v_mfma_f32_16x16x32_bf16 v[64:67], a[220:223], v[160:163], v[64:67]
    v_add_f32 v96, v96, v56
    v_mfma_f32_16x16x32_bf16 v[68:71], a[224:227], v[160:163], v[68:71]
    v_add_f32 v97, v97, v57
    v_mfma_f32_16x16x32_bf16 v[72:75], a[228:231], v[160:163], v[72:75]
    v_add_f32 v98, v98, v58
    v_mfma_f32_16x16x32_bf16 v[76:79], a[232:235], v[160:163], v[76:79]
    v_add_f32 v99, v99, v59
    s_waitcnt vmcnt(3)
    v_mfma_f32_16x16x32_bf16 v[60:63], a[236:239], v[164:167], v[60:63]
    ds_read_b128 v[40:43], v169 offset:10240
    v_mfma_f32_16x16x32_bf16 v[64:67], a[240:243], v[164:167], v[64:67]
    ds_read_b128 v[44:47], v169 offset:11264
    v_mfma_f32_16x16x32_bf16 v[68:71], a[244:247], v[164:167], v[68:71]
    ds_read_b128 v[48:51], v169 offset:12288
    v_mfma_f32_16x16x32_bf16 v[72:75], a[248:251], v[164:167], v[72:75]
    ds_read_b128 v[52:55], v169 offset:13312
    v_mfma_f32_16x16x32_bf16 v[76:79], a[252:255], v[164:167], v[76:79]
    ds_read_b128 v[56:59], v169 offset:14336
    s_waitcnt vmcnt(0)
    s_barrier
    ds_read_b64_tr_b16 v[176:177], v24 offset:0
    ds_read_b64_tr_b16 v[178:179], v24 offset:2048
    ds_read_b64_tr_b16 v[180:181], v24 offset:4096
    ds_read_b64_tr_b16 v[182:183], v24 offset:6144
    ds_read_b64_tr_b16 v[184:185], v24 offset:8192
    v_lshlrev_b32 v144, 16, v4
    v_and_b32 v145, 0xffff0000, v4
    v_lshlrev_b32 v146, 16, v5
    v_and_b32 v147, 0xffff0000, v5
    v_lshlrev_b32 v148, 16, v6
    v_and_b32 v149, 0xffff0000, v6
    v_lshlrev_b32 v150, 16, v7
    v_and_b32 v151, 0xffff0000, v7
    v_lshlrev_b32 v152, 16, v8
    v_and_b32 v153, 0xffff0000, v8
    v_lshlrev_b32 v154, 16, v9
    v_and_b32 v155, 0xffff0000, v9
    v_lshlrev_b32 v156, 16, v10
    v_and_b32 v157, 0xffff0000, v10
    v_lshlrev_b32 v158, 16, v11
    v_and_b32 v159, 0xffff0000, v11
    v_lshlrev_b32 v160, 16, v12
    v_and_b32 v161, 0xffff0000, v12
    v_lshlrev_b32 v162, 16, v13
    v_and_b32 v163, 0xffff0000, v13
    s_waitcnt lgkmcnt(5)
    v_pk_add_f32 v[80:81], v[80:81], v[40:41]
    v_pk_add_f32 v[82:83], v[82:83], v[42:43]
    v_pk_add_f32 v[84:85], v[84:85], v[44:45]
    v_pk_add_f32 v[86:87], v[86:87], v[46:47]
    v_pk_add_f32 v[88:89], v[88:89], v[48:49]
    v_pk_add_f32 v[90:91], v[90:91], v[50:51]
    v_pk_add_f32 v[92:93], v[92:93], v[52:53]
    v_pk_add_f32 v[94:95], v[94:95], v[54:55]
    v_pk_add_f32 v[96:97], v[96:97], v[56:57]
    v_pk_add_f32 v[98:99], v[98:99], v[58:59]
    v_pk_add_f32 v[60:61], v[60:61], v[80:81]
    v_pk_add_f32 v[62:63], v[62:63], v[82:83]
    v_pk_add_f32 v[64:65], v[64:65], v[84:85]
    v_pk_add_f32 v[66:67], v[66:67], v[86:87]
    v_pk_add_f32 v[68:69], v[68:69], v[88:89]
    v_pk_add_f32 v[70:71], v[70:71], v[90:91]
    v_pk_add_f32 v[72:73], v[72:73], v[92:93]
    v_pk_add_f32 v[74:75], v[74:75], v[94:95]
    v_pk_add_f32 v[76:77], v[76:77], v[96:97]
    v_pk_add_f32 v[78:79], v[78:79], v[98:99]
    v_pk_mul_f32 v[80:81], v[60:61], s[68:69] op_sel_hi:[1,0]
    v_pk_mul_f32 v[82:83], v[62:63], s[68:69] op_sel_hi:[1,0]
    v_pk_mul_f32 v[84:85], v[64:65], s[68:69] op_sel_hi:[1,0]
    v_pk_mul_f32 v[86:87], v[66:67], s[68:69] op_sel_hi:[1,0]
    v_pk_mul_f32 v[88:89], v[68:69], s[68:69] op_sel_hi:[1,0]
    v_pk_mul_f32 v[90:91], v[70:71], s[68:69] op_sel_hi:[1,0]
    v_pk_mul_f32 v[92:93], v[72:73], s[68:69] op_sel_hi:[1,0]
    v_pk_mul_f32 v[94:95], v[74:75], s[68:69] op_sel_hi:[1,0]
    v_pk_mul_f32 v[96:97], v[76:77], s[68:69] op_sel_hi:[1,0]
    v_pk_mul_f32 v[98:99], v[78:79], s[68:69] op_sel_hi:[1,0]
    v_exp_f32 v80, v80
    v_exp_f32 v81, v81
    v_exp_f32 v82, v82
    v_exp_f32 v83, v83
    v_exp_f32 v84, v84
    v_exp_f32 v85, v85
    v_exp_f32 v86, v86
    v_exp_f32 v87, v87
    v_exp_f32 v88, v88
    v_exp_f32 v89, v89
    v_exp_f32 v90, v90
    v_exp_f32 v91, v91
    v_exp_f32 v92, v92
    v_exp_f32 v93, v93
    v_exp_f32 v94, v94
    v_exp_f32 v95, v95
    v_exp_f32 v96, v96
    v_exp_f32 v97, v97
    v_exp_f32 v98, v98
    v_exp_f32 v99, v99
    s_waitcnt lgkmcnt(0)
    v_lshlrev_b32 v124, 16, v176
    v_and_b32 v125, 0xffff0000, v176
    v_lshlrev_b32 v126, 16, v177
    v_and_b32 v127, 0xffff0000, v177
    v_lshlrev_b32 v128, 16, v178
    v_and_b32 v129, 0xffff0000, v178
    v_lshlrev_b32 v130, 16, v179
    v_and_b32 v131, 0xffff0000, v179
    v_lshlrev_b32 v132, 16, v180
    v_and_b32 v133, 0xffff0000, v180
    v_lshlrev_b32 v134, 16, v181
    v_and_b32 v135, 0xffff0000, v181
    v_lshlrev_b32 v136, 16, v182
    v_and_b32 v137, 0xffff0000, v182
    v_lshlrev_b32 v138, 16, v183
    v_and_b32 v139, 0xffff0000, v183
    v_lshlrev_b32 v140, 16, v184
    v_and_b32 v141, 0xffff0000, v184
    v_lshlrev_b32 v142, 16, v185
    v_and_b32 v143, 0xffff0000, v185
    v_pk_add_f32 v[80:81], v[80:81], 1.0 op_sel_hi:[1,0]
    v_pk_add_f32 v[82:83], v[82:83], 1.0 op_sel_hi:[1,0]
    v_pk_add_f32 v[84:85], v[84:85], 1.0 op_sel_hi:[1,0]
    v_pk_add_f32 v[86:87], v[86:87], 1.0 op_sel_hi:[1,0]
    v_pk_add_f32 v[88:89], v[88:89], 1.0 op_sel_hi:[1,0]
    v_pk_add_f32 v[90:91], v[90:91], 1.0 op_sel_hi:[1,0]
    v_pk_add_f32 v[92:93], v[92:93], 1.0 op_sel_hi:[1,0]
    v_pk_add_f32 v[94:95], v[94:95], 1.0 op_sel_hi:[1,0]
    v_pk_add_f32 v[96:97], v[96:97], 1.0 op_sel_hi:[1,0]
    v_pk_add_f32 v[98:99], v[98:99], 1.0 op_sel_hi:[1,0]
    v_pk_mul_f32 v[124:125], v[124:125], v[60:61]
    v_pk_mul_f32 v[126:127], v[126:127], v[62:63]
    v_pk_mul_f32 v[128:129], v[128:129], v[64:65]
    v_pk_mul_f32 v[130:131], v[130:131], v[66:67]
    v_pk_mul_f32 v[132:133], v[132:133], v[68:69]
    v_pk_mul_f32 v[134:135], v[134:135], v[70:71]
    v_pk_mul_f32 v[136:137], v[136:137], v[72:73]
    v_pk_mul_f32 v[138:139], v[138:139], v[74:75]
    v_pk_mul_f32 v[140:141], v[140:141], v[76:77]
    v_pk_mul_f32 v[142:143], v[142:143], v[78:79]
    v_rcp_f32 v80, v80
    v_rcp_f32 v81, v81
    v_rcp_f32 v82, v82
    v_rcp_f32 v83, v83
    v_pk_fma_f32 v[80:81], v[80:81], v[124:125], v[144:145]
    v_pk_fma_f32 v[82:83], v[82:83], v[126:127], v[146:147]
    v_cvt_pk_bf16_f32 v104, v80, v81
    v_cvt_pk_bf16_f32 v105, v82, v83
    v_rcp_f32 v84, v84
    v_rcp_f32 v85, v85
    v_rcp_f32 v86, v86
    v_rcp_f32 v87, v87
    ds_write_b64 v25, v[104:105] offset:0
    v_pk_fma_f32 v[84:85], v[84:85], v[128:129], v[148:149]
    v_pk_fma_f32 v[86:87], v[86:87], v[130:131], v[150:151]
    v_cvt_pk_bf16_f32 v106, v84, v85
    v_cvt_pk_bf16_f32 v107, v86, v87
    v_rcp_f32 v88, v88
    v_rcp_f32 v89, v89
    v_rcp_f32 v90, v90
    v_rcp_f32 v91, v91
    ds_write_b64 v25, v[106:107] offset:32
    v_pk_fma_f32 v[88:89], v[88:89], v[132:133], v[152:153]
    v_pk_fma_f32 v[90:91], v[90:91], v[134:135], v[154:155]
    v_cvt_pk_bf16_f32 v108, v88, v89
    v_cvt_pk_bf16_f32 v109, v90, v91
    v_rcp_f32 v92, v92
    v_rcp_f32 v93, v93
    v_rcp_f32 v94, v94
    v_rcp_f32 v95, v95
    ds_write_b64 v25, v[108:109] offset:64
    v_pk_fma_f32 v[92:93], v[92:93], v[136:137], v[156:157]
    v_pk_fma_f32 v[94:95], v[94:95], v[138:139], v[158:159]
    v_cvt_pk_bf16_f32 v110, v92, v93
    v_cvt_pk_bf16_f32 v111, v94, v95
    v_rcp_f32 v96, v96
    v_rcp_f32 v97, v97
    v_rcp_f32 v98, v98
    v_rcp_f32 v99, v99
    ds_write_b64 v25, v[110:111] offset:96
    v_pk_fma_f32 v[96:97], v[96:97], v[140:141], v[160:161]
    v_pk_fma_f32 v[98:99], v[98:99], v[142:143], v[162:163]
    v_cvt_pk_bf16_f32 v112, v96, v97
    v_cvt_pk_bf16_f32 v113, v98, v99
    ds_write_b64 v25, v[112:113] offset:128
    ds_read_b128 v[80:83], v26
    ds_read_b128 v[84:87], v27
    ds_read_b128 v[88:91], v28
    s_waitcnt lgkmcnt(2)
    buffer_store_dwordx4 v[80:83], v29, s[56:59], s14 offen
    s_waitcnt lgkmcnt(1)
    buffer_store_dwordx4 v[84:87], v30, s[56:59], s14 offen
    s_waitcnt lgkmcnt(0)
    s_mov_b32 exec_hi, 0
    buffer_store_dwordx4 v[88:91], v31, s[56:59], s14 offen
    s_mov_b32 exec_hi, -1
    s_cmp_eq_u32 s2, 0
    s_cbranch_scc0 L_noep
    s_cmp_eq_u32 s62, 0
    s_cbranch_scc0 L_noep
    s_mov_b32 s66, 0
    s_mov_b64 exec, 65535
    buffer_store_dwordx2 v[38:39], v36, s[52:55], s66 offen sc1
    s_mov_b64 exec, -1
L_noep:
L_end:
    s_endpgm
.section .rodata,"a"
.p2align 6
.amdhsa_kernel recurrent_scan__ssm_conv_s4__mixer_s_mlp__prompt_kernel
  .amdhsa_next_free_vgpr 512
  .amdhsa_next_free_sgpr 102
  .amdhsa_accum_offset 256
  .amdhsa_group_segment_fixed_size 0
  .amdhsa_kernarg_size 136
  .amdhsa_user_sgpr_count 2
  .amdhsa_user_sgpr_kernarg_segment_ptr 1
  .amdhsa_system_sgpr_workgroup_id_x 1
.end_amdhsa_kernel
```
